```python
import torch

def _softmax(x, axis=-1):
    return torch.softmax(x, dim=axis)
def _gelu(x):
    return torch.nn.functional.gelu(x, approximate="tanh")
def _silu(x):
    return torch.nn.functional.silu(x)
def _sigmoid(x):
    return torch.sigmoid(x)
def _layernorm(x, axis=-1, eps=1e-5):
    m = x.mean(dim=axis, keepdim=True)
    v = x.var(dim=axis, keepdim=True, unbiased=False)
    return (x - m) / torch.sqrt(v + eps)
def _scatter_add(tgt, idx, src, axis=0):
    return tgt.clone().index_add_(axis, idx, src)
def _segment_sum(src, seg, n):
    out = torch.zeros((n,) + src.shape[1:], dtype=src.dtype)
    return out.index_add_(0, seg, src)
def _pad(x, pw):
    flat = tuple(v for pair in reversed(pw) for v in pair)
    return torch.nn.functional.pad(x, flat)

kernel_name = 'sequential_preLN__ssm_conv_s4d__glu_gated_bilinear__prompt'

def setup_inputs():

    _w = (lambda a: (lambda t: t.to(torch.bfloat16) if t.is_floating_point() else t)(torch.as_tensor(a)))
    def _A_setup():
        Bsz, L, D, N = 1, 2048, 640, 192
        return {
            "u": _w((lambda *s: torch.randn(*s, dtype=torch.bfloat16) * 0.05)(Bsz, L, D)),
            "log_A_real": _w((lambda *s: torch.randn(*s, dtype=torch.bfloat16) * 6.4)(D, N) * 0.5),
            "A_imag": _w((lambda *s: torch.randn(*s, dtype=torch.bfloat16) * 0.05)(D, N) * 3.14),
            "C_real": _w((lambda *s: torch.randn(*s, dtype=torch.bfloat16) * 0.05)(D, N) / N ** 0.5),
            "C_imag": _w((lambda *s: torch.randn(*s, dtype=torch.bfloat16) * 0.05)(D, N) / N ** 0.5),
            "log_dt": _w((lambda *s: torch.randn(*s, dtype=torch.bfloat16) * 0.05)(D) * 0.5 - 4.0),
            "D_skip": _w((lambda *s: torch.randn(*s, dtype=torch.bfloat16) * 0.05)(D)),
        }
    _A_in = _A_setup()

    def _B_setup():
        B, S, D, F = 1, 2048, 640, 1536
        return {
            "x": _w((lambda *s: torch.randn(*s, dtype=torch.bfloat16) * 0.05)(B, S, D)),
            "w_gate": _w((lambda *s: torch.randn(*s, dtype=torch.bfloat16) * 0.4)(D, F) * (D ** -0.5)),
            "w_up": _w((lambda *s: torch.randn(*s, dtype=torch.bfloat16) * 0.4)(D, F) * (D ** -0.5)),
            "w_down": _w((lambda *s: torch.randn(*s, dtype=torch.bfloat16) * 0.4)(F, D) * (F ** -0.5)),
        }
    _B_in = _B_setup()

    return {
        "A_u": _A_in["u"],
        "A_log_A_real": _A_in["log_A_real"],
        "A_A_imag": _A_in["A_imag"],
        "A_C_real": _A_in["C_real"],
        "A_C_imag": _A_in["C_imag"],
        "A_log_dt": _A_in["log_dt"],
        "A_D_skip": _A_in["D_skip"],
        "B_x": _B_in["x"],
        "B_w_gate": _B_in["w_gate"],
        "B_w_up": _B_in["w_up"],
        "B_w_down": _B_in["w_down"],
    }

def reference(A_u, A_log_A_real, A_A_imag, A_C_real, A_C_imag, A_log_dt, A_D_skip, B_x, B_w_gate, B_w_up, B_w_down):
    def _A_ref(u, log_A_real, A_imag, C_real, C_imag, log_dt, D_skip):
        L = u.shape[1]
        dt = torch.exp(log_dt)
        A = -torch.exp(log_A_real) + 1j * A_imag
        C = (C_real + 1j * C_imag) * dt[:, None]
        pos = (lambda x, dt: x.to(dt))(torch.arange(L), log_dt.dtype)
        P = torch.exp((A * dt[:, None])[:, :, None] * pos[None, None, :])
        K = 2.0 * torch.einsum("dn,dnl->dl", C, P).real
        L2 = 2 * L
        u_t = (lambda x, *d: x.permute(*d))(u, 0, 2, 1)
        Kf = (lambda x, *a, **k: torch.fft.rfft(x.float(), *a, **k))(K, L2)
        Uf = (lambda x, *a, **k: torch.fft.rfft(x.float(), *a, **k))(u_t, L2)
        y = (lambda x, *a, **k: torch.fft.irfft(x, *a, **k).to(torch.bfloat16))(Uf * Kf[None, :, :], L2)[:, :, :L]
        y = (lambda x, *d: x.permute(*d))(y, 0, 2, 1)
        return y + u * D_skip[None, None, :]

    def _B_ref(x, w_gate, w_up, w_down):
        g = torch.einsum("bsd,df->bsf", x, w_gate)
        u = torch.einsum("bsd,df->bsf", x, w_up)
        h = g * u
        return torch.einsum("bsf,fd->bsd", h, w_down)

    x = A_u
    h = x + _A_ref(_layernorm(x, axis=-1), A_log_A_real, A_A_imag, A_C_real, A_C_imag, A_log_dt, A_D_skip)
    h2 = h + _B_ref(_layernorm(h, axis=-1), B_w_gate, B_w_up, B_w_down)
    return h2
```

```asm
; @launch grid=(256,1,1) block=(256,1,1) lds=163840
.amdgcn_target "amdgcn-amd-amdhsa--gfx950"
.text
.globl sequential_preLN__ssm_conv_s4d__glu_gated_bilinear__prompt_kernel
.p2align 8
.type sequential_preLN__ssm_conv_s4d__glu_gated_bilinear__prompt_kernel,@function
sequential_preLN__ssm_conv_s4d__glu_gated_bilinear__prompt_kernel:
    s_cmp_ge_u32 s2, 256
    s_cbranch_scc1 L_end
    s_load_dwordx16 s[8:23], s[0:1], 0
    s_load_dwordx8 s[24:31], s[0:1], 64
    s_load_dwordx4 s[32:35], s[0:1], 96
    v_lshrrev_b32 v1, 6, v0
    v_and_b32 v0, 63, v0
    s_and_b32 s61, s2, 7
    v_readfirstlane_b32 s60, v1
    s_lshr_b32 s62, s2, 3
    s_mov_b32 s83, 0xffff0000
    v_lshlrev_b32 v15, 4, v0
    s_cmp_lg_u32 s60, 3
    s_cbranch_scc1 L_conv
    v_lshrrev_b32 v1, 4, v0
    v_bfe_u32 v2, v0, 3, 1
    v_lshl_add_u32 v1, v1, 3, v2
    v_mul_u32_u24 v1, 1280, v1
    v_and_b32 v2, 7, v0
    v_lshl_add_u32 v1, v2, 4, v1
    s_lshr_b32 s64, s2, 2
    s_and_b32 s65, s2, 3
    s_lshl_b32 s66, s64, 4
    s_add_u32 s66, s66, s65
    s_mul_i32 s66, s66, 2560
    v_add_u32 v1, s66, v1
    v_mov_b32 v3, 0
    v_add_u32 v4, 0, v0
    v_mul_u32_u24 v5, 205, v4
    v_lshrrev_b32 v5, 12, v5
    v_mul_u32_u24 v6, 20, v5
    v_sub_u32 v4, v4, v6
    v_lshrrev_b32 v6, 2, v5
    v_and_b32 v6, 2, v6
    v_xor_b32 v4, v4, v6
    v_mul_u32_u24 v5, 1280, v5
    v_lshl_add_u32 v126, v4, 4, v5
    v_add_u32 v4, 64, v0
    v_mul_u32_u24 v5, 205, v4
    v_lshrrev_b32 v5, 12, v5
    v_mul_u32_u24 v6, 20, v5
    v_sub_u32 v4, v4, v6
    v_lshrrev_b32 v6, 2, v5
    v_and_b32 v6, 2, v6
    v_xor_b32_e64 v4, v4, v6
    v_mul_u32_u24 v5, 1280, v5
    v_lshl_add_u32 v127, v4, 4, v5
    v_add_u32 v4, 128, v0
    v_mul_u32_u24 v5, 205, v4
    v_lshrrev_b32 v5, 12, v5
    v_mul_u32_u24 v6, 20, v5
    v_sub_u32 v4, v4, v6
    v_lshrrev_b32 v6, 2, v5
    v_and_b32 v6, 2, v6
    v_xor_b32 v4, v4, v6
    v_mul_u32_u24 v5, 1280, v5
    v_lshl_add_u32 v128, v4, 4, v5
    v_add_u32 v4, 192, v0
    v_mul_u32_u24 v5, 205, v4
    v_lshrrev_b32 v5, 12, v5
    v_mul_u32_u24 v6, 20, v5
    v_sub_u32 v4, v4, v6
    v_lshrrev_b32 v6, 2, v5
    v_and_b32 v6, 2, v6
    v_xor_b32 v4, v4, v6
    v_mul_u32_u24 v5, 1280, v5
    v_lshl_add_u32 v129, v4, 4, v5
    v_add_u32 v4, 256, v0
    v_mul_u32_u24 v5, 205, v4
    v_lshrrev_b32 v5, 12, v5
    v_mul_u32_u24 v6, 20, v5
    v_sub_u32 v4, v4, v6
    v_lshrrev_b32 v6, 2, v5
    v_and_b32 v6, 2, v6
    v_xor_b32 v4, v4, v6
    v_mul_u32_u24 v5, 1280, v5
    v_lshl_add_u32 v130, v4, 4, v5
    s_mul_i32 s66, s64, 40960
    s_mul_i32 s67, s65, 320
    s_add_u32 s66, s66, s67
    s_mul_i32 s72, s65, 655360
    s_lshl_b32 s67, s64, 6
    s_add_u32 s72, s72, s67
    s_add_u32 s72, s72, 6946816
    s_waitcnt lgkmcnt(0)
    s_mov_b32 s36, s8
    s_mov_b32 s37, s9
    s_mov_b32 s38, 0x280000
    s_mov_b32 s39, 0x20000
    s_mov_b32 m0, 0
    s_nop 0
    buffer_load_dwordx4 v126, s[36:39], s66 offen lds
    s_mov_b32 m0, 1024
    s_nop 0
    buffer_load_dwordx4 v127, s[36:39], s66 offen lds
    s_mov_b32 m0, 2048
    s_nop 0
    buffer_load_dwordx4 v128, s[36:39], s66 offen lds
    s_mov_b32 m0, 3072
    s_nop 0
    buffer_load_dwordx4 v129, s[36:39], s66 offen lds
    s_mov_b32 m0, 4096
    s_nop 0
    buffer_load_dwordx4 v130, s[36:39], s66 offen lds
    s_add_u32 s66, s66, 20480
    s_mov_b32 m0, 5120
    s_nop 0
    buffer_load_dwordx4 v126, s[36:39], s66 offen lds
    s_mov_b32 m0, 6144
    s_nop 0
    buffer_load_dwordx4 v127, s[36:39], s66 offen lds
    s_mov_b32 m0, 7168
    s_nop 0
    buffer_load_dwordx4 v128, s[36:39], s66 offen lds
    s_mov_b32 m0, 8192
    s_nop 0
    buffer_load_dwordx4 v129, s[36:39], s66 offen lds
    s_mov_b32 m0, 9216
    s_nop 0
    buffer_load_dwordx4 v130, s[36:39], s66 offen lds
    s_nop 0
    global_load_dwordx4 v[16:19], v1, s[8:9] offset:0
    global_load_dwordx4 v[20:23], v1, s[8:9] offset:128
    global_load_dwordx4 v[24:27], v1, s[8:9] offset:256
    global_load_dwordx4 v[28:31], v1, s[8:9] offset:384
    global_load_dwordx4 v[32:35], v1, s[8:9] offset:512
    global_load_dwordx4 v[36:39], v1, s[8:9] offset:640
    global_load_dwordx4 v[40:43], v1, s[8:9] offset:768
    global_load_dwordx4 v[44:47], v1, s[8:9] offset:896
    global_load_dwordx4 v[48:51], v1, s[8:9] offset:1024
    global_load_dwordx4 v[52:55], v1, s[8:9] offset:1152
    global_load_dword v212, v3, s[34:35] sc1
    s_branch L_aux
L_conv:
    s_cmp_lg_u32 s60, 1
    s_cbranch_scc1 L_nocode
    s_getpc_b64 s[4:5]
L_pc_1:
    s_sub_u32 s4, s4, L_pc_1-sequential_preLN__ssm_conv_s4d__glu_gated_bilinear__prompt_kernel
    s_subb_u32 s5, s5, 0
    s_mov_b32 s6, 42368
    s_mov_b32 s7, 0x20000
    v_lshlrev_b32 v2, 12, v0
    s_lshl_b32 s3, s62, 7
    s_mov_b64 exec, 0xfff
    buffer_load_dword a255, v2, s[4:7], s3 offen
    s_mov_b64 exec, -1
L_nocode:
    s_cmp_ge_u32 s62, 27
    s_cbranch_scc1 L_work
    s_mul_i32 s64, s62, 3
    s_add_u32 s64, s64, s60
    s_min_u32 s65, s64, 79
    s_mul_i32 s66, s61, 80
    s_add_u32 s81, s66, s65
    s_cmp_lt_u32 s64, 80
    s_cselect_b32 s86, 0x280000, 0
    s_mov_b32 s87, 0x20000
    s_mul_i32 s67, s81, 384
    s_lshl_b32 s68, s81, 1
    v_mov_b32 v40, 0
    v_mov_b32 v41, 0
    v_mov_b32 v42, 0
    v_mov_b32 v43, 0
    v_mov_b32 v44, 0
    v_mov_b32 v45, 0
    v_mov_b32 v46, 0
    v_mov_b32 v47, 0
    v_mov_b32 v48, 0
    v_mov_b32 v49, 0
    v_mov_b32 v50, 0
    v_mov_b32 v51, 0
    v_mov_b32 v52, 0
    v_mov_b32 v53, 0
    v_lshl_add_u32 v1, v0, 1, s67
    v_mov_b32 v2, s68
    v_mov_b32 v3, 0
    s_waitcnt lgkmcnt(0)
    global_load_short_d16_hi v52, v2, s[18:19]
    s_nop 0
    global_load_short_d16_hi v40, v1, s[10:11] offset:0
    global_load_short_d16_hi v41, v1, s[12:13] offset:0
    global_load_short_d16_hi v42, v1, s[14:15] offset:0
    global_load_short_d16_hi v43, v1, s[16:17] offset:0
    global_load_short_d16_hi v44, v1, s[10:11] offset:128
    global_load_short_d16_hi v45, v1, s[12:13] offset:128
    global_load_short_d16_hi v46, v1, s[14:15] offset:128
    global_load_short_d16_hi v47, v1, s[16:17] offset:128
    global_load_short_d16_hi v48, v1, s[10:11] offset:256
    global_load_short_d16_hi v49, v1, s[12:13] offset:256
    global_load_short_d16_hi v50, v1, s[14:15] offset:256
    global_load_short_d16_hi v51, v1, s[16:17] offset:256
    global_load_short_d16_hi v53, v2, s[20:21]
    global_load_dword v54, v3, s[34:35] sc1
    s_lshr_b32 s64, s61, 1
    s_lshl_b32 s64, s64, 2
    s_lshr_b32 s65, s62, 3
    s_add_u32 s76, s64, s65
    s_and_b32 s64, s61, 1
    s_lshl_b32 s64, s64, 3
    s_and_b32 s80, s62, 7
    s_add_u32 s77, s64, s80
    s_lshl_b32 s64, s61, 1
    s_lshr_b32 s65, s62, 4
    s_add_u32 s78, s64, s65
    s_bfe_u32 s79, s62, 0x10003
    s_mov_b32 s44, s34
    s_mov_b32 s45, s35
    s_mov_b32 s46, 0x11a0000
    s_mov_b32 s47, 0x20000
    s_add_u32 s40, s34, 0x920000
    s_addc_u32 s41, s35, 0
    s_mov_b32 s42, 0x280000
    s_mov_b32 s43, 0x20000
    s_lshl_b32 s64, s77, 2
    s_add_u32 s64, s64, s60
    s_mul_i32 s64, s64, 61440
    s_add_u32 s92, s64, 1048576
    s_mov_b32 s84, s40
    s_mov_b32 s85, s41
    s_mul_i32 s69, s60, 16704
    s_add_u32 s69, s69, 87040
    s_mul_i32 s70, s60, 4608
    s_add_u32 s70, s70, 137152
    s_mul_i32 s71, s60, 4160
    s_add_u32 s71, s71, 150976
    v_lshlrev_b32 v1, 2, v0
    v_xor_b32 v16, 0, v1
    v_add_u32 v16, s69, v16
    v_xor_b32 v17, 16, v1
    v_add_u32 v17, s69, v17
    v_xor_b32 v18, 32, v1
    v_add_u32 v18, s69, v18
    v_xor_b32 v19, 48, v1
    v_add_u32 v19, s69, v19
    v_xor_b32 v20, 64, v1
    v_add_u32 v20, s69, v20
    v_xor_b32 v21, 80, v1
    v_add_u32 v21, s69, v21
    v_xor_b32 v22, 96, v1
    v_add_u32 v22, s69, v22
    v_xor_b32 v23, 112, v1
    v_add_u32 v23, s69, v23
    v_xor_b32 v24, 128, v1
    v_add_u32 v24, s69, v24
    v_xor_b32 v25, 144, v1
    v_add_u32 v25, s69, v25
    v_xor_b32 v26, 160, v1
    v_add_u32_e64 v26, s69, v26
    v_xor_b32 v27, 176, v1
    v_add_u32 v27, s69, v27
    v_xor_b32 v28, 192, v1
    v_add_u32 v28, s69, v28
    v_xor_b32 v29, 208, v1
    v_add_u32 v29, s69, v29
    v_xor_b32 v30, 224, v1
    v_add_u32 v30, s69, v30
    v_xor_b32 v31, 240, v1
    v_add_u32 v31, s69, v31
    v_and_b32 v1, 31, v0
    v_lshrrev_b32 v2, 5, v0
    v_lshrrev_b32 v3, 3, v1
    v_and_b32 v4, 3, v1
    v_lshl_add_u32 v3, v3, 2, v4
    v_xor_b32 v3, v3, v2
    v_lshlrev_b32_e64 v3, 4, v3
    v_lshl_add_u32 v5, v1, 8, s69
    v_xor_b32 v32, 0, v3
    v_add_u32 v32, v32, v5
    v_xor_b32 v33, 32, v3
    v_add_u32 v33, v33, v5
    v_xor_b32 v34, 64, v3
    v_add_u32 v34, v34, v5
    v_xor_b32 v35, 96, v3
    v_add_u32 v35, v35, v5
    v_xor_b32 v36, 128, v3
    v_add_u32 v36, v36, v5
    v_xor_b32 v37, 160, v3
    v_add_u32 v37, v37, v5
    v_xor_b32 v38, 192, v3
    v_add_u32 v38, v38, v5
    v_xor_b32 v39, 224, v3
    v_add_u32 v39, v39, v5
    v_and_b32 v1, 15, v0
    v_lshrrev_b32 v2, 4, v0
    v_mul_u32_u24 v3, 4160, v4
    v_lshrrev_b32 v5, 2, v1
    v_lshl_add_u32 v3, v5, 3, v3
    v_lshlrev_b32 v5, 4, v2
    v_sub_u32 v3, v3, v5
    s_add_u32 s72, s69, 56
    v_add_u32 v208, s72, v3
    v_lshl_add_u32 v3, v1, 5, v5
    s_add_u32 s72, s70, 32
    v_add_u32 v209, s72, v3
    v_add_u32 v210, s71, v3
    s_lshl_b32 s72, s81, 7
    v_and_b32 v3, 3, v1
    v_lshlrev_b32 v3, 5, v3
    v_lshl_add_u32 v3, v2, 3, v3
    v_lshrrev_b32_e64 v6, 2, v1
    v_mul_u32_u24 v6, 81920, v6
    v_add3_u32 v211, s72, v3, v6
    v_lshlrev_b32 v3, 3, v2
    v_sub_u32 v3, v3, v1
    v_mov_b32 v4, 0x3f80
    v_mov_b32 v5, 0x3f800000
    v_cmp_eq_u32 vcc, 9, v3
    s_nop 1
    v_cndmask_b32 v204, 0, v4, vcc
    v_cmp_eq_u32 vcc, 10, v3
    s_nop 1
    v_cndmask_b32 v204, v204, v5, vcc
    v_cmp_eq_u32 vcc, 11, v3
    s_nop 1
    v_cndmask_b32 v205, 0, v4, vcc
    v_cmp_eq_u32 vcc, 12, v3
    s_nop 1
    v_cndmask_b32 v205, v205, v5, vcc
    v_cmp_eq_u32 vcc, 13, v3
    s_nop 1
    v_cndmask_b32 v206, 0, v4, vcc
    v_cmp_eq_u32 vcc, 14, v3
    s_nop 1
    v_cndmask_b32 v206, v206, v5, vcc
    v_cmp_eq_u32 vcc, 15, v3
    s_nop 1
    v_cndmask_b32 v207, 0, v4, vcc
    v_cmp_eq_u32 vcc, 16, v3
    s_nop 1
    v_cndmask_b32_e64 v207, v207, v5, vcc
    v_mov_b32 v118, 0x3f80
    v_mov_b32 v64, 0
    v_mov_b32 v65, 0
    v_lshl_add_u32 v3, v0, 3, s70
    v_and_b32_e64 v4, 3, v0
    v_lshl_add_u32 v4, v4, 3, s71
    ds_write_b64 v3, v[64:65]
    s_mov_b64 exec, 15
    ds_write_b64 v4, v[64:65]
    s_mov_b64 exec, -1
    s_waitcnt vmcnt(10)
    v_mul_f32 v52, 0x3fb8aa3b, v52
    v_exp_f32 v52, v52
    s_nop 0
    v_cvt_pk_bf16_f32 v52, v52, v52
    v_and_b32 v52, s83, v52
    v_mul_f32 v55, 0xbfb8aa3b, v52
    v_mul_f32 v57, 0x3e22f983, v52
    v_add_f32 v56, v52, v52
    v_mul_f32 v64, 0x3fb8aa3b, v40
    v_exp_f32 v64, v64
    v_mul_f32 v65, v41, v57
    v_cvt_pk_bf16_f32 v64, v64, v64
    v_fract_f32 v66, v65
    v_and_b32 v64, s83, v64
    v_cos_f32 v58, v66
    v_mul_f32 v64, v64, v55
    v_sin_f32_e64 v59, v66
    v_mul_f32 v67, 0x41000000, v65
    v_exp_f32 v68, v64
    v_fract_f32 v67, v67
    v_mul_f32 v70, 0x41000000, v64
    v_cos_f32_e64 v60, v67
    v_pk_mul_f32 v[58:59], v[58:59], v[68:69] op_sel:[0,0] op_sel_hi:[1,0]
    v_sin_f32 v61, -v67
    v_pk_mul_f32 v[76:77], v[42:43], v[56:57] op_sel:[0,0] op_sel_hi:[1,0]
    v_exp_f32_e64 v70, v70
    v_cvt_pk_bf16_f32 v212, v76, v77
    v_pk_mul_f32 v[60:61], v[60:61], v[70:71] op_sel:[0,0] op_sel_hi:[1,0]
    v_mul_f32 v65, 0x43800000, v65
    v_mul_f32 v64, 0x43800000, v64
    v_fract_f32 v65, v65
    v_exp_f32 v64, v64
    v_cos_f32 v62, v65
    v_sin_f32 v63, -v65
    s_nop 0
    v_pk_mul_f32 v[62:63], v[62:63], v[64:65] op_sel:[0,0] op_sel_hi:[1,0]
    v_cvt_pk_bf16_f32 v109, v60, v61
    v_pk_mul_f32 v[78:79], v[76:77], v[58:59] op_sel:[0,0] op_sel_hi:[1,0]
    v_pk_mul_f32 v[72:73], v[60:61], v[60:61] op_sel:[0,0] op_sel_hi:[1,0]
    v_pk_fma_f32 v[78:79], v[76:77], v[58:59], v[78:79] op_sel:[1,1,0] op_sel_hi:[0,1,1] neg_lo:[1,0,0]
    v_pk_fma_f32 v[72:73], v[60:61], v[60:61], v[72:73] op_sel:[1,1,0] op_sel_hi:[0,1,1] neg_lo:[1,0,0]
    v_cvt_pk_bf16_f32 v110, v72, v73
    v_cvt_pk_bf16_f32 v213, v78, v79
    v_pk_mul_f32 v[74:75], v[72:73], v[60:61] op_sel:[0,0] op_sel_hi:[1,0]
    v_pk_mul_f32 v[80:81], v[78:79], v[58:59] op_sel:[0,0] op_sel_hi:[1,0]
    v_pk_fma_f32 v[74:75], v[72:73], v[60:61], v[74:75] op_sel:[1,1,0] op_sel_hi:[0,1,1] neg_lo:[1,0,0]
    v_cvt_pk_bf16_f32 v111, v74, v75
    v_pk_fma_f32 v[80:81], v[78:79], v[58:59], v[80:81] op_sel:[1,1,0] op_sel_hi:[0,1,1] neg_lo:[1,0,0]
    v_pk_mul_f32 v[72:73], v[74:75], v[60:61] op_sel:[0,0] op_sel_hi:[1,0]
    v_cvt_pk_bf16_f32 v214, v80, v81
    v_pk_fma_f32 v[72:73], v[74:75], v[60:61], v[72:73] op_sel:[1,1,0] op_sel_hi:[0,1,1] neg_lo:[1,0,0]
    v_cvt_pk_bf16_f32 v112, v72, v73
    v_pk_mul_f32 v[82:83], v[80:81], v[58:59] op_sel:[0,0] op_sel_hi:[1,0]
    v_pk_mul_f32 v[74:75], v[72:73], v[60:61] op_sel:[0,0] op_sel_hi:[1,0]
    v_pk_fma_f32 v[82:83], v[80:81], v[58:59], v[82:83] op_sel:[1,1,0] op_sel_hi:[0,1,1] neg_lo:[1,0,0]
    v_pk_fma_f32 v[74:75], v[72:73], v[60:61], v[74:75] op_sel:[1,1,0] op_sel_hi:[0,1,1] neg_lo:[1,0,0]
    v_cvt_pk_bf16_f32 v113, v74, v75
    v_cvt_pk_bf16_f32 v215, v82, v83
    v_pk_mul_f32 v[72:73], v[74:75], v[60:61] op_sel:[0,0] op_sel_hi:[1,0]
    v_pk_mul_f32 v[84:85], v[82:83], v[58:59] op_sel:[0,0] op_sel_hi:[1,0]
    v_pk_fma_f32 v[72:73], v[74:75], v[60:61], v[72:73] op_sel:[1,1,0] op_sel_hi:[0,1,1] neg_lo:[1,0,0]
    v_cvt_pk_bf16_f32 v114, v72, v73
    v_pk_fma_f32 v[84:85], v[82:83], v[58:59], v[84:85] op_sel:[1,1,0] op_sel_hi:[0,1,1] neg_lo:[1,0,0]
    v_pk_mul_f32 v[74:75], v[72:73], v[60:61] op_sel:[0,0] op_sel_hi:[1,0]
    v_cvt_pk_bf16_f32 v216, v84, v85
    v_pk_fma_f32 v[74:75], v[72:73], v[60:61], v[74:75] op_sel:[1,1,0] op_sel_hi:[0,1,1] neg_lo:[1,0,0]
    v_cvt_pk_bf16_f32 v115, v74, v75
    v_pk_mul_f32 v[86:87], v[84:85], v[58:59] op_sel:[0,0] op_sel_hi:[1,0]
    ds_write2st64_b32 v16, v118, v112 offset0:0 offset1:4
    ds_write2st64_b32 v17, v109, v113 offset0:1 offset1:5
    ds_write2st64_b32 v18, v110, v114 offset0:2 offset1:6
    ds_write2st64_b32 v19, v111, v115 offset0:3 offset1:7
    v_pk_fma_f32 v[86:87], v[84:85], v[58:59], v[86:87] op_sel:[1,1,0] op_sel_hi:[0,1,1] neg_lo:[1,0,0]
    v_pk_mul_f32 v[72:73], v[74:75], v[60:61] op_sel:[0,0] op_sel_hi:[1,0]
    v_pk_fma_f32 v[72:73], v[74:75], v[60:61], v[72:73] op_sel:[1,1,0] op_sel_hi:[0,1,1] neg_lo:[1,0,0]
    v_cvt_pk_bf16_f32 v217, v86, v87
    v_cvt_pk_bf16_f32 v108, v72, v73
    v_pk_mul_f32 v[88:89], v[86:87], v[58:59] op_sel:[0,0] op_sel_hi:[1,0]
    v_pk_mul_f32 v[74:75], v[72:73], v[60:61] op_sel:[0,0] op_sel_hi:[1,0]
    v_pk_fma_f32 v[74:75], v[72:73], v[60:61], v[74:75] op_sel:[1,1,0] op_sel_hi:[0,1,1] neg_lo:[1,0,0]
    v_pk_fma_f32 v[88:89], v[86:87], v[58:59], v[88:89] op_sel:[1,1,0] op_sel_hi:[0,1,1] neg_lo:[1,0,0]
    v_cvt_pk_bf16_f32 v109, v74, v75
    v_cvt_pk_bf16_f32 v218, v88, v89
    v_pk_mul_f32 v[72:73], v[74:75], v[60:61] op_sel:[0,0] op_sel_hi:[1,0]
    v_pk_fma_f32 v[72:73], v[74:75], v[60:61], v[72:73] op_sel:[1,1,0] op_sel_hi:[0,1,1] neg_lo:[1,0,0]
    v_pk_mul_f32 v[90:91], v[88:89], v[58:59] op_sel:[0,0] op_sel_hi:[1,0]
    v_cvt_pk_bf16_f32 v110, v72, v73
    v_pk_fma_f32 v[90:91], v[88:89], v[58:59], v[90:91] op_sel:[1,1,0] op_sel_hi:[0,1,1] neg_lo:[1,0,0]
    v_pk_mul_f32 v[74:75], v[72:73], v[60:61] op_sel:[0,0] op_sel_hi:[1,0]
    v_pk_fma_f32 v[74:75], v[72:73], v[60:61], v[74:75] op_sel:[1,1,0] op_sel_hi:[0,1,1] neg_lo:[1,0,0]
    v_cvt_pk_bf16_f32 v219, v90, v91
    v_cvt_pk_bf16_f32 v111, v74, v75
    ds_write2st64_b32 v16, v212, v216 offset0:32 offset1:36
    ds_write2st64_b32 v17, v213, v217 offset0:33 offset1:37
    ds_write2st64_b32 v18, v214, v218 offset0:34 offset1:38
    ds_write2st64_b32 v19, v215, v219 offset0:35 offset1:39
    v_pk_mul_f32 v[72:73], v[74:75], v[60:61] op_sel:[0,0] op_sel_hi:[1,0]
    v_pk_fma_f32 v[72:73], v[74:75], v[60:61], v[72:73] op_sel:[1,1,0] op_sel_hi:[0,1,1] neg_lo:[1,0,0]
    v_pk_mul_f32 v[92:93], v[76:77], v[62:63] op_sel:[0,0] op_sel_hi:[1,0]
    v_cvt_pk_bf16_f32 v112, v72, v73
    v_pk_fma_f32 v[92:93], v[76:77], v[62:63], v[92:93] op_sel:[1,1,0] op_sel_hi:[0,1,1] neg_hi:[1,0,0]
    v_pk_mul_f32 v[74:75], v[72:73], v[60:61] op_sel:[0,0] op_sel_hi:[1,0]
    v_pk_fma_f32 v[74:75], v[72:73], v[60:61], v[74:75] op_sel:[1,1,0] op_sel_hi:[0,1,1] neg_lo:[1,0,0]
    v_cvt_pk_bf16_f32 v212, v92, v93
    v_cvt_pk_bf16_f32 v113, v74, v75
    v_pk_mul_f32 v[94:95], v[80:81], v[62:63] op_sel:[0,0] op_sel_hi:[1,0]
    v_pk_mul_f32 v[72:73], v[74:75], v[60:61] op_sel:[0,0] op_sel_hi:[1,0]
    v_pk_fma_f32 v[72:73], v[74:75], v[60:61], v[72:73] op_sel:[1,1,0] op_sel_hi:[0,1,1] neg_lo:[1,0,0]
    v_pk_fma_f32 v[94:95], v[80:81], v[62:63], v[94:95] op_sel:[1,1,0] op_sel_hi:[0,1,1] neg_hi:[1,0,0]
    v_cvt_pk_bf16_f32 v114, v72, v73
    v_cvt_pk_bf16_f32 v213, v94, v95
    v_pk_mul_f32 v[74:75], v[72:73], v[60:61] op_sel:[0,0] op_sel_hi:[1,0]
    v_pk_fma_f32 v[74:75], v[72:73], v[60:61], v[74:75] op_sel:[1,1,0] op_sel_hi:[0,1,1] neg_lo:[1,0,0]
    v_pk_mul_f32 v[96:97], v[84:85], v[62:63] op_sel:[0,0] op_sel_hi:[1,0]
    v_cvt_pk_bf16_f32 v115, v74, v75
    v_pk_fma_f32 v[96:97], v[84:85], v[62:63], v[96:97] op_sel:[1,1,0] op_sel_hi:[0,1,1] neg_hi:[1,0,0]
    ds_write2st64_b32 v20, v108, v112 offset0:8 offset1:12
    ds_write2st64_b32 v21, v109, v113 offset0:9 offset1:13
    ds_write2st64_b32 v22, v110, v114 offset0:10 offset1:14
    ds_write2st64_b32 v23, v111, v115 offset0:11 offset1:15
    v_pk_mul_f32 v[72:73], v[74:75], v[60:61] op_sel:[0,0] op_sel_hi:[1,0]
    v_cvt_pk_bf16_f32 v214, v96, v97
    v_pk_fma_f32 v[72:73], v[74:75], v[60:61], v[72:73] op_sel:[1,1,0] op_sel_hi:[0,1,1] neg_lo:[1,0,0]
    v_pk_mul_f32 v[98:99], v[88:89], v[62:63] op_sel:[0,0] op_sel_hi:[1,0]
    v_cvt_pk_bf16_f32 v108, v72, v73
    v_pk_mul_f32 v[74:75], v[72:73], v[60:61] op_sel:[0,0] op_sel_hi:[1,0]
    v_pk_fma_f32 v[98:99], v[88:89], v[62:63], v[98:99] op_sel:[1,1,0] op_sel_hi:[0,1,1] neg_hi:[1,0,0]
    v_pk_fma_f32 v[74:75], v[72:73], v[60:61], v[74:75] op_sel:[1,1,0] op_sel_hi:[0,1,1] neg_lo:[1,0,0]
    v_cvt_pk_bf16_f32 v215, v98, v99
    v_cvt_pk_bf16_f32 v109, v74, v75
    v_pk_mul_f32 v[72:73], v[74:75], v[60:61] op_sel:[0,0] op_sel_hi:[1,0]
    v_pk_mul_f32 v[100:101], v[92:93], v[62:63] op_sel:[0,0] op_sel_hi:[1,0]
    v_pk_fma_f32 v[72:73], v[74:75], v[60:61], v[72:73] op_sel:[1,1,0] op_sel_hi:[0,1,1] neg_lo:[1,0,0]
    v_pk_fma_f32 v[100:101], v[92:93], v[62:63], v[100:101] op_sel:[1,1,0] op_sel_hi:[0,1,1] neg_hi:[1,0,0]
    v_cvt_pk_bf16_f32 v110, v72, v73
    v_pk_mul_f32 v[74:75], v[72:73], v[60:61] op_sel:[0,0] op_sel_hi:[1,0]
    v_cvt_pk_bf16_f32 v216, v100, v101
    v_pk_fma_f32 v[74:75], v[72:73], v[60:61], v[74:75] op_sel:[1,1,0] op_sel_hi:[0,1,1] neg_lo:[1,0,0]
    v_pk_mul_f32 v[102:103], v[96:97], v[62:63] op_sel:[0,0] op_sel_hi:[1,0]
    v_cvt_pk_bf16_f32 v111, v74, v75
    v_pk_mul_f32 v[72:73], v[74:75], v[60:61] op_sel:[0,0] op_sel_hi:[1,0]
    v_pk_fma_f32 v[102:103], v[96:97], v[62:63], v[102:103] op_sel:[1,1,0] op_sel_hi:[0,1,1] neg_hi:[1,0,0]
    v_pk_fma_f32 v[72:73], v[74:75], v[60:61], v[72:73] op_sel:[1,1,0] op_sel_hi:[0,1,1] neg_lo:[1,0,0]
    v_cvt_pk_bf16_f32 v217, v102, v103
    v_cvt_pk_bf16_f32 v112, v72, v73
    v_pk_mul_f32 v[74:75], v[72:73], v[60:61] op_sel:[0,0] op_sel_hi:[1,0]
    v_pk_mul_f32 v[104:105], v[100:101], v[62:63] op_sel:[0,0] op_sel_hi:[1,0]
    v_pk_fma_f32 v[74:75], v[72:73], v[60:61], v[74:75] op_sel:[1,1,0] op_sel_hi:[0,1,1] neg_lo:[1,0,0]
    v_pk_fma_f32 v[104:105], v[100:101], v[62:63], v[104:105] op_sel:[1,1,0] op_sel_hi:[0,1,1] neg_hi:[1,0,0]
    v_cvt_pk_bf16_f32 v113, v74, v75
    v_pk_mul_f32 v[72:73], v[74:75], v[60:61] op_sel:[0,0] op_sel_hi:[1,0]
    v_cvt_pk_bf16_f32 v218, v104, v105
    v_pk_fma_f32 v[72:73], v[74:75], v[60:61], v[72:73] op_sel:[1,1,0] op_sel_hi:[0,1,1] neg_lo:[1,0,0]
    v_pk_mul_f32 v[106:107], v[102:103], v[62:63] op_sel:[0,0] op_sel_hi:[1,0]
    v_cvt_pk_bf16_f32 v114, v72, v73
    v_pk_mul_f32 v[74:75], v[72:73], v[60:61] op_sel:[0,0] op_sel_hi:[1,0]
    v_pk_fma_f32 v[106:107], v[102:103], v[62:63], v[106:107] op_sel:[1,1,0] op_sel_hi:[0,1,1] neg_hi:[1,0,0]
    v_pk_fma_f32 v[74:75], v[72:73], v[60:61], v[74:75] op_sel:[1,1,0] op_sel_hi:[0,1,1] neg_lo:[1,0,0]
    v_cvt_pk_bf16_f32 v219, v106, v107
    v_cvt_pk_bf16_f32 v115, v74, v75
    ds_write2st64_b32 v24, v108, v112 offset0:16 offset1:20
    ds_write2st64_b32 v25, v109, v113 offset0:17 offset1:21
    ds_write2st64_b32 v26, v110, v114 offset0:18 offset1:22
    ds_write2st64_b32 v27, v111, v115 offset0:19 offset1:23
    ds_write2st64_b32 v20, v212, v216 offset0:40 offset1:44
    ds_write2st64_b32 v21, v213, v217 offset0:41 offset1:45
    ds_write2st64_b32 v22, v214, v218 offset0:42 offset1:46
    ds_write2st64_b32 v23, v215, v219 offset0:43 offset1:47
    v_pk_mul_f32 v[72:73], v[74:75], v[60:61] op_sel:[0,0] op_sel_hi:[1,0]
    v_pk_mul_f32 v[100:101], v[104:105], v[62:63] op_sel:[0,0] op_sel_hi:[1,0]
    v_pk_fma_f32 v[72:73], v[74:75], v[60:61], v[72:73] op_sel:[1,1,0] op_sel_hi:[0,1,1] neg_lo:[1,0,0]
    v_cvt_pk_bf16_f32 v108, v72, v73
    v_pk_fma_f32 v[100:101], v[104:105], v[62:63], v[100:101] op_sel:[1,1,0] op_sel_hi:[0,1,1] neg_hi:[1,0,0]
    v_pk_mul_f32 v[74:75], v[72:73], v[60:61] op_sel:[0,0] op_sel_hi:[1,0]
    v_cvt_pk_bf16_f32 v212, v100, v101
    v_pk_fma_f32 v[74:75], v[72:73], v[60:61], v[74:75] op_sel:[1,1,0] op_sel_hi:[0,1,1] neg_lo:[1,0,0]
    v_cvt_pk_bf16_f32 v109, v74, v75
    v_pk_mul_f32 v[102:103], v[100:101], v[62:63] op_sel:[0,0] op_sel_hi:[1,0]
    v_pk_mul_f32 v[72:73], v[74:75], v[60:61] op_sel:[0,0] op_sel_hi:[1,0]
    v_pk_fma_f32 v[102:103], v[100:101], v[62:63], v[102:103] op_sel:[1,1,0] op_sel_hi:[0,1,1] neg_hi:[1,0,0]
    v_pk_fma_f32 v[72:73], v[74:75], v[60:61], v[72:73] op_sel:[1,1,0] op_sel_hi:[0,1,1] neg_lo:[1,0,0]
    v_cvt_pk_bf16_f32 v110, v72, v73
    v_cvt_pk_bf16_f32 v213, v102, v103
    v_pk_mul_f32 v[74:75], v[72:73], v[60:61] op_sel:[0,0] op_sel_hi:[1,0]
    v_pk_mul_f32 v[100:101], v[102:103], v[62:63] op_sel:[0,0] op_sel_hi:[1,0]
    v_pk_fma_f32 v[74:75], v[72:73], v[60:61], v[74:75] op_sel:[1,1,0] op_sel_hi:[0,1,1] neg_lo:[1,0,0]
    v_cvt_pk_bf16_f32 v111, v74, v75
    v_pk_fma_f32 v[100:101], v[102:103], v[62:63], v[100:101] op_sel:[1,1,0] op_sel_hi:[0,1,1] neg_hi:[1,0,0]
    v_pk_mul_f32 v[72:73], v[74:75], v[60:61] op_sel:[0,0] op_sel_hi:[1,0]
    v_cvt_pk_bf16_f32 v214, v100, v101
    v_pk_fma_f32 v[72:73], v[74:75], v[60:61], v[72:73] op_sel:[1,1,0] op_sel_hi:[0,1,1] neg_lo:[1,0,0]
    v_cvt_pk_bf16_f32 v112, v72, v73
    v_pk_mul_f32 v[102:103], v[100:101], v[62:63] op_sel:[0,0] op_sel_hi:[1,0]
    v_pk_mul_f32 v[74:75], v[72:73], v[60:61] op_sel:[0,0] op_sel_hi:[1,0]
    v_pk_fma_f32 v[102:103], v[100:101], v[62:63], v[102:103] op_sel:[1,1,0] op_sel_hi:[0,1,1] neg_hi:[1,0,0]
    v_pk_fma_f32 v[74:75], v[72:73], v[60:61], v[74:75] op_sel:[1,1,0] op_sel_hi:[0,1,1] neg_lo:[1,0,0]
    v_cvt_pk_bf16_f32 v113, v74, v75
    v_cvt_pk_bf16_f32 v215, v102, v103
    v_pk_mul_f32 v[72:73], v[74:75], v[60:61] op_sel:[0,0] op_sel_hi:[1,0]
    v_pk_mul_f32 v[100:101], v[102:103], v[62:63] op_sel:[0,0] op_sel_hi:[1,0]
    v_pk_fma_f32 v[72:73], v[74:75], v[60:61], v[72:73] op_sel:[1,1,0] op_sel_hi:[0,1,1] neg_lo:[1,0,0]
    v_cvt_pk_bf16_f32 v114, v72, v73
    v_pk_fma_f32 v[100:101], v[102:103], v[62:63], v[100:101] op_sel:[1,1,0] op_sel_hi:[0,1,1] neg_hi:[1,0,0]
    v_pk_mul_f32 v[74:75], v[72:73], v[60:61] op_sel:[0,0] op_sel_hi:[1,0]
    v_cvt_pk_bf16_f32 v216, v100, v101
    v_pk_fma_f32 v[74:75], v[72:73], v[60:61], v[74:75] op_sel:[1,1,0] op_sel_hi:[0,1,1] neg_lo:[1,0,0]
    v_cvt_pk_bf16_f32 v115, v74, v75
    ds_write2st64_b32 v24, v212, v216 offset0:48 offset1:52
    ds_write_b32 v25, v213 offset:12544
    ds_write_b32 v26, v214 offset:12800
    ds_write_b32 v27, v215 offset:13056
    ds_write2st64_b32 v28, v108, v112 offset0:24 offset1:28
    ds_write2st64_b32 v29, v109, v113 offset0:25 offset1:29
    ds_write2st64_b32 v30, v110, v114 offset0:26 offset1:30
    ds_write2st64_b32 v31, v111, v115 offset0:27 offset1:31
    ds_read_b128 v[120:123], v32 offset:8192
    ds_read_b128 v[124:127], v32
    ds_read_b128 v[128:131], v33 offset:8192
    ds_read_b128 v[132:135], v33
    ds_read_b128 v[136:139], v34 offset:8192
    ds_read_b128 v[140:143], v34
    ds_read_b128 v[144:147], v35 offset:8192
    ds_read_b128 v[148:151], v35
    ds_read_b128 v[152:155], v36 offset:8192
    ds_read_b128 v[156:159], v36
    ds_read_b128 v[160:163], v37 offset:8192
    ds_read_b128 v[164:167], v37
    ds_read_b128 v[168:171], v38 offset:8192
    ds_read_b128 v[172:175], v38
    ds_read_b128 v[176:179], v39 offset:8192
    ds_read_b128 v[180:183], v39
    s_waitcnt vmcnt(6)
    v_mul_f32 v64, 0x3fb8aa3b, v44
    v_exp_f32 v64, v64
    v_mul_f32 v65, v45, v57
    v_cvt_pk_bf16_f32 v64, v64, v64
    v_fract_f32 v66, v65
    v_and_b32 v64, s83, v64
    s_waitcnt lgkmcnt(12)
    v_mfma_f32_32x32x16_bf16 v[184:199], v[120:123], v[124:127], 0
    v_cos_f32 v58, v66
    v_mul_f32 v64, v64, v55
    v_sin_f32 v59, v66
    v_mul_f32 v67, 0x41000000, v65
    v_exp_f32 v68, v64
    v_fract_f32 v67, v67
    v_mfma_f32_32x32x16_bf16 v[184:199], v[128:131], v[132:135], v[184:199]
    v_mul_f32 v70, 0x41000000, v64
    v_cos_f32 v60, v67
    v_pk_mul_f32 v[58:59], v[58:59], v[68:69] op_sel:[0,0] op_sel_hi:[1,0]
    v_sin_f32 v61, -v67
    v_pk_mul_f32 v[76:77], v[46:47], v[56:57] op_sel:[0,0] op_sel_hi:[1,0]
    v_exp_f32 v70, v70
    s_waitcnt lgkmcnt(8)
    v_mfma_f32_32x32x16_bf16 v[184:199], v[136:139], v[140:143], v[184:199]
    v_cvt_pk_bf16_f32 v212, v76, v77
    v_pk_mul_f32 v[60:61], v[60:61], v[70:71] op_sel:[0,0] op_sel_hi:[1,0]
    v_mul_f32 v65, 0x43800000, v65
    v_mul_f32 v64, 0x43800000, v64
    v_fract_f32 v65, v65
    v_exp_f32 v64, v64
    v_mfma_f32_32x32x16_bf16 v[184:199], v[144:147], v[148:151], v[184:199]
    v_cos_f32 v62, v65
    v_sin_f32 v63, -v65
    s_nop 0
    v_pk_mul_f32 v[62:63], v[62:63], v[64:65] op_sel:[0,0] op_sel_hi:[1,0]
    v_cvt_pk_bf16_f32 v109, v60, v61
    v_pk_mul_f32 v[78:79], v[76:77], v[58:59] op_sel:[0,0] op_sel_hi:[1,0]
    s_waitcnt lgkmcnt(0)
    v_mfma_f32_32x32x16_bf16 v[184:199], v[152:155], v[156:159], v[184:199]
    v_pk_mul_f32 v[72:73], v[60:61], v[60:61] op_sel:[0,0] op_sel_hi:[1,0]
    v_pk_fma_f32 v[78:79], v[76:77], v[58:59], v[78:79] op_sel:[1,1,0] op_sel_hi:[0,1,1] neg_lo:[1,0,0]
    v_pk_fma_f32 v[72:73], v[60:61], v[60:61], v[72:73] op_sel:[1,1,0] op_sel_hi:[0,1,1] neg_lo:[1,0,0]
    v_cvt_pk_bf16_f32 v110, v72, v73
    v_cvt_pk_bf16_f32 v213, v78, v79
    v_pk_mul_f32 v[74:75], v[72:73], v[60:61] op_sel:[0,0] op_sel_hi:[1,0]
    v_mfma_f32_32x32x16_bf16 v[184:199], v[160:163], v[164:167], v[184:199]
    v_pk_mul_f32 v[80:81], v[78:79], v[58:59] op_sel:[0,0] op_sel_hi:[1,0]
    v_pk_fma_f32 v[74:75], v[72:73], v[60:61], v[74:75] op_sel:[1,1,0] op_sel_hi:[0,1,1] neg_lo:[1,0,0]
    v_cvt_pk_bf16_f32 v111, v74, v75
    v_pk_fma_f32 v[80:81], v[78:79], v[58:59], v[80:81] op_sel:[1,1,0] op_sel_hi:[0,1,1] neg_lo:[1,0,0]
    v_pk_mul_f32 v[72:73], v[74:75], v[60:61] op_sel:[0,0] op_sel_hi:[1,0]
    v_cvt_pk_bf16_f32 v214, v80, v81
    v_mfma_f32_32x32x16_bf16 v[184:199], v[168:171], v[172:175], v[184:199]
    v_pk_fma_f32 v[72:73], v[74:75], v[60:61], v[72:73] op_sel:[1,1,0] op_sel_hi:[0,1,1] neg_lo:[1,0,0]
    v_cvt_pk_bf16_f32 v112, v72, v73
    v_pk_mul_f32 v[82:83], v[80:81], v[58:59] op_sel:[0,0] op_sel_hi:[1,0]
    v_pk_mul_f32 v[74:75], v[72:73], v[60:61] op_sel:[0,0] op_sel_hi:[1,0]
    v_pk_fma_f32 v[82:83], v[80:81], v[58:59], v[82:83] op_sel:[1,1,0] op_sel_hi:[0,1,1] neg_lo:[1,0,0]
    v_pk_fma_f32 v[74:75], v[72:73], v[60:61], v[74:75] op_sel:[1,1,0] op_sel_hi:[0,1,1] neg_lo:[1,0,0]
    v_mfma_f32_32x32x16_bf16 v[184:199], v[176:179], v[180:183], v[184:199]
    v_cvt_pk_bf16_f32 v113, v74, v75
    v_cvt_pk_bf16_f32 v215, v82, v83
    v_pk_mul_f32 v[72:73], v[74:75], v[60:61] op_sel:[0,0] op_sel_hi:[1,0]
    v_pk_mul_f32 v[84:85], v[82:83], v[58:59] op_sel:[0,0] op_sel_hi:[1,0]
    v_pk_fma_f32 v[72:73], v[74:75], v[60:61], v[72:73] op_sel:[1,1,0] op_sel_hi:[0,1,1] neg_lo:[1,0,0]
    v_cvt_pk_bf16_f32 v114, v72, v73
    s_nop 0
    v_pk_fma_f32 v[84:85], v[82:83], v[58:59], v[84:85] op_sel:[1,1,0] op_sel_hi:[0,1,1] neg_lo:[1,0,0]
    v_pk_mul_f32 v[74:75], v[72:73], v[60:61] op_sel:[0,0] op_sel_hi:[1,0]
    v_cvt_pk_bf16_f32 v216, v84, v85
    v_pk_fma_f32 v[74:75], v[72:73], v[60:61], v[74:75] op_sel:[1,1,0] op_sel_hi:[0,1,1] neg_lo:[1,0,0]
    v_cvt_pk_bf16_f32 v115, v74, v75
    v_pk_mul_f32 v[86:87], v[84:85], v[58:59] op_sel:[0,0] op_sel_hi:[1,0]
    ds_write2st64_b32 v16, v118, v112 offset0:0 offset1:4
    ds_write2st64_b32 v17, v109, v113 offset0:1 offset1:5
    ds_write2st64_b32 v18, v110, v114 offset0:2 offset1:6
    ds_write2st64_b32 v19, v111, v115 offset0:3 offset1:7
    v_pk_fma_f32 v[86:87], v[84:85], v[58:59], v[86:87] op_sel:[1,1,0] op_sel_hi:[0,1,1] neg_lo:[1,0,0]
    v_pk_mul_f32 v[72:73], v[74:75], v[60:61] op_sel:[0,0] op_sel_hi:[1,0]
    v_pk_fma_f32 v[72:73], v[74:75], v[60:61], v[72:73] op_sel:[1,1,0] op_sel_hi:[0,1,1] neg_lo:[1,0,0]
    v_cvt_pk_bf16_f32 v217, v86, v87
    v_cvt_pk_bf16_f32 v108, v72, v73
    v_pk_mul_f32 v[88:89], v[86:87], v[58:59] op_sel:[0,0] op_sel_hi:[1,0]
    v_pk_mul_f32 v[74:75], v[72:73], v[60:61] op_sel:[0,0] op_sel_hi:[1,0]
    v_pk_fma_f32 v[74:75], v[72:73], v[60:61], v[74:75] op_sel:[1,1,0] op_sel_hi:[0,1,1] neg_lo:[1,0,0]
    v_pk_fma_f32 v[88:89], v[86:87], v[58:59], v[88:89] op_sel:[1,1,0] op_sel_hi:[0,1,1] neg_lo:[1,0,0]
    v_cvt_pk_bf16_f32 v109, v74, v75
    v_cvt_pk_bf16_f32 v218, v88, v89
    v_pk_mul_f32 v[72:73], v[74:75], v[60:61] op_sel:[0,0] op_sel_hi:[1,0]
    v_pk_fma_f32 v[72:73], v[74:75], v[60:61], v[72:73] op_sel:[1,1,0] op_sel_hi:[0,1,1] neg_lo:[1,0,0]
    v_pk_mul_f32 v[90:91], v[88:89], v[58:59] op_sel:[0,0] op_sel_hi:[1,0]
    v_cvt_pk_bf16_f32 v110, v72, v73
    v_pk_fma_f32 v[90:91], v[88:89], v[58:59], v[90:91] op_sel:[1,1,0] op_sel_hi:[0,1,1] neg_lo:[1,0,0]
    v_pk_mul_f32 v[74:75], v[72:73], v[60:61] op_sel:[0,0] op_sel_hi:[1,0]
    v_pk_fma_f32 v[74:75], v[72:73], v[60:61], v[74:75] op_sel:[1,1,0] op_sel_hi:[0,1,1] neg_lo:[1,0,0]
    v_cvt_pk_bf16_f32 v219, v90, v91
    v_cvt_pk_bf16_f32 v111, v74, v75
    ds_write2st64_b32 v16, v212, v216 offset0:32 offset1:36
    ds_write2st64_b32 v17, v213, v217 offset0:33 offset1:37
    ds_write2st64_b32 v18, v214, v218 offset0:34 offset1:38
    ds_write2st64_b32 v19, v215, v219 offset0:35 offset1:39
    v_pk_mul_f32 v[72:73], v[74:75], v[60:61] op_sel:[0,0] op_sel_hi:[1,0]
    v_pk_fma_f32 v[72:73], v[74:75], v[60:61], v[72:73] op_sel:[1,1,0] op_sel_hi:[0,1,1] neg_lo:[1,0,0]
    v_pk_mul_f32 v[92:93], v[76:77], v[62:63] op_sel:[0,0] op_sel_hi:[1,0]
    v_cvt_pk_bf16_f32 v112, v72, v73
    v_pk_fma_f32 v[92:93], v[76:77], v[62:63], v[92:93] op_sel:[1,1,0] op_sel_hi:[0,1,1] neg_hi:[1,0,0]
    v_pk_mul_f32 v[74:75], v[72:73], v[60:61] op_sel:[0,0] op_sel_hi:[1,0]
    v_pk_fma_f32 v[74:75], v[72:73], v[60:61], v[74:75] op_sel:[1,1,0] op_sel_hi:[0,1,1] neg_lo:[1,0,0]
    v_cvt_pk_bf16_f32 v212, v92, v93
    v_cvt_pk_bf16_f32 v113, v74, v75
    v_pk_mul_f32 v[94:95], v[80:81], v[62:63] op_sel:[0,0] op_sel_hi:[1,0]
    v_pk_mul_f32 v[72:73], v[74:75], v[60:61] op_sel:[0,0] op_sel_hi:[1,0]
    v_pk_fma_f32 v[72:73], v[74:75], v[60:61], v[72:73] op_sel:[1,1,0] op_sel_hi:[0,1,1] neg_lo:[1,0,0]
    v_pk_fma_f32 v[94:95], v[80:81], v[62:63], v[94:95] op_sel:[1,1,0] op_sel_hi:[0,1,1] neg_hi:[1,0,0]
    v_cvt_pk_bf16_f32 v114, v72, v73
    v_cvt_pk_bf16_f32 v213, v94, v95
    v_pk_mul_f32 v[74:75], v[72:73], v[60:61] op_sel:[0,0] op_sel_hi:[1,0]
    v_pk_fma_f32 v[74:75], v[72:73], v[60:61], v[74:75] op_sel:[1,1,0] op_sel_hi:[0,1,1] neg_lo:[1,0,0]
    v_pk_mul_f32 v[96:97], v[84:85], v[62:63] op_sel:[0,0] op_sel_hi:[1,0]
    v_cvt_pk_bf16_f32 v115, v74, v75
    v_pk_fma_f32 v[96:97], v[84:85], v[62:63], v[96:97] op_sel:[1,1,0] op_sel_hi:[0,1,1] neg_hi:[1,0,0]
    ds_write2st64_b32 v20, v108, v112 offset0:8 offset1:12
    ds_write2st64_b32 v21, v109, v113 offset0:9 offset1:13
    ds_write2st64_b32 v22, v110, v114 offset0:10 offset1:14
    ds_write2st64_b32 v23, v111, v115 offset0:11 offset1:15
    v_pk_mul_f32 v[72:73], v[74:75], v[60:61] op_sel:[0,0] op_sel_hi:[1,0]
    v_cvt_pk_bf16_f32 v214, v96, v97
    v_pk_fma_f32 v[72:73], v[74:75], v[60:61], v[72:73] op_sel:[1,1,0] op_sel_hi:[0,1,1] neg_lo:[1,0,0]
    v_pk_mul_f32 v[98:99], v[88:89], v[62:63] op_sel:[0,0] op_sel_hi:[1,0]
    v_cvt_pk_bf16_f32 v108, v72, v73
    v_pk_mul_f32 v[74:75], v[72:73], v[60:61] op_sel:[0,0] op_sel_hi:[1,0]
    v_pk_fma_f32 v[98:99], v[88:89], v[62:63], v[98:99] op_sel:[1,1,0] op_sel_hi:[0,1,1] neg_hi:[1,0,0]
    v_pk_fma_f32 v[74:75], v[72:73], v[60:61], v[74:75] op_sel:[1,1,0] op_sel_hi:[0,1,1] neg_lo:[1,0,0]
    v_cvt_pk_bf16_f32 v215, v98, v99
    v_cvt_pk_bf16_f32 v109, v74, v75
    v_pk_mul_f32 v[72:73], v[74:75], v[60:61] op_sel:[0,0] op_sel_hi:[1,0]
    v_pk_mul_f32 v[100:101], v[92:93], v[62:63] op_sel:[0,0] op_sel_hi:[1,0]
    v_pk_fma_f32 v[72:73], v[74:75], v[60:61], v[72:73] op_sel:[1,1,0] op_sel_hi:[0,1,1] neg_lo:[1,0,0]
    v_pk_fma_f32 v[100:101], v[92:93], v[62:63], v[100:101] op_sel:[1,1,0] op_sel_hi:[0,1,1] neg_hi:[1,0,0]
    v_cvt_pk_bf16_f32 v110, v72, v73
    v_pk_mul_f32 v[74:75], v[72:73], v[60:61] op_sel:[0,0] op_sel_hi:[1,0]
    v_cvt_pk_bf16_f32 v216, v100, v101
    v_pk_fma_f32 v[74:75], v[72:73], v[60:61], v[74:75] op_sel:[1,1,0] op_sel_hi:[0,1,1] neg_lo:[1,0,0]
    v_pk_mul_f32 v[102:103], v[96:97], v[62:63] op_sel:[0,0] op_sel_hi:[1,0]
    v_cvt_pk_bf16_f32 v111, v74, v75
    v_pk_mul_f32 v[72:73], v[74:75], v[60:61] op_sel:[0,0] op_sel_hi:[1,0]
    v_pk_fma_f32 v[102:103], v[96:97], v[62:63], v[102:103] op_sel:[1,1,0] op_sel_hi:[0,1,1] neg_hi:[1,0,0]
    v_pk_fma_f32 v[72:73], v[74:75], v[60:61], v[72:73] op_sel:[1,1,0] op_sel_hi:[0,1,1] neg_lo:[1,0,0]
    v_cvt_pk_bf16_f32 v217, v102, v103
    v_cvt_pk_bf16_f32 v112, v72, v73
    v_pk_mul_f32 v[74:75], v[72:73], v[60:61] op_sel:[0,0] op_sel_hi:[1,0]
    v_pk_mul_f32 v[104:105], v[100:101], v[62:63] op_sel:[0,0] op_sel_hi:[1,0]
    v_pk_fma_f32 v[74:75], v[72:73], v[60:61], v[74:75] op_sel:[1,1,0] op_sel_hi:[0,1,1] neg_lo:[1,0,0]
    v_pk_fma_f32 v[104:105], v[100:101], v[62:63], v[104:105] op_sel:[1,1,0] op_sel_hi:[0,1,1] neg_hi:[1,0,0]
    v_cvt_pk_bf16_f32 v113, v74, v75
    v_pk_mul_f32 v[72:73], v[74:75], v[60:61] op_sel:[0,0] op_sel_hi:[1,0]
    v_cvt_pk_bf16_f32 v218, v104, v105
    v_pk_fma_f32 v[72:73], v[74:75], v[60:61], v[72:73] op_sel:[1,1,0] op_sel_hi:[0,1,1] neg_lo:[1,0,0]
    v_pk_mul_f32 v[106:107], v[102:103], v[62:63] op_sel:[0,0] op_sel_hi:[1,0]
    v_cvt_pk_bf16_f32 v114, v72, v73
    v_pk_mul_f32 v[74:75], v[72:73], v[60:61] op_sel:[0,0] op_sel_hi:[1,0]
    v_pk_fma_f32 v[106:107], v[102:103], v[62:63], v[106:107] op_sel:[1,1,0] op_sel_hi:[0,1,1] neg_hi:[1,0,0]
    v_pk_fma_f32 v[74:75], v[72:73], v[60:61], v[74:75] op_sel:[1,1,0] op_sel_hi:[0,1,1] neg_lo:[1,0,0]
    v_cvt_pk_bf16_f32 v219, v106, v107
    v_cvt_pk_bf16_f32 v115, v74, v75
    ds_write2st64_b32 v24, v108, v112 offset0:16 offset1:20
    ds_write2st64_b32 v25, v109, v113 offset0:17 offset1:21
    ds_write2st64_b32 v26, v110, v114 offset0:18 offset1:22
    ds_write2st64_b32 v27, v111, v115 offset0:19 offset1:23
    ds_write2st64_b32 v20, v212, v216 offset0:40 offset1:44
    ds_write2st64_b32 v21, v213, v217 offset0:41 offset1:45
    ds_write2st64_b32 v22, v214, v218 offset0:42 offset1:46
    ds_write2st64_b32 v23, v215, v219 offset0:43 offset1:47
    v_pk_mul_f32 v[72:73], v[74:75], v[60:61] op_sel:[0,0] op_sel_hi:[1,0]
    v_pk_mul_f32 v[100:101], v[104:105], v[62:63] op_sel:[0,0] op_sel_hi:[1,0]
    v_pk_fma_f32 v[72:73], v[74:75], v[60:61], v[72:73] op_sel:[1,1,0] op_sel_hi:[0,1,1] neg_lo:[1,0,0]
    v_cvt_pk_bf16_f32 v108, v72, v73
    v_pk_fma_f32 v[100:101], v[104:105], v[62:63], v[100:101] op_sel:[1,1,0] op_sel_hi:[0,1,1] neg_hi:[1,0,0]
    v_pk_mul_f32 v[74:75], v[72:73], v[60:61] op_sel:[0,0] op_sel_hi:[1,0]
    v_cvt_pk_bf16_f32 v212, v100, v101
    v_pk_fma_f32 v[74:75], v[72:73], v[60:61], v[74:75] op_sel:[1,1,0] op_sel_hi:[0,1,1] neg_lo:[1,0,0]
    v_cvt_pk_bf16_f32 v109, v74, v75
    v_pk_mul_f32 v[102:103], v[100:101], v[62:63] op_sel:[0,0] op_sel_hi:[1,0]
    v_pk_mul_f32 v[72:73], v[74:75], v[60:61] op_sel:[0,0] op_sel_hi:[1,0]
    v_pk_fma_f32 v[102:103], v[100:101], v[62:63], v[102:103] op_sel:[1,1,0] op_sel_hi:[0,1,1] neg_hi:[1,0,0]
    v_pk_fma_f32 v[72:73], v[74:75], v[60:61], v[72:73] op_sel:[1,1,0] op_sel_hi:[0,1,1] neg_lo:[1,0,0]
    v_cvt_pk_bf16_f32 v110, v72, v73
    v_cvt_pk_bf16_f32 v213, v102, v103
    v_pk_mul_f32 v[74:75], v[72:73], v[60:61] op_sel:[0,0] op_sel_hi:[1,0]
    v_pk_mul_f32 v[100:101], v[102:103], v[62:63] op_sel:[0,0] op_sel_hi:[1,0]
    v_pk_fma_f32 v[74:75], v[72:73], v[60:61], v[74:75] op_sel:[1,1,0] op_sel_hi:[0,1,1] neg_lo:[1,0,0]
    v_cvt_pk_bf16_f32 v111, v74, v75
    v_pk_fma_f32 v[100:101], v[102:103], v[62:63], v[100:101] op_sel:[1,1,0] op_sel_hi:[0,1,1] neg_hi:[1,0,0]
    v_pk_mul_f32 v[72:73], v[74:75], v[60:61] op_sel:[0,0] op_sel_hi:[1,0]
    v_cvt_pk_bf16_f32 v214, v100, v101
    v_pk_fma_f32 v[72:73], v[74:75], v[60:61], v[72:73] op_sel:[1,1,0] op_sel_hi:[0,1,1] neg_lo:[1,0,0]
    v_cvt_pk_bf16_f32 v112, v72, v73
    v_pk_mul_f32 v[102:103], v[100:101], v[62:63] op_sel:[0,0] op_sel_hi:[1,0]
    v_pk_mul_f32 v[74:75], v[72:73], v[60:61] op_sel:[0,0] op_sel_hi:[1,0]
    v_pk_fma_f32 v[102:103], v[100:101], v[62:63], v[102:103] op_sel:[1,1,0] op_sel_hi:[0,1,1] neg_hi:[1,0,0]
    v_pk_fma_f32 v[74:75], v[72:73], v[60:61], v[74:75] op_sel:[1,1,0] op_sel_hi:[0,1,1] neg_lo:[1,0,0]
    v_cvt_pk_bf16_f32 v113, v74, v75
    v_cvt_pk_bf16_f32 v215, v102, v103
    v_pk_mul_f32 v[72:73], v[74:75], v[60:61] op_sel:[0,0] op_sel_hi:[1,0]
    v_pk_mul_f32 v[100:101], v[102:103], v[62:63] op_sel:[0,0] op_sel_hi:[1,0]
    v_pk_fma_f32 v[72:73], v[74:75], v[60:61], v[72:73] op_sel:[1,1,0] op_sel_hi:[0,1,1] neg_lo:[1,0,0]
    v_cvt_pk_bf16_f32 v114, v72, v73
    v_pk_fma_f32 v[100:101], v[102:103], v[62:63], v[100:101] op_sel:[1,1,0] op_sel_hi:[0,1,1] neg_hi:[1,0,0]
    v_pk_mul_f32 v[74:75], v[72:73], v[60:61] op_sel:[0,0] op_sel_hi:[1,0]
    v_cvt_pk_bf16_f32 v216, v100, v101
    v_pk_fma_f32 v[74:75], v[72:73], v[60:61], v[74:75] op_sel:[1,1,0] op_sel_hi:[0,1,1] neg_lo:[1,0,0]
    v_cvt_pk_bf16_f32 v115, v74, v75
    ds_write2st64_b32 v24, v212, v216 offset0:48 offset1:52
    ds_write_b32 v25, v213 offset:12544
    ds_write_b32 v26, v214 offset:12800
    ds_write_b32 v27, v215 offset:13056
    ds_write2st64_b32 v28, v108, v112 offset0:24 offset1:28
    ds_write2st64_b32 v29, v109, v113 offset0:25 offset1:29
    ds_write2st64_b32 v30, v110, v114 offset0:26 offset1:30
    ds_write2st64_b32 v31, v111, v115 offset0:27 offset1:31
    ds_read_b128 v[120:123], v32 offset:8192
    ds_read_b128 v[124:127], v32
    ds_read_b128 v[128:131], v33 offset:8192
    ds_read_b128 v[132:135], v33
    ds_read_b128 v[136:139], v34 offset:8192
    ds_read_b128 v[140:143], v34
    ds_read_b128 v[144:147], v35 offset:8192
    ds_read_b128 v[148:151], v35
    ds_read_b128 v[152:155], v36 offset:8192
    ds_read_b128 v[156:159], v36
    ds_read_b128 v[160:163], v37 offset:8192
    ds_read_b128 v[164:167], v37
    ds_read_b128 v[168:171], v38 offset:8192
    ds_read_b128 v[172:175], v38
    ds_read_b128 v[176:179], v39 offset:8192
    ds_read_b128 v[180:183], v39
    s_waitcnt vmcnt(2)
    v_mul_f32 v64, 0x3fb8aa3b, v48
    v_exp_f32 v64, v64
    v_mul_f32_e64 v65, v49, v57
    v_cvt_pk_bf16_f32 v64, v64, v64
    v_fract_f32 v66, v65
    v_and_b32 v64, s83, v64
    s_waitcnt lgkmcnt(12)
    v_mfma_f32_32x32x16_bf16 v[184:199], v[120:123], v[124:127], v[184:199]
    v_cos_f32 v58, v66
    v_mul_f32 v64, v64, v55
    v_sin_f32 v59, v66
    v_mul_f32 v67, 0x41000000, v65
    v_exp_f32 v68, v64
    v_fract_f32 v67, v67
    v_mfma_f32_32x32x16_bf16 v[184:199], v[128:131], v[132:135], v[184:199]
    v_mul_f32 v70, 0x41000000, v64
    v_cos_f32_e64 v60, v67
    v_pk_mul_f32 v[58:59], v[58:59], v[68:69] op_sel:[0,0] op_sel_hi:[1,0]
    v_sin_f32 v61, -v67
    v_pk_mul_f32 v[76:77], v[50:51], v[56:57] op_sel:[0,0] op_sel_hi:[1,0]
    v_exp_f32 v70, v70
    s_waitcnt lgkmcnt(8)
    v_mfma_f32_32x32x16_bf16 v[184:199], v[136:139], v[140:143], v[184:199]
    v_cvt_pk_bf16_f32 v212, v76, v77
    v_pk_mul_f32 v[60:61], v[60:61], v[70:71] op_sel:[0,0] op_sel_hi:[1,0]
    v_mul_f32 v65, 0x43800000, v65
    v_mul_f32 v64, 0x43800000, v64
    v_fract_f32 v65, v65
    v_exp_f32 v64, v64
    v_mfma_f32_32x32x16_bf16 v[184:199], v[144:147], v[148:151], v[184:199]
    v_cos_f32 v62, v65
    v_sin_f32 v63, -v65
    s_nop 0
    v_pk_mul_f32 v[62:63], v[62:63], v[64:65] op_sel:[0,0] op_sel_hi:[1,0]
    v_cvt_pk_bf16_f32 v109, v60, v61
    v_pk_mul_f32 v[78:79], v[76:77], v[58:59] op_sel:[0,0] op_sel_hi:[1,0]
    s_waitcnt lgkmcnt(0)
    v_mfma_f32_32x32x16_bf16 v[184:199], v[152:155], v[156:159], v[184:199]
    v_pk_mul_f32 v[72:73], v[60:61], v[60:61] op_sel:[0,0] op_sel_hi:[1,0]
    v_pk_fma_f32 v[78:79], v[76:77], v[58:59], v[78:79] op_sel:[1,1,0] op_sel_hi:[0,1,1] neg_lo:[1,0,0]
    v_pk_fma_f32 v[72:73], v[60:61], v[60:61], v[72:73] op_sel:[1,1,0] op_sel_hi:[0,1,1] neg_lo:[1,0,0]
    v_cvt_pk_bf16_f32 v110, v72, v73
    v_cvt_pk_bf16_f32 v213, v78, v79
    v_pk_mul_f32 v[74:75], v[72:73], v[60:61] op_sel:[0,0] op_sel_hi:[1,0]
    v_mfma_f32_32x32x16_bf16 v[184:199], v[160:163], v[164:167], v[184:199]
    v_pk_mul_f32 v[80:81], v[78:79], v[58:59] op_sel:[0,0] op_sel_hi:[1,0]
    v_pk_fma_f32 v[74:75], v[72:73], v[60:61], v[74:75] op_sel:[1,1,0] op_sel_hi:[0,1,1] neg_lo:[1,0,0]
    v_cvt_pk_bf16_f32 v111, v74, v75
    v_pk_fma_f32 v[80:81], v[78:79], v[58:59], v[80:81] op_sel:[1,1,0] op_sel_hi:[0,1,1] neg_lo:[1,0,0]
    v_pk_mul_f32 v[72:73], v[74:75], v[60:61] op_sel:[0,0] op_sel_hi:[1,0]
    v_cvt_pk_bf16_f32 v214, v80, v81
    v_mfma_f32_32x32x16_bf16 v[184:199], v[168:171], v[172:175], v[184:199]
    v_pk_fma_f32 v[72:73], v[74:75], v[60:61], v[72:73] op_sel:[1,1,0] op_sel_hi:[0,1,1] neg_lo:[1,0,0]
    v_cvt_pk_bf16_f32 v112, v72, v73
    v_pk_mul_f32 v[82:83], v[80:81], v[58:59] op_sel:[0,0] op_sel_hi:[1,0]
    v_pk_mul_f32 v[74:75], v[72:73], v[60:61] op_sel:[0,0] op_sel_hi:[1,0]
    v_pk_fma_f32 v[82:83], v[80:81], v[58:59], v[82:83] op_sel:[1,1,0] op_sel_hi:[0,1,1] neg_lo:[1,0,0]
    v_pk_fma_f32 v[74:75], v[72:73], v[60:61], v[74:75] op_sel:[1,1,0] op_sel_hi:[0,1,1] neg_lo:[1,0,0]
    v_mfma_f32_32x32x16_bf16 v[184:199], v[176:179], v[180:183], v[184:199]
    v_cvt_pk_bf16_f32 v113, v74, v75
    v_cvt_pk_bf16_f32 v215, v82, v83
    v_pk_mul_f32 v[72:73], v[74:75], v[60:61] op_sel:[0,0] op_sel_hi:[1,0]
    v_pk_mul_f32 v[84:85], v[82:83], v[58:59] op_sel:[0,0] op_sel_hi:[1,0]
    v_pk_fma_f32 v[72:73], v[74:75], v[60:61], v[72:73] op_sel:[1,1,0] op_sel_hi:[0,1,1] neg_lo:[1,0,0]
    v_cvt_pk_bf16_f32 v114, v72, v73
    v_pk_fma_f32 v[84:85], v[82:83], v[58:59], v[84:85] op_sel:[1,1,0] op_sel_hi:[0,1,1] neg_lo:[1,0,0]
    s_nop 0
    v_pk_mul_f32 v[74:75], v[72:73], v[60:61] op_sel:[0,0] op_sel_hi:[1,0]
    v_cvt_pk_bf16_f32 v216, v84, v85
    v_pk_fma_f32 v[74:75], v[72:73], v[60:61], v[74:75] op_sel:[1,1,0] op_sel_hi:[0,1,1] neg_lo:[1,0,0]
    v_cvt_pk_bf16_f32 v115, v74, v75
    v_pk_mul_f32 v[86:87], v[84:85], v[58:59] op_sel:[0,0] op_sel_hi:[1,0]
    ds_write2st64_b32 v16, v118, v112 offset0:0 offset1:4
    ds_write2st64_b32 v17, v109, v113 offset0:1 offset1:5
    ds_write2st64_b32 v18, v110, v114 offset0:2 offset1:6
    ds_write2st64_b32 v19, v111, v115 offset0:3 offset1:7
    v_pk_fma_f32 v[86:87], v[84:85], v[58:59], v[86:87] op_sel:[1,1,0] op_sel_hi:[0,1,1] neg_lo:[1,0,0]
    v_pk_mul_f32 v[72:73], v[74:75], v[60:61] op_sel:[0,0] op_sel_hi:[1,0]
    v_pk_fma_f32 v[72:73], v[74:75], v[60:61], v[72:73] op_sel:[1,1,0] op_sel_hi:[0,1,1] neg_lo:[1,0,0]
    v_cvt_pk_bf16_f32 v217, v86, v87
    v_cvt_pk_bf16_f32 v108, v72, v73
    v_pk_mul_f32 v[88:89], v[86:87], v[58:59] op_sel:[0,0] op_sel_hi:[1,0]
    v_pk_mul_f32 v[74:75], v[72:73], v[60:61] op_sel:[0,0] op_sel_hi:[1,0]
    v_pk_fma_f32 v[74:75], v[72:73], v[60:61], v[74:75] op_sel:[1,1,0] op_sel_hi:[0,1,1] neg_lo:[1,0,0]
    v_pk_fma_f32 v[88:89], v[86:87], v[58:59], v[88:89] op_sel:[1,1,0] op_sel_hi:[0,1,1] neg_lo:[1,0,0]
    v_cvt_pk_bf16_f32 v109, v74, v75
    v_cvt_pk_bf16_f32 v218, v88, v89
    v_pk_mul_f32 v[72:73], v[74:75], v[60:61] op_sel:[0,0] op_sel_hi:[1,0]
    v_pk_fma_f32 v[72:73], v[74:75], v[60:61], v[72:73] op_sel:[1,1,0] op_sel_hi:[0,1,1] neg_lo:[1,0,0]
    v_pk_mul_f32 v[90:91], v[88:89], v[58:59] op_sel:[0,0] op_sel_hi:[1,0]
    v_cvt_pk_bf16_f32 v110, v72, v73
    v_pk_fma_f32 v[90:91], v[88:89], v[58:59], v[90:91] op_sel:[1,1,0] op_sel_hi:[0,1,1] neg_lo:[1,0,0]
    v_pk_mul_f32 v[74:75], v[72:73], v[60:61] op_sel:[0,0] op_sel_hi:[1,0]
    v_pk_fma_f32 v[74:75], v[72:73], v[60:61], v[74:75] op_sel:[1,1,0] op_sel_hi:[0,1,1] neg_lo:[1,0,0]
    v_cvt_pk_bf16_f32 v219, v90, v91
    v_cvt_pk_bf16_f32 v111, v74, v75
    ds_write2st64_b32 v16, v212, v216 offset0:32 offset1:36
    ds_write2st64_b32 v17, v213, v217 offset0:33 offset1:37
    ds_write2st64_b32 v18, v214, v218 offset0:34 offset1:38
    ds_write2st64_b32 v19, v215, v219 offset0:35 offset1:39
    v_pk_mul_f32 v[72:73], v[74:75], v[60:61] op_sel:[0,0] op_sel_hi:[1,0]
    v_pk_fma_f32 v[72:73], v[74:75], v[60:61], v[72:73] op_sel:[1,1,0] op_sel_hi:[0,1,1] neg_lo:[1,0,0]
    v_pk_mul_f32 v[92:93], v[76:77], v[62:63] op_sel:[0,0] op_sel_hi:[1,0]
    v_cvt_pk_bf16_f32 v112, v72, v73
    v_pk_fma_f32 v[92:93], v[76:77], v[62:63], v[92:93] op_sel:[1,1,0] op_sel_hi:[0,1,1] neg_hi:[1,0,0]
    v_pk_mul_f32 v[74:75], v[72:73], v[60:61] op_sel:[0,0] op_sel_hi:[1,0]
    v_pk_fma_f32 v[74:75], v[72:73], v[60:61], v[74:75] op_sel:[1,1,0] op_sel_hi:[0,1,1] neg_lo:[1,0,0]
    v_cvt_pk_bf16_f32 v212, v92, v93
    v_cvt_pk_bf16_f32 v113, v74, v75
    v_pk_mul_f32 v[94:95], v[80:81], v[62:63] op_sel:[0,0] op_sel_hi:[1,0]
    v_pk_mul_f32 v[72:73], v[74:75], v[60:61] op_sel:[0,0] op_sel_hi:[1,0]
    v_pk_fma_f32 v[72:73], v[74:75], v[60:61], v[72:73] op_sel:[1,1,0] op_sel_hi:[0,1,1] neg_lo:[1,0,0]
    v_pk_fma_f32 v[94:95], v[80:81], v[62:63], v[94:95] op_sel:[1,1,0] op_sel_hi:[0,1,1] neg_hi:[1,0,0]
    v_cvt_pk_bf16_f32 v114, v72, v73
    v_cvt_pk_bf16_f32 v213, v94, v95
    v_pk_mul_f32 v[74:75], v[72:73], v[60:61] op_sel:[0,0] op_sel_hi:[1,0]
    v_pk_fma_f32 v[74:75], v[72:73], v[60:61], v[74:75] op_sel:[1,1,0] op_sel_hi:[0,1,1] neg_lo:[1,0,0]
    v_pk_mul_f32 v[96:97], v[84:85], v[62:63] op_sel:[0,0] op_sel_hi:[1,0]
    v_cvt_pk_bf16_f32 v115, v74, v75
    v_pk_fma_f32 v[96:97], v[84:85], v[62:63], v[96:97] op_sel:[1,1,0] op_sel_hi:[0,1,1] neg_hi:[1,0,0]
    ds_write2st64_b32 v20, v108, v112 offset0:8 offset1:12
    ds_write2st64_b32 v21, v109, v113 offset0:9 offset1:13
    ds_write2st64_b32 v22, v110, v114 offset0:10 offset1:14
    ds_write2st64_b32 v23, v111, v115 offset0:11 offset1:15
    v_pk_mul_f32 v[72:73], v[74:75], v[60:61] op_sel:[0,0] op_sel_hi:[1,0]
    v_cvt_pk_bf16_f32 v214, v96, v97
    v_pk_fma_f32 v[72:73], v[74:75], v[60:61], v[72:73] op_sel:[1,1,0] op_sel_hi:[0,1,1] neg_lo:[1,0,0]
    v_pk_mul_f32 v[98:99], v[88:89], v[62:63] op_sel:[0,0] op_sel_hi:[1,0]
    v_cvt_pk_bf16_f32 v108, v72, v73
    v_pk_mul_f32 v[74:75], v[72:73], v[60:61] op_sel:[0,0] op_sel_hi:[1,0]
    v_pk_fma_f32 v[98:99], v[88:89], v[62:63], v[98:99] op_sel:[1,1,0] op_sel_hi:[0,1,1] neg_hi:[1,0,0]
    v_pk_fma_f32 v[74:75], v[72:73], v[60:61], v[74:75] op_sel:[1,1,0] op_sel_hi:[0,1,1] neg_lo:[1,0,0]
    v_cvt_pk_bf16_f32 v215, v98, v99
    v_cvt_pk_bf16_f32 v109, v74, v75
    v_pk_mul_f32 v[72:73], v[74:75], v[60:61] op_sel:[0,0] op_sel_hi:[1,0]
    v_pk_mul_f32 v[100:101], v[92:93], v[62:63] op_sel:[0,0] op_sel_hi:[1,0]
    v_pk_fma_f32 v[72:73], v[74:75], v[60:61], v[72:73] op_sel:[1,1,0] op_sel_hi:[0,1,1] neg_lo:[1,0,0]
    v_pk_fma_f32 v[100:101], v[92:93], v[62:63], v[100:101] op_sel:[1,1,0] op_sel_hi:[0,1,1] neg_hi:[1,0,0]
    v_cvt_pk_bf16_f32 v110, v72, v73
    v_pk_mul_f32 v[74:75], v[72:73], v[60:61] op_sel:[0,0] op_sel_hi:[1,0]
    v_cvt_pk_bf16_f32 v216, v100, v101
    v_pk_fma_f32 v[74:75], v[72:73], v[60:61], v[74:75] op_sel:[1,1,0] op_sel_hi:[0,1,1] neg_lo:[1,0,0]
    v_pk_mul_f32 v[102:103], v[96:97], v[62:63] op_sel:[0,0] op_sel_hi:[1,0]
    v_cvt_pk_bf16_f32 v111, v74, v75
    v_pk_mul_f32 v[72:73], v[74:75], v[60:61] op_sel:[0,0] op_sel_hi:[1,0]
    v_pk_fma_f32 v[102:103], v[96:97], v[62:63], v[102:103] op_sel:[1,1,0] op_sel_hi:[0,1,1] neg_hi:[1,0,0]
    v_pk_fma_f32 v[72:73], v[74:75], v[60:61], v[72:73] op_sel:[1,1,0] op_sel_hi:[0,1,1] neg_lo:[1,0,0]
    v_cvt_pk_bf16_f32 v217, v102, v103
    v_cvt_pk_bf16_f32 v112, v72, v73
    v_pk_mul_f32 v[74:75], v[72:73], v[60:61] op_sel:[0,0] op_sel_hi:[1,0]
    v_pk_mul_f32 v[104:105], v[100:101], v[62:63] op_sel:[0,0] op_sel_hi:[1,0]
    v_pk_fma_f32 v[74:75], v[72:73], v[60:61], v[74:75] op_sel:[1,1,0] op_sel_hi:[0,1,1] neg_lo:[1,0,0]
    v_pk_fma_f32 v[104:105], v[100:101], v[62:63], v[104:105] op_sel:[1,1,0] op_sel_hi:[0,1,1] neg_hi:[1,0,0]
    v_cvt_pk_bf16_f32 v113, v74, v75
    v_pk_mul_f32 v[72:73], v[74:75], v[60:61] op_sel:[0,0] op_sel_hi:[1,0]
    v_cvt_pk_bf16_f32 v218, v104, v105
    v_pk_fma_f32 v[72:73], v[74:75], v[60:61], v[72:73] op_sel:[1,1,0] op_sel_hi:[0,1,1] neg_lo:[1,0,0]
    v_pk_mul_f32 v[106:107], v[102:103], v[62:63] op_sel:[0,0] op_sel_hi:[1,0]
    v_cvt_pk_bf16_f32 v114, v72, v73
    v_pk_mul_f32 v[74:75], v[72:73], v[60:61] op_sel:[0,0] op_sel_hi:[1,0]
    v_pk_fma_f32 v[106:107], v[102:103], v[62:63], v[106:107] op_sel:[1,1,0] op_sel_hi:[0,1,1] neg_hi:[1,0,0]
    v_pk_fma_f32 v[74:75], v[72:73], v[60:61], v[74:75] op_sel:[1,1,0] op_sel_hi:[0,1,1] neg_lo:[1,0,0]
    v_cvt_pk_bf16_f32 v219, v106, v107
    v_cvt_pk_bf16_f32 v115, v74, v75
    ds_write2st64_b32 v24, v108, v112 offset0:16 offset1:20
    ds_write2st64_b32 v25, v109, v113 offset0:17 offset1:21
    ds_write2st64_b32 v26, v110, v114 offset0:18 offset1:22
    ds_write2st64_b32 v27, v111, v115 offset0:19 offset1:23
    ds_write2st64_b32 v20, v212, v216 offset0:40 offset1:44
    ds_write2st64_b32 v21, v213, v217 offset0:41 offset1:45
    ds_write2st64_b32 v22, v214, v218 offset0:42 offset1:46
    ds_write2st64_b32 v23, v215, v219 offset0:43 offset1:47
    v_pk_mul_f32 v[72:73], v[74:75], v[60:61] op_sel:[0,0] op_sel_hi:[1,0]
    v_pk_mul_f32 v[100:101], v[104:105], v[62:63] op_sel:[0,0] op_sel_hi:[1,0]
    v_pk_fma_f32 v[72:73], v[74:75], v[60:61], v[72:73] op_sel:[1,1,0] op_sel_hi:[0,1,1] neg_lo:[1,0,0]
    v_cvt_pk_bf16_f32 v108, v72, v73
    v_pk_fma_f32 v[100:101], v[104:105], v[62:63], v[100:101] op_sel:[1,1,0] op_sel_hi:[0,1,1] neg_hi:[1,0,0]
    v_pk_mul_f32 v[74:75], v[72:73], v[60:61] op_sel:[0,0] op_sel_hi:[1,0]
    v_cvt_pk_bf16_f32 v212, v100, v101
    v_pk_fma_f32 v[74:75], v[72:73], v[60:61], v[74:75] op_sel:[1,1,0] op_sel_hi:[0,1,1] neg_lo:[1,0,0]
    v_cvt_pk_bf16_f32 v109, v74, v75
    v_pk_mul_f32 v[102:103], v[100:101], v[62:63] op_sel:[0,0] op_sel_hi:[1,0]
    v_pk_mul_f32 v[72:73], v[74:75], v[60:61] op_sel:[0,0] op_sel_hi:[1,0]
    v_pk_fma_f32 v[102:103], v[100:101], v[62:63], v[102:103] op_sel:[1,1,0] op_sel_hi:[0,1,1] neg_hi:[1,0,0]
    v_pk_fma_f32 v[72:73], v[74:75], v[60:61], v[72:73] op_sel:[1,1,0] op_sel_hi:[0,1,1] neg_lo:[1,0,0]
    v_cvt_pk_bf16_f32 v110, v72, v73
    v_cvt_pk_bf16_f32 v213, v102, v103
    v_pk_mul_f32 v[74:75], v[72:73], v[60:61] op_sel:[0,0] op_sel_hi:[1,0]
    v_pk_mul_f32 v[100:101], v[102:103], v[62:63] op_sel:[0,0] op_sel_hi:[1,0]
    v_pk_fma_f32 v[74:75], v[72:73], v[60:61], v[74:75] op_sel:[1,1,0] op_sel_hi:[0,1,1] neg_lo:[1,0,0]
    v_cvt_pk_bf16_f32 v111, v74, v75
    v_pk_fma_f32 v[100:101], v[102:103], v[62:63], v[100:101] op_sel:[1,1,0] op_sel_hi:[0,1,1] neg_hi:[1,0,0]
    v_pk_mul_f32 v[72:73], v[74:75], v[60:61] op_sel:[0,0] op_sel_hi:[1,0]
    v_cvt_pk_bf16_f32 v214, v100, v101
    v_pk_fma_f32 v[72:73], v[74:75], v[60:61], v[72:73] op_sel:[1,1,0] op_sel_hi:[0,1,1] neg_lo:[1,0,0]
    v_cvt_pk_bf16_f32 v112, v72, v73
    v_pk_mul_f32 v[102:103], v[100:101], v[62:63] op_sel:[0,0] op_sel_hi:[1,0]
    v_pk_mul_f32 v[74:75], v[72:73], v[60:61] op_sel:[0,0] op_sel_hi:[1,0]
    v_pk_fma_f32 v[102:103], v[100:101], v[62:63], v[102:103] op_sel:[1,1,0] op_sel_hi:[0,1,1] neg_hi:[1,0,0]
    v_pk_fma_f32 v[74:75], v[72:73], v[60:61], v[74:75] op_sel:[1,1,0] op_sel_hi:[0,1,1] neg_lo:[1,0,0]
    v_cvt_pk_bf16_f32 v113, v74, v75
    v_cvt_pk_bf16_f32 v215, v102, v103
    v_pk_mul_f32 v[72:73], v[74:75], v[60:61] op_sel:[0,0] op_sel_hi:[1,0]
    v_pk_mul_f32 v[100:101], v[102:103], v[62:63] op_sel:[0,0] op_sel_hi:[1,0]
    v_pk_fma_f32 v[72:73], v[74:75], v[60:61], v[72:73] op_sel:[1,1,0] op_sel_hi:[0,1,1] neg_lo:[1,0,0]
    v_cvt_pk_bf16_f32 v114, v72, v73
    v_pk_fma_f32 v[100:101], v[102:103], v[62:63], v[100:101] op_sel:[1,1,0] op_sel_hi:[0,1,1] neg_hi:[1,0,0]
    v_pk_mul_f32 v[74:75], v[72:73], v[60:61] op_sel:[0,0] op_sel_hi:[1,0]
    v_cvt_pk_bf16_f32 v216, v100, v101
    v_pk_fma_f32 v[74:75], v[72:73], v[60:61], v[74:75] op_sel:[1,1,0] op_sel_hi:[0,1,1] neg_lo:[1,0,0]
    v_cvt_pk_bf16_f32 v115, v74, v75
    ds_write2st64_b32 v24, v212, v216 offset0:48 offset1:52
    ds_write_b32 v25, v213 offset:12544
    ds_write_b32 v26, v214 offset:12800
    ds_write_b32 v27, v215 offset:13056
    ds_write2st64_b32 v28, v108, v112 offset0:24 offset1:28
    ds_write2st64_b32 v29, v109, v113 offset0:25 offset1:29
    ds_write2st64_b32 v30, v110, v114 offset0:26 offset1:30
    ds_write2st64_b32 v31, v111, v115 offset0:27 offset1:31
    ds_read_b128 v[120:123], v32 offset:8192
    ds_read_b128 v[124:127], v32
    ds_read_b128 v[128:131], v33 offset:8192
    ds_read_b128 v[132:135], v33
    ds_read_b128 v[136:139], v34 offset:8192
    ds_read_b128 v[140:143], v34
    ds_read_b128 v[144:147], v35 offset:8192
    ds_read_b128 v[148:151], v35
    ds_read_b128 v[152:155], v36 offset:8192
    ds_read_b128 v[156:159], v36
    ds_read_b128 v[160:163], v37 offset:8192
    ds_read_b128 v[164:167], v37
    ds_read_b128 v[168:171], v38 offset:8192
    ds_read_b128 v[172:175], v38
    ds_read_b128 v[176:179], v39 offset:8192
    ds_read_b128 v[180:183], v39
    s_waitcnt vmcnt(0)
    s_waitcnt lgkmcnt(14)
    v_mfma_f32_32x32x16_bf16 v[184:199], v[120:123], v[124:127], v[184:199]
    v_readfirstlane_b32 s63, v54
    v_cmp_eq_u32 vcc, 0, v0
    v_and_b32 v1, 31, v0
    s_waitcnt lgkmcnt(12)
    v_mfma_f32_32x32x16_bf16 v[184:199], v[128:131], v[132:135], v[184:199]
    v_lshrrev_b32 v2, 5, v0
    s_mul_i32 s63, s63, 0x41c64e6d
    v_cndmask_b32 v200, 0, v53, vcc
    s_waitcnt lgkmcnt(10)
    v_mfma_f32_32x32x16_bf16 v[184:199], v[136:139], v[140:143], v[184:199]
    s_add_u32 s63, s63, 0x3c6ef35f
    v_lshl_add_u32 v3, v1, 4, s69
    v_lshl_add_u32 v4, v2, 3, v3
    s_waitcnt lgkmcnt(8)
    v_mfma_f32_32x32x16_bf16 v[184:199], v[144:147], v[148:151], v[184:199]
    v_lshl_add_u32 v5, v2, 11, v3
    v_add_u32 v6, s69, v15
    v_lshrrev_b32 v7, 2, v0
    s_waitcnt lgkmcnt(6)
    v_mfma_f32_32x32x16_bf16 v[184:199], v[152:155], v[156:159], v[184:199]
    v_mul_u32_u24 v7, 4160, v7
    v_and_b32 v8, 3, v0
    v_lshl_add_u32 v7, v8, 3, v7
    s_waitcnt lgkmcnt(4)
    v_mfma_f32_32x32x16_bf16 v[184:199], v[160:163], v[164:167], v[184:199]
    v_add_u32 v7, s69, v7
    v_mov_b32 v8, 0
    v_mov_b32 v9, 0
    s_waitcnt lgkmcnt(2)
    v_mfma_f32_32x32x16_bf16 v[184:199], v[168:171], v[172:175], v[184:199]
    v_add_u32 v10, 1028, v3
    v_add_u32 v201, 4192, v6
    v_add_u32 v202, 8352, v6
    s_waitcnt lgkmcnt(0)
    v_mfma_f32_32x32x16_bf16 v[184:199], v[176:179], v[180:183], v[184:199]
    s_nop 11
    v_add_f32 v184, v184, v200
    v_mov_b32_dpp v20, v192 quad_perm:[0,0,2,2] row_mask:0xf bank_mask:0xf
    v_mov_b32_dpp v24, v193 quad_perm:[0,0,2,2] row_mask:0xf bank_mask:0xf
    v_mov_b32_dpp v28, v194 quad_perm:[0,0,2,2] row_mask:0xf bank_mask:0xf
    v_mov_b32_dpp v32, v195 quad_perm:[0,0,2,2] row_mask:0xf bank_mask:0xf
    v_cvt_pk_bf16_f32 v21, v192, v192
    v_cvt_pk_bf16_f32 v20, v20, v192
    v_cvt_pk_bf16_f32 v22, v192, v192
    v_cvt_pk_bf16_f32 v23, v192, v192
    v_cvt_pk_bf16_f32 v25, v193, v193
    v_cvt_pk_bf16_f32 v24, v24, v193
    v_cvt_pk_bf16_f32 v26, v193, v193
    v_cvt_pk_bf16_f32 v27, v193, v193
    v_cvt_pk_bf16_f32 v29, v194, v194
    v_cvt_pk_bf16_f32 v28, v28, v194
    v_cvt_pk_bf16_f32 v30, v194, v194
    v_cvt_pk_bf16_f32 v31, v194, v194
    v_cvt_pk_bf16_f32 v33, v195, v195
    v_cvt_pk_bf16_f32 v32, v32, v195
    v_cvt_pk_bf16_f32 v34, v195, v195
    v_cvt_pk_bf16_f32 v35, v195, v195
    v_cvt_pk_bf16_f32 v36, v188, v188
    v_cvt_pk_bf16_f32 v37, v188, v189
    v_cvt_pk_bf16_f32 v38, v189, v189
    v_cvt_pk_bf16_f32 v39, v190, v190
    v_cvt_pk_bf16_f32 v40, v190, v191
    v_cvt_pk_bf16_f32 v41, v191, v191
    v_cvt_pk_bf16_f32 v42, v189, v190
    v_cvt_pk_bf16_f32 v44, v184, v185
    v_cvt_pk_bf16_f32 v45, v186, v187
    ds_write_b128 v5, v[20:23] offset:2048
    ds_write_b128 v5, v[24:27] offset:2560
    ds_write_b128 v5, v[28:31] offset:3072
    ds_write_b128 v5, v[32:35] offset:3584
    s_mov_b32 exec_lo, 0
    ds_write2_b32 v10, v36, v36 offset0:0 offset1:1
    s_nop 0
    ds_write2_b32 v10, v37, v38 offset0:2 offset1:3
    ds_write2_b32 v10, v39, v39 offset0:128 offset1:129
    ds_write2_b32 v10, v40, v41 offset0:130 offset1:131
    s_mov_b64 exec, 0xffffffff
    ds_write_b16 v3, v36 offset:518
    ds_write2_b32 v3, v36, v42 offset0:130 offset1:131
    ds_write_b32 v3, v39 offset:528
    ds_write_b16 v3, v41 offset:532
    s_mov_b64 exec, 1
    ds_write_b64 v3, v[8:9]
    s_mov_b64 exec, -1
    ds_write_b64 v4, v[44:45] offset:8
    ds_read_b128 v[48:51], v6 offset:0
    ds_read_b64 v[52:53], v6 offset:16
    ds_read_b128 v[54:57], v6 offset:1024
    ds_read_b64 v[58:59], v6 offset:1040
    ds_read_b128 v[60:63], v6 offset:2048
    ds_read_b64 v[64:65], v6 offset:2064
    ds_read_b128 v[66:69], v6 offset:3072
    ds_read_b64 v[70:71], v6 offset:3088
    s_mov_b64 exec, 0xffff
    ds_write_b64 v7, v[8:9]
    s_mov_b64 exec, -1
    s_mul_i32 s64, s77, 1280
    s_add_u32 s64, s64, 32768
    v_min_u32 v1, 12, v0
    v_lshl_add_u32 v1, v1, 6, s64
    s_waitcnt lgkmcnt(7)
    v_alignbit_b32 v72, v49, v48, 16
    v_alignbit_b32 v73, v50, v49, 16
    s_nop 0
    v_alignbit_b32 v74, v51, v50, 16
    v_alignbit_b32 v75, v52, v51, 16
    v_alignbit_b32 v76, v53, v52, 16
    ds_write_b128 v6, v[50:53] offset:12512
    ds_write_b128 v6, v[72:75] offset:32
    ds_write2_b32 v201, v49, v50 offset0:0 offset1:1
    ds_write2_b32 v201, v51, v52 offset0:2 offset1:3
    ds_write2_b32 v202, v73, v74 offset0:0 offset1:1
    ds_write2_b32 v202, v75, v76 offset0:2 offset1:3
    s_waitcnt lgkmcnt(11)
    v_alignbit_b32 v78, v55, v54, 16
    v_alignbit_b32 v79, v56, v55, 16
    s_nop 0
    v_alignbit_b32 v80, v57, v56, 16
    v_alignbit_b32 v81, v58, v57, 16
    v_alignbit_b32 v82, v59, v58, 16
    v_add_u32 v201, 1024, v201
    v_add_u32 v202, 1024, v202
    ds_write_b128 v6, v[56:59] offset:13536
    ds_write_b128 v6, v[78:81] offset:1056
    ds_write2_b32 v201, v55, v56 offset0:0 offset1:1
    ds_write2_b32 v201, v57, v58 offset0:2 offset1:3
    ds_write2_b32 v202, v79, v80 offset0:0 offset1:1
    ds_write2_b32 v202, v81, v82 offset0:2 offset1:3
    s_waitcnt lgkmcnt(15)
    s_nop 0
    v_alignbit_b32 v84, v61, v60, 16
    v_alignbit_b32 v85, v62, v61, 16
    v_alignbit_b32 v86, v63, v62, 16
    v_alignbit_b32 v87, v64, v63, 16
    v_alignbit_b32 v88, v65, v64, 16
    v_add_u32 v201, 1024, v201
    v_add_u32 v202, 1024, v202
    ds_write_b128 v6, v[62:65] offset:14560
    ds_write_b128 v6, v[84:87] offset:2080
    ds_write2_b32 v201, v61, v62 offset0:0 offset1:1
    ds_write2_b32 v201, v63, v64 offset0:2 offset1:3
    ds_write2_b32 v202, v85, v86 offset0:0 offset1:1
    ds_write2_b32 v202, v87, v88 offset0:2 offset1:3
    s_waitcnt lgkmcnt(15)
    v_alignbit_b32 v90, v67, v66, 16
    v_alignbit_b32 v91, v68, v67, 16
    s_nop 0
    v_alignbit_b32 v92, v69, v68, 16
    v_alignbit_b32 v93, v70, v69, 16
    v_alignbit_b32 v94, v71, v70, 16
    v_add_u32 v201, 1024, v201
    v_add_u32 v202, 1024, v202
    ds_write_b128 v6, v[68:71] offset:15584
    ds_write_b128 v6, v[90:93] offset:3104
    ds_write2_b32 v201, v67, v68 offset0:0 offset1:1
    ds_write2_b32 v201, v69, v70 offset0:2 offset1:3
    ds_write2_b32 v202, v91, v92 offset0:0 offset1:1
    ds_write2_b32 v202, v93, v94 offset0:2 offset1:3
    v_lshrrev_b32_e64 v4, 3, v0
    v_bfe_u32 v5, v0, 1, 2
    v_lshrrev_b32 v3, 4, v0
    v_xor_b32 v5, v5, v3
    v_and_b32 v3, 1, v0
    v_lshl_add_u32 v5, v5, 1, v3
    v_lshlrev_b32 v5, 4, v5
    v_lshl_add_u32 v5, v4, 7, v5
    s_mul_i32 s64, s76, 81920
    v_add_u32 v14, s64, v5
    v_lshrrev_b32 v3, 2, v0
    v_and_b32 v4, 3, v0
    v_lshlrev_b32 v4, 3, v4
    v_lshl_add_u32 v4, v3, 7, v4
    v_bfe_u32 v5, v0, 3, 2
    v_xor_b32 v5, s60, v5
    v_lshl_add_u32 v144, v5, 5, v4
    v_xor_b32 v145, 32, v144
    v_xor_b32_e64 v146, 64, v144
    v_xor_b32 v147, 96, v144
    v_mov_b32 v172, 0x3f803f80
    v_mov_b32 v173, 0x3f803f80
    v_mov_b32 v174, 0x3f803f80
    v_mov_b32 v175, 0x3f803f80
    s_lshl_b32 s93, s60, 12
    s_cmp_eq_u32 s60, 3
    s_cselect_b32 s64, 0, 0x40000000
    v_mov_b32 v12, 0x40000000
    v_writelane_b32 v12, s64, 0
    v_mov_b32 v13, s63
    s_lshl_b32 s72, s2, 4
    s_add_u32 s72, s72, 69632
    v_and_b32 v10, 15, v0
    v_lshrrev_b32 v11, 4, v0
    v_lshlrev_b32 v4, 6, v10
    v_lshl_add_u32 v4, v11, 4, v4
    v_cmp_gt_u32 vcc, 4, v10
    v_mov_b32 v5, 0x40000000
    s_lshl_b32 s64, s77, 2
    s_add_u32 s64, s64, s60
    v_cndmask_b32 v5, v5, v4, vcc
    s_mul_i32 s64, s64, 6144
    s_add_u32 s22, s64, 131072
    s_add_u32 s23, s22, 4096
    s_barrier
    s_nop 0
    ds_read_b128 v[16:19], v210 offset:0
    ds_read_b128 v[20:23], v210 offset:512
    ds_read_b128 v[24:27], v210 offset:1024
    ds_read_b128 v[28:31], v210 offset:1536
    ds_read_b64 v[96:97], v208 offset:1984
    ds_read_b64 v[98:99], v208 offset:1992
    ds_read_b128 v[32:35], v209 offset:0
    ds_read_b64 v[100:101], v208 offset:1920
    ds_read_b64 v[102:103], v208 offset:1928
    ds_read_b128 v[36:39], v209 offset:64
    ds_read_b64 v[104:105], v208 offset:1856
    ds_read_b64 v[106:107], v208 offset:1864
    ds_read_b128 v[40:43], v209 offset:128
    s_waitcnt lgkmcnt(9)
    v_mfma_f32_16x16x32_bf16 v[212:215], v[204:207], v[16:19], 0
    v_mfma_f32_16x16x32_bf16 v[216:219], v[204:207], v[20:23], 0
    v_mfma_f32_16x16x32_bf16 v[220:223], v[204:207], v[24:27], 0
    v_mfma_f32_16x16x32_bf16 v[224:227], v[204:207], v[28:31], 0
    s_waitcnt lgkmcnt(6)
    v_mfma_f32_16x16x32_bf16 v[224:227], v[96:99], v[32:35], v[224:227]
    ds_read_b64 v[108:109], v208 offset:1792
    ds_read_b64 v[110:111], v208 offset:1800
    ds_read_b128 v[44:47], v209 offset:192
    s_waitcnt lgkmcnt(6)
    v_mfma_f32_16x16x32_bf16 v[224:227], v[100:103], v[36:39], v[224:227]
    ds_read_b64 v[96:97], v208 offset:1728
    ds_read_b64 v[98:99], v208 offset:1736
    ds_read_b128 v[48:51], v209 offset:256
    s_waitcnt lgkmcnt(6)
    v_mfma_f32_16x16x32_bf16 v[224:227], v[104:107], v[40:43], v[224:227]
    ds_read_b64 v[100:101], v208 offset:1664
    ds_read_b64 v[102:103], v208 offset:1672
    ds_read_b128 v[52:55], v209 offset:320
    s_waitcnt lgkmcnt(6)
    v_mfma_f32_16x16x32_bf16 v[224:227], v[108:111], v[44:47], v[224:227]
    ds_read_b64 v[104:105], v208 offset:1600
    ds_read_b64 v[106:107], v208 offset:1608
    ds_read_b128 v[56:59], v209 offset:384
    s_waitcnt lgkmcnt(6)
    v_mfma_f32_16x16x32_bf16 v[224:227], v[96:99], v[48:51], v[224:227]
    ds_read_b64 v[108:109], v208 offset:1536
    ds_read_b64 v[110:111], v208 offset:1544
    ds_read_b128 v[60:63], v209 offset:448
    s_waitcnt lgkmcnt(6)
    v_mfma_f32_16x16x32_bf16 v[224:227], v[100:103], v[52:55], v[224:227]
    ds_read_b64 v[96:97], v208 offset:1472
    ds_read_b64 v[98:99], v208 offset:1480
    ds_read_b128 v[64:67], v209 offset:512
    s_waitcnt lgkmcnt(6)
    v_mfma_f32_16x16x32_bf16 v[224:227], v[104:107], v[56:59], v[224:227]
    ds_read_b64 v[100:101], v208 offset:1408
    ds_read_b64 v[102:103], v208 offset:1416
    ds_read_b128 v[68:71], v209 offset:576
    s_waitcnt lgkmcnt(6)
    v_mfma_f32_16x16x32_bf16 v[224:227], v[108:111], v[60:63], v[224:227]
    ds_read_b64 v[104:105], v208 offset:1344
    ds_read_b64 v[106:107], v208 offset:1352
    ds_read_b128 v[72:75], v209 offset:640
    s_waitcnt lgkmcnt(6)
    v_mfma_f32_16x16x32_bf16 v[220:223], v[96:99], v[32:35], v[220:223]
    ds_read_b64 v[108:109], v208 offset:1280
    ds_read_b64 v[110:111], v208 offset:1288
    v_mfma_f32_16x16x32_bf16 v[224:227], v[96:99], v[64:67], v[224:227]
    ds_read_b128 v[76:79], v209 offset:704
    s_waitcnt lgkmcnt(6)
    v_mfma_f32_16x16x32_bf16 v[220:223], v[100:103], v[36:39], v[220:223]
    ds_read_b64 v[96:97], v208 offset:1216
    ds_read_b64 v[98:99], v208 offset:1224
    v_mfma_f32_16x16x32_bf16 v[224:227], v[100:103], v[68:71], v[224:227]
    ds_read_b128 v[80:83], v209 offset:768
    s_waitcnt lgkmcnt(6)
    v_mfma_f32_16x16x32_bf16 v[220:223], v[104:107], v[40:43], v[220:223]
    ds_read_b64 v[100:101], v208 offset:1152
    ds_read_b64 v[102:103], v208 offset:1160
    v_mfma_f32_16x16x32_bf16 v[224:227], v[104:107], v[72:75], v[224:227]
    ds_read_b128 v[84:87], v209 offset:832
    s_waitcnt lgkmcnt(6)
    v_mfma_f32_16x16x32_bf16 v[220:223], v[108:111], v[44:47], v[220:223]
    ds_read_b64 v[104:105], v208 offset:1088
    ds_read_b64 v[106:107], v208 offset:1096
    v_mfma_f32_16x16x32_bf16 v[224:227], v[108:111], v[76:79], v[224:227]
    ds_read_b128 v[88:91], v209 offset:896
    s_waitcnt lgkmcnt(6)
    v_mfma_f32_16x16x32_bf16 v[220:223], v[96:99], v[48:51], v[220:223]
    ds_read_b64 v[108:109], v208 offset:1024
    ds_read_b64 v[110:111], v208 offset:1032
    v_mfma_f32_16x16x32_bf16 v[224:227], v[96:99], v[80:83], v[224:227]
    ds_read_b128 v[92:95], v209 offset:960
    s_waitcnt lgkmcnt(6)
    v_mfma_f32_16x16x32_bf16 v[220:223], v[100:103], v[52:55], v[220:223]
    ds_read_b64 v[96:97], v208 offset:960
    ds_read_b64 v[98:99], v208 offset:968
    v_mfma_f32_16x16x32_bf16 v[224:227], v[100:103], v[84:87], v[224:227]
    ds_read_b128 v[112:115], v209 offset:1024
    s_waitcnt lgkmcnt(6)
    v_mfma_f32_16x16x32_bf16 v[220:223], v[104:107], v[56:59], v[220:223]
    ds_read_b64 v[100:101], v208 offset:896
    ds_read_b64 v[102:103], v208 offset:904
    v_mfma_f32_16x16x32_bf16 v[224:227], v[104:107], v[88:91], v[224:227]
    ds_read_b128 v[116:119], v209 offset:1088
    s_waitcnt lgkmcnt(6)
    v_mfma_f32_16x16x32_bf16 v[220:223], v[108:111], v[60:63], v[220:223]
    ds_read_b64 v[104:105], v208 offset:832
    ds_read_b64 v[106:107], v208 offset:840
    v_mfma_f32_16x16x32_bf16 v[224:227], v[108:111], v[92:95], v[224:227]
    ds_read_b128 v[120:123], v209 offset:1152
    s_waitcnt lgkmcnt(6)
    v_mfma_f32_16x16x32_bf16 v[216:219], v[96:99], v[32:35], v[216:219]
    ds_read_b64 v[108:109], v208 offset:768
    v_mfma_f32_16x16x32_bf16 v[220:223], v[96:99], v[64:67], v[220:223]
    ds_read_b64 v[110:111], v208 offset:776
    v_mfma_f32_16x16x32_bf16 v[224:227], v[96:99], v[112:115], v[224:227]
    ds_read_b128 v[124:127], v209 offset:1216
    s_waitcnt lgkmcnt(6)
    v_mfma_f32_16x16x32_bf16 v[216:219], v[100:103], v[36:39], v[216:219]
    ds_read_b64 v[96:97], v208 offset:704
    v_mfma_f32_16x16x32_bf16 v[220:223], v[100:103], v[68:71], v[220:223]
    ds_read_b64 v[98:99], v208 offset:712
    v_mfma_f32_16x16x32_bf16 v[224:227], v[100:103], v[116:119], v[224:227]
    ds_read_b128 v[128:131], v209 offset:1280
    s_waitcnt lgkmcnt(6)
    v_mfma_f32_16x16x32_bf16 v[216:219], v[104:107], v[40:43], v[216:219]
    ds_read_b64 v[100:101], v208 offset:640
    v_mfma_f32_16x16x32_bf16 v[220:223], v[104:107], v[72:75], v[220:223]
    ds_read_b64 v[102:103], v208 offset:648
    v_mfma_f32_16x16x32_bf16 v[224:227], v[104:107], v[120:123], v[224:227]
    ds_read_b128 v[132:135], v209 offset:1344
    s_waitcnt lgkmcnt(6)
    v_mfma_f32_16x16x32_bf16 v[216:219], v[108:111], v[44:47], v[216:219]
    ds_read_b64 v[104:105], v208 offset:576
    v_mfma_f32_16x16x32_bf16 v[220:223], v[108:111], v[76:79], v[220:223]
    ds_read_b64 v[106:107], v208 offset:584
    v_mfma_f32_16x16x32_bf16 v[224:227], v[108:111], v[124:127], v[224:227]
    ds_read_b128 v[136:139], v209 offset:1408
    s_waitcnt lgkmcnt(6)
    v_mfma_f32_16x16x32_bf16 v[216:219], v[96:99], v[48:51], v[216:219]
    ds_read_b64 v[108:109], v208 offset:512
    v_mfma_f32_16x16x32_bf16 v[220:223], v[96:99], v[80:83], v[220:223]
    ds_read_b64 v[110:111], v208 offset:520
    v_mfma_f32_16x16x32_bf16 v[224:227], v[96:99], v[128:131], v[224:227]
    ds_read_b128 v[140:143], v209 offset:1472
    s_waitcnt lgkmcnt(6)
    v_mfma_f32_16x16x32_bf16 v[216:219], v[100:103], v[52:55], v[216:219]
    ds_read_b64 v[96:97], v208 offset:448
    v_mfma_f32_16x16x32_bf16 v[220:223], v[100:103], v[84:87], v[220:223]
    ds_read_b64 v[98:99], v208 offset:456
    v_mfma_f32_16x16x32_bf16 v[224:227], v[100:103], v[132:135], v[224:227]
    ds_read_b128 v[16:19], v209 offset:1536
    s_waitcnt lgkmcnt(6)
    v_mfma_f32_16x16x32_bf16 v[216:219], v[104:107], v[56:59], v[216:219]
    ds_read_b64 v[100:101], v208 offset:384
    v_mfma_f32_16x16x32_bf16 v[220:223], v[104:107], v[88:91], v[220:223]
    ds_read_b64 v[102:103], v208 offset:392
    v_mfma_f32_16x16x32_bf16 v[224:227], v[104:107], v[136:139], v[224:227]
    ds_read_b128 v[20:23], v209 offset:1600
    s_waitcnt lgkmcnt(6)
    v_mfma_f32_16x16x32_bf16 v[216:219], v[108:111], v[60:63], v[216:219]
    ds_read_b64 v[104:105], v208 offset:320
    v_mfma_f32_16x16x32_bf16 v[220:223], v[108:111], v[92:95], v[220:223]
    ds_read_b64 v[106:107], v208 offset:328
    v_mfma_f32_16x16x32_bf16 v[224:227], v[108:111], v[140:143], v[224:227]
    ds_read_b128 v[24:27], v209 offset:1664
    s_waitcnt lgkmcnt(6)
    v_mfma_f32_16x16x32_bf16 v[212:215], v[96:99], v[32:35], v[212:215]
    ds_read_b64 v[108:109], v208 offset:256
    v_mfma_f32_16x16x32_bf16 v[216:219], v[96:99], v[64:67], v[216:219]
    ds_read_b64 v[110:111], v208 offset:264
    v_mfma_f32_16x16x32_bf16 v[220:223], v[96:99], v[112:115], v[220:223]
    ds_read_b128 v[28:31], v209 offset:1728
    v_mfma_f32_16x16x32_bf16 v[224:227], v[96:99], v[16:19], v[224:227]
    s_waitcnt lgkmcnt(6)
    v_mfma_f32_16x16x32_bf16 v[212:215], v[100:103], v[36:39], v[212:215]
    ds_read_b64 v[96:97], v208 offset:192
    v_mfma_f32_16x16x32_bf16 v[216:219], v[100:103], v[68:71], v[216:219]
    ds_read_b64 v[98:99], v208 offset:200
    v_mfma_f32_16x16x32_bf16 v[220:223], v[100:103], v[116:119], v[220:223]
    ds_read_b128 v[32:35], v209 offset:1792
    v_mfma_f32_16x16x32_bf16 v[224:227], v[100:103], v[20:23], v[224:227]
    s_waitcnt lgkmcnt(6)
    v_mfma_f32_16x16x32_bf16 v[212:215], v[104:107], v[40:43], v[212:215]
    ds_read_b64 v[100:101], v208 offset:128
    v_mfma_f32_16x16x32_bf16 v[216:219], v[104:107], v[72:75], v[216:219]
    ds_read_b64 v[102:103], v208 offset:136
    v_mfma_f32_16x16x32_bf16 v[220:223], v[104:107], v[120:123], v[220:223]
    ds_read_b128 v[64:67], v209 offset:1856
    v_mfma_f32_16x16x32_bf16 v[224:227], v[104:107], v[24:27], v[224:227]
    s_waitcnt lgkmcnt(6)
    v_mfma_f32_16x16x32_bf16 v[212:215], v[108:111], v[44:47], v[212:215]
    ds_read_b64 v[104:105], v208 offset:64
    v_mfma_f32_16x16x32_bf16 v[216:219], v[108:111], v[76:79], v[216:219]
    ds_read_b64 v[106:107], v208 offset:72
    v_mfma_f32_16x16x32_bf16 v[220:223], v[108:111], v[124:127], v[220:223]
    ds_read_b128 v[112:115], v209 offset:1920
    v_mfma_f32_16x16x32_bf16 v[224:227], v[108:111], v[28:31], v[224:227]
    s_waitcnt lgkmcnt(6)
    v_mfma_f32_16x16x32_bf16 v[212:215], v[96:99], v[48:51], v[212:215]
    ds_read_b64 v[108:109], v208 offset:0
    v_mfma_f32_16x16x32_bf16 v[216:219], v[96:99], v[80:83], v[216:219]
    ds_read_b64 v[110:111], v208 offset:8
    v_mfma_f32_16x16x32_bf16 v[220:223], v[96:99], v[128:131], v[220:223]
    ds_read_b128 v[16:19], v209 offset:1984
    v_mfma_f32_16x16x32_bf16 v[224:227], v[96:99], v[32:35], v[224:227]
    s_waitcnt lgkmcnt(6)
    v_mfma_f32_16x16x32_bf16 v[212:215], v[100:103], v[52:55], v[212:215]
    v_mfma_f32_16x16x32_bf16 v[216:219], v[100:103], v[84:87], v[216:219]
    v_mfma_f32_16x16x32_bf16 v[220:223], v[100:103], v[132:135], v[220:223]
    v_mfma_f32_16x16x32_bf16 v[224:227], v[100:103], v[64:67], v[224:227]
    s_waitcnt lgkmcnt(3)
    v_mfma_f32_16x16x32_bf16 v[212:215], v[104:107], v[56:59], v[212:215]
    buffer_load_dword v2, v1, s[44:47], 0 offen sc1
    v_mfma_f32_16x16x32_bf16 v[216:219], v[104:107], v[88:91], v[216:219]
    v_mfma_f32_16x16x32_bf16 v[220:223], v[104:107], v[136:139], v[220:223]
    v_mfma_f32_16x16x32_bf16 v[224:227], v[104:107], v[112:115], v[224:227]
    s_waitcnt lgkmcnt(0)
    v_mfma_f32_16x16x32_bf16 v[212:215], v[108:111], v[60:63], v[212:215]
    v_mfma_f32_16x16x32_bf16 v[216:219], v[108:111], v[92:95], v[216:219]
    v_mfma_f32_16x16x32_bf16 v[220:223], v[108:111], v[140:143], v[220:223]
    v_mfma_f32_16x16x32_bf16 v[224:227], v[108:111], v[16:19], v[224:227]
    s_nop 4
    v_cvt_pk_bf16_f32 v244, v212, v213
    v_cvt_pk_bf16_f32 v245, v214, v215
    s_mov_b32 s97, 0
    buffer_store_dwordx2 v[244:245], v211, s[84:87], s97 offen sc1
    v_cvt_pk_bf16_f32 v246, v216, v217
    v_cvt_pk_bf16_f32 v247, v218, v219
    s_nop 0
    s_mov_b32 s97, 327680
    buffer_store_dwordx2 v[246:247], v211, s[84:87], s97 offen sc1
    v_cvt_pk_bf16_f32 v248, v220, v221
    v_cvt_pk_bf16_f32 v249, v222, v223
    s_mov_b32 s97, 655360
    buffer_store_dwordx2 v[248:249], v211, s[84:87], s97 offen sc1
    v_cvt_pk_bf16_f32 v250, v224, v225
    v_cvt_pk_bf16_f32 v251, v226, v227
    s_mov_b32 s97, 983040
    buffer_store_dwordx2 v[250:251], v211, s[84:87], s97 offen sc1
    s_barrier
    ds_read_b128 v[16:19], v210 offset:2048
    s_nop 0
    ds_read_b128 v[20:23], v210 offset:2560
    ds_read_b128 v[24:27], v210 offset:3072
    ds_read_b128 v[28:31], v210 offset:3584
    ds_read_b64 v[96:97], v208 offset:0
    ds_read_b64 v[98:99], v208 offset:8
    ds_read_b128 v[32:35], v209 offset:2496
    ds_read_b128 v[36:39], v209 offset:3008
    ds_read_b128 v[40:43], v209 offset:3520
    ds_read_b128 v[44:47], v209 offset:4032
    ds_read_b64 v[100:101], v208 offset:64
    ds_read_b64 v[102:103], v208 offset:72
    ds_read_b128 v[48:51], v209 offset:2432
    ds_read_b128 v[52:55], v209 offset:2944
    ds_read_b128 v[56:59], v209 offset:3456
    ds_read_b128 v[60:63], v209 offset:3968
    ds_read_b64 v[104:105], v208 offset:128
    ds_read_b64 v[106:107], v208 offset:136
    ds_read_b128 v[64:67], v209 offset:2368
    ds_read_b128 v[68:71], v209 offset:2880
    ds_read_b128 v[72:75], v209 offset:3392
    ds_read_b128 v[76:79], v209 offset:3904
    s_waitcnt lgkmcnt(15)
    v_mfma_f32_16x16x32_bf16 v[228:231], v[204:207], v[16:19], 0
    v_mfma_f32_16x16x32_bf16 v[232:235], v[204:207], v[20:23], 0
    v_mfma_f32_16x16x32_bf16 v[236:239], v[204:207], v[24:27], 0
    v_mfma_f32_16x16x32_bf16 v[240:243], v[204:207], v[28:31], 0
    s_waitcnt lgkmcnt(12)
    v_mfma_f32_16x16x32_bf16 v[228:231], v[96:99], v[32:35], v[228:231]
    ds_read_b64 v[108:109], v208 offset:192
    ds_read_b64 v[110:111], v208 offset:200
    v_mfma_f32_16x16x32_bf16 v[232:235], v[96:99], v[36:39], v[232:235]
    ds_read_b128 v[80:83], v209 offset:2304
    ds_read_b128 v[84:87], v209 offset:2816
    v_mfma_f32_16x16x32_bf16 v[236:239], v[96:99], v[40:43], v[236:239]
    ds_read_b128 v[88:91], v209 offset:3328
    v_mfma_f32_16x16x32_bf16 v[240:243], v[96:99], v[44:47], v[240:243]
    ds_read_b128 v[92:95], v209 offset:3840
    s_waitcnt lgkmcnt(12)
    v_mfma_f32_16x16x32_bf16 v[228:231], v[100:103], v[48:51], v[228:231]
    ds_read_b64 v[96:97], v208 offset:256
    ds_read_b64 v[98:99], v208 offset:264
    v_mfma_f32_16x16x32_bf16 v[232:235], v[100:103], v[52:55], v[232:235]
    ds_read_b128 v[112:115], v209 offset:2240
    ds_read_b128 v[116:119], v209 offset:2752
    v_mfma_f32_16x16x32_bf16 v[236:239], v[100:103], v[56:59], v[236:239]
    ds_read_b128 v[120:123], v209 offset:3264
    v_mfma_f32_16x16x32_bf16 v[240:243], v[100:103], v[60:63], v[240:243]
    ds_read_b128 v[124:127], v209 offset:3776
    s_waitcnt lgkmcnt(12)
    v_mfma_f32_16x16x32_bf16 v[228:231], v[104:107], v[64:67], v[228:231]
    ds_read_b64 v[100:101], v208 offset:320
    ds_read_b64 v[102:103], v208 offset:328
    v_mfma_f32_16x16x32_bf16 v[232:235], v[104:107], v[68:71], v[232:235]
    ds_read_b128 v[128:131], v209 offset:2176
    ds_read_b128 v[132:135], v209 offset:2688
    v_mfma_f32_16x16x32_bf16 v[236:239], v[104:107], v[72:75], v[236:239]
    ds_read_b128 v[136:139], v209 offset:3200
    v_mfma_f32_16x16x32_bf16 v[240:243], v[104:107], v[76:79], v[240:243]
    ds_read_b128 v[140:143], v209 offset:3712
    s_waitcnt lgkmcnt(12)
    v_mfma_f32_16x16x32_bf16 v[228:231], v[108:111], v[80:83], v[228:231]
    ds_read_b64 v[104:105], v208 offset:384
    ds_read_b64 v[106:107], v208 offset:392
    v_mfma_f32_16x16x32_bf16 v[232:235], v[108:111], v[84:87], v[232:235]
    ds_read_b128 v[16:19], v209 offset:2112
    ds_read_b128 v[20:23], v209 offset:2624
    v_mfma_f32_16x16x32_bf16 v[236:239], v[108:111], v[88:91], v[236:239]
    ds_read_b128 v[24:27], v209 offset:3136
    v_mfma_f32_16x16x32_bf16 v[240:243], v[108:111], v[92:95], v[240:243]
    ds_read_b128 v[28:31], v209 offset:3648
    s_waitcnt lgkmcnt(12)
    v_mfma_f32_16x16x32_bf16 v[228:231], v[96:99], v[112:115], v[228:231]
    ds_read_b64 v[108:109], v208 offset:448
    ds_read_b64 v[110:111], v208 offset:456
    v_mfma_f32_16x16x32_bf16 v[232:235], v[96:99], v[116:119], v[232:235]
    ds_read_b128 v[44:47], v209 offset:2048
    ds_read_b128 v[60:63], v209 offset:2560
    v_mfma_f32_16x16x32_bf16 v[236:239], v[96:99], v[120:123], v[236:239]
    ds_read_b128 v[76:79], v209 offset:3072
    v_mfma_f32_16x16x32_bf16 v[240:243], v[96:99], v[124:127], v[240:243]
    ds_read_b128 v[92:95], v209 offset:3584
    s_waitcnt lgkmcnt(12)
    v_mfma_f32_16x16x32_bf16 v[228:231], v[100:103], v[128:131], v[228:231]
    ds_read_b64 v[96:97], v208 offset:512
    v_mfma_f32_16x16x32_bf16 v[232:235], v[100:103], v[132:135], v[232:235]
    ds_read_b64 v[98:99], v208 offset:520
    v_mfma_f32_16x16x32_bf16 v[236:239], v[100:103], v[136:139], v[236:239]
    ds_read_b128 v[124:127], v209 offset:1984
    v_mfma_f32_16x16x32_bf16 v[240:243], v[100:103], v[140:143], v[240:243]
    s_waitcnt lgkmcnt(9)
    v_mfma_f32_16x16x32_bf16 v[228:231], v[104:107], v[16:19], v[228:231]
    ds_read_b64 v[100:101], v208 offset:576
    s_waitcnt vmcnt(4)
    v_cmp_ne_u32 vcc, s63, v2
    s_cbranch_vccz L_pdone_3
    s_mov_b32 s82, 0
L_poll_2:
    buffer_load_dword v2, v1, s[44:47], 0 offen sc1
    s_waitcnt vmcnt(0)
    v_cmp_ne_u32 vcc, s63, v2
    s_cbranch_vccz L_pdone_3
    s_add_u32 s82, s82, 1
    s_cmp_lt_u32 s82, 400000
    s_cbranch_scc1 L_poll_2
L_pdone_3:
    v_mfma_f32_16x16x32_bf16 v[232:235], v[104:107], v[20:23], v[232:235]
    ds_read_b64 v[102:103], v208 offset:584
    v_mfma_f32_16x16x32_bf16 v[236:239], v[104:107], v[24:27], v[236:239]
    ds_read_b128 v[140:143], v209 offset:1920
    v_mfma_f32_16x16x32_bf16 v[240:243], v[104:107], v[28:31], v[240:243]
    s_waitcnt lgkmcnt(6)
    v_mfma_f32_16x16x32_bf16 v[228:231], v[108:111], v[44:47], v[228:231]
    ds_read_b64 v[104:105], v208 offset:640
    buffer_load_dwordx4 a[0:3], v15, s[44:47], s92 offen offset:0 sc1
    v_mfma_f32_16x16x32_bf16 v[232:235], v[108:111], v[60:63], v[232:235]
    ds_read_b64 v[106:107], v208 offset:648
    v_mfma_f32_16x16x32_bf16 v[236:239], v[108:111], v[76:79], v[236:239]
    ds_read_b128 v[28:31], v209 offset:1856
    v_mfma_f32_16x16x32_bf16 v[240:243], v[108:111], v[92:95], v[240:243]
    s_waitcnt lgkmcnt(6)
    v_mfma_f32_16x16x32_bf16 v[228:231], v[96:99], v[124:127], v[228:231]
    ds_read_b64 v[108:109], v208 offset:704
    buffer_load_dwordx4 a[4:7], v15, s[44:47], s92 offen offset:1024 sc1
    v_mfma_f32_16x16x32_bf16 v[232:235], v[96:99], v[32:35], v[232:235]
    ds_read_b64 v[110:111], v208 offset:712
    v_mfma_f32_16x16x32_bf16 v[236:239], v[96:99], v[36:39], v[236:239]
    ds_read_b128 v[92:95], v209 offset:1792
    v_mfma_f32_16x16x32_bf16 v[240:243], v[96:99], v[40:43], v[240:243]
    s_waitcnt lgkmcnt(6)
    v_mfma_f32_16x16x32_bf16 v[228:231], v[100:103], v[140:143], v[228:231]
    ds_read_b64 v[96:97], v208 offset:768
    buffer_load_dwordx4 a[8:11], v15, s[44:47], s92 offen offset:2048 sc1
    v_mfma_f32_16x16x32_bf16 v[232:235], v[100:103], v[48:51], v[232:235]
    ds_read_b64 v[98:99], v208 offset:776
    v_mfma_f32_16x16x32_bf16 v[236:239], v[100:103], v[52:55], v[236:239]
    ds_read_b128 v[40:43], v209 offset:1728
    v_mfma_f32_16x16x32_bf16 v[240:243], v[100:103], v[56:59], v[240:243]
    s_waitcnt lgkmcnt(6)
    v_mfma_f32_16x16x32_bf16 v[228:231], v[104:107], v[28:31], v[228:231]
    ds_read_b64 v[100:101], v208 offset:832
    buffer_load_dwordx4 a[12:15], v15, s[44:47], s92 offen offset:3072 sc1
    v_mfma_f32_16x16x32_bf16 v[232:235], v[104:107], v[64:67], v[232:235]
    ds_read_b64 v[102:103], v208 offset:840
    s_add_u32 s92, s92, 4096
    v_mfma_f32_16x16x32_bf16 v[236:239], v[104:107], v[68:71], v[236:239]
    ds_read_b128 v[56:59], v209 offset:1664
    v_mfma_f32_16x16x32_bf16 v[240:243], v[104:107], v[72:75], v[240:243]
    s_waitcnt lgkmcnt(6)
    v_mfma_f32_16x16x32_bf16 v[228:231], v[108:111], v[92:95], v[228:231]
    ds_read_b64 v[104:105], v208 offset:896
    buffer_load_dwordx4 a[16:19], v15, s[44:47], s92 offen offset:0 sc1
    v_mfma_f32_16x16x32_bf16 v[232:235], v[108:111], v[80:83], v[232:235]
    ds_read_b64 v[106:107], v208 offset:904
    v_mfma_f32_16x16x32_bf16 v[236:239], v[108:111], v[84:87], v[236:239]
    ds_read_b128 v[72:75], v209 offset:1600
    v_mfma_f32_16x16x32_bf16 v[240:243], v[108:111], v[88:91], v[240:243]
    s_waitcnt lgkmcnt(6)
    v_mfma_f32_16x16x32_bf16 v[228:231], v[96:99], v[40:43], v[228:231]
    ds_read_b64 v[108:109], v208 offset:960
    buffer_load_dwordx4 a[20:23], v15, s[44:47], s92 offen offset:1024 sc1
    v_mfma_f32_16x16x32_bf16 v[232:235], v[96:99], v[112:115], v[232:235]
    ds_read_b64 v[110:111], v208 offset:968
    v_mfma_f32_16x16x32_bf16 v[236:239], v[96:99], v[116:119], v[236:239]
    ds_read_b128 v[88:91], v209 offset:1536
    v_mfma_f32_16x16x32_bf16 v[240:243], v[96:99], v[120:123], v[240:243]
    s_waitcnt lgkmcnt(6)
    v_mfma_f32_16x16x32_bf16 v[228:231], v[100:103], v[56:59], v[228:231]
    ds_read_b64 v[96:97], v208 offset:1024
    buffer_load_dwordx4 a[24:27], v15, s[44:47], s92 offen offset:2048 sc1
    v_mfma_f32_16x16x32_bf16 v[232:235], v[100:103], v[128:131], v[232:235]
    ds_read_b64 v[98:99], v208 offset:1032
    s_waitcnt vmcnt(7)
    s_barrier
    v_mfma_f32_16x16x32_bf16 v[236:239], v[100:103], v[132:135], v[236:239]
    ds_read_b128 v[120:123], v209 offset:1472
    v_mfma_f32_16x16x32_bf16 v[240:243], v[100:103], v[136:139], v[240:243]
    s_waitcnt lgkmcnt(6)
    v_mfma_f32_16x16x32_bf16 v[228:231], v[104:107], v[72:75], v[228:231]
    ds_read_b64 v[100:101], v208 offset:1088
    buffer_load_dwordx4 a[28:31], v15, s[44:47], s92 offen offset:3072 sc1
    v_mfma_f32_16x16x32_bf16 v[232:235], v[104:107], v[16:19], v[232:235]
    ds_read_b64 v[102:103], v208 offset:1096
    s_add_u32 s92, s92, 4096
    v_mfma_f32_16x16x32_bf16 v[236:239], v[104:107], v[20:23], v[236:239]
    ds_read_b128 v[136:139], v209 offset:1408
    v_mfma_f32_16x16x32_bf16 v[240:243], v[104:107], v[24:27], v[240:243]
    s_waitcnt lgkmcnt(6)
    v_mfma_f32_16x16x32_bf16 v[228:231], v[108:111], v[88:91], v[228:231]
    ds_read_b64 v[104:105], v208 offset:1152
    buffer_load_dwordx4 a[32:35], v15, s[44:47], s92 offen offset:0 sc1
    v_mfma_f32_16x16x32_bf16 v[232:235], v[108:111], v[44:47], v[232:235]
    ds_read_b64 v[106:107], v208 offset:1160
    v_mfma_f32_16x16x32_bf16 v[236:239], v[108:111], v[60:63], v[236:239]
    ds_read_b128 v[24:27], v209 offset:1344
    v_mfma_f32_16x16x32_bf16 v[240:243], v[108:111], v[76:79], v[240:243]
    s_waitcnt lgkmcnt(6)
    v_mfma_f32_16x16x32_bf16 v[228:231], v[96:99], v[120:123], v[228:231]
    ds_read_b64 v[108:109], v208 offset:1216
    buffer_load_dwordx4 a[36:39], v15, s[44:47], s92 offen offset:1024 sc1
    v_mfma_f32_16x16x32_bf16 v[232:235], v[96:99], v[124:127], v[232:235]
    ds_read_b64 v[110:111], v208 offset:1224
    v_mfma_f32_16x16x32_bf16 v[236:239], v[96:99], v[32:35], v[236:239]
    ds_read_b128 v[76:79], v209 offset:1280
    v_mfma_f32_16x16x32_bf16 v[240:243], v[96:99], v[36:39], v[240:243]
    s_waitcnt lgkmcnt(6)
    v_mfma_f32_16x16x32_bf16 v[228:231], v[100:103], v[136:139], v[228:231]
    ds_read_b64 v[96:97], v208 offset:1280
    buffer_load_dwordx4 a[40:43], v15, s[44:47], s92 offen offset:2048 sc1
    v_mfma_f32_16x16x32_bf16 v[232:235], v[100:103], v[140:143], v[232:235]
    ds_read_b64 v[98:99], v208 offset:1288
    v_mfma_f32_16x16x32_bf16 v[236:239], v[100:103], v[48:51], v[236:239]
    ds_read_b128 v[36:39], v209 offset:1216
    v_mfma_f32_16x16x32_bf16 v[240:243], v[100:103], v[52:55], v[240:243]
    s_waitcnt lgkmcnt(6)
    v_mfma_f32_16x16x32_bf16 v[228:231], v[104:107], v[24:27], v[228:231]
    ds_read_b64 v[100:101], v208 offset:1344
    buffer_load_dwordx4 a[44:47], v15, s[44:47], s92 offen offset:3072 sc1
    v_mfma_f32_16x16x32_bf16 v[232:235], v[104:107], v[28:31], v[232:235]
    ds_read_b64 v[102:103], v208 offset:1352
    s_add_u32 s92, s92, 4096
    v_mfma_f32_16x16x32_bf16 v[236:239], v[104:107], v[64:67], v[236:239]
    ds_read_b128 v[52:55], v209 offset:1152
    v_mfma_f32_16x16x32_bf16 v[240:243], v[104:107], v[68:71], v[240:243]
    s_waitcnt lgkmcnt(6)
    v_mfma_f32_16x16x32_bf16 v[228:231], v[108:111], v[76:79], v[228:231]
    ds_read_b64 v[104:105], v208 offset:1408
    buffer_load_dwordx4 a[48:51], v15, s[44:47], s92 offen offset:0 sc1
    v_mfma_f32_16x16x32_bf16 v[232:235], v[108:111], v[92:95], v[232:235]
    ds_read_b64 v[106:107], v208 offset:1416
    v_mfma_f32_16x16x32_bf16 v[236:239], v[108:111], v[80:83], v[236:239]
    ds_read_b128 v[68:71], v209 offset:1088
    v_mfma_f32_16x16x32_bf16 v[240:243], v[108:111], v[84:87], v[240:243]
    s_waitcnt lgkmcnt(6)
    v_mfma_f32_16x16x32_bf16 v[228:231], v[96:99], v[36:39], v[228:231]
    ds_read_b64 v[108:109], v208 offset:1472
    buffer_load_dwordx4 a[52:55], v15, s[44:47], s92 offen offset:1024 sc1
    v_mfma_f32_16x16x32_bf16 v[232:235], v[96:99], v[40:43], v[232:235]
    ds_read_b64 v[110:111], v208 offset:1480
    v_mfma_f32_16x16x32_bf16 v[236:239], v[96:99], v[112:115], v[236:239]
    ds_read_b128 v[84:87], v209 offset:1024
    v_mfma_f32_16x16x32_bf16 v[240:243], v[96:99], v[116:119], v[240:243]
    s_waitcnt lgkmcnt(6)
    v_mfma_f32_16x16x32_bf16 v[228:231], v[100:103], v[52:55], v[228:231]
    ds_read_b64 v[96:97], v208 offset:1536
    buffer_load_dwordx4 a[56:59], v15, s[44:47], s92 offen offset:2048 sc1
    v_mfma_f32_16x16x32_bf16 v[232:235], v[100:103], v[56:59], v[232:235]
    ds_read_b64 v[98:99], v208 offset:1544
    v_mfma_f32_16x16x32_bf16 v[236:239], v[100:103], v[128:131], v[236:239]
    ds_read_b128 v[116:119], v209 offset:960
    v_mfma_f32_16x16x32_bf16 v[240:243], v[100:103], v[132:135], v[240:243]
    s_waitcnt lgkmcnt(6)
    v_mfma_f32_16x16x32_bf16 v[228:231], v[104:107], v[68:71], v[228:231]
    ds_read_b64 v[100:101], v208 offset:1600
    buffer_load_dwordx4 a[60:63], v15, s[44:47], s92 offen offset:3072 sc1
    v_mfma_f32_16x16x32_bf16 v[232:235], v[104:107], v[72:75], v[232:235]
    ds_read_b64 v[102:103], v208 offset:1608
    s_add_u32 s92, s92, 4096
    v_mfma_f32_16x16x32_bf16 v[236:239], v[104:107], v[16:19], v[236:239]
    ds_read_b128 v[132:135], v209 offset:896
    v_mfma_f32_16x16x32_bf16 v[240:243], v[104:107], v[20:23], v[240:243]
    s_waitcnt lgkmcnt(6)
    v_mfma_f32_16x16x32_bf16 v[228:231], v[108:111], v[84:87], v[228:231]
    ds_read_b64 v[104:105], v208 offset:1664
    buffer_load_dwordx4 a[64:67], v15, s[44:47], s92 offen offset:0 sc1
    v_mfma_f32_16x16x32_bf16 v[232:235], v[108:111], v[88:91], v[232:235]
    ds_read_b64 v[106:107], v208 offset:1672
    v_mfma_f32_16x16x32_bf16 v[236:239], v[108:111], v[44:47], v[236:239]
    ds_read_b128 v[20:23], v209 offset:832
    v_mfma_f32_16x16x32_bf16 v[240:243], v[108:111], v[60:63], v[240:243]
    s_waitcnt lgkmcnt(6)
    v_mfma_f32_16x16x32_bf16 v[228:231], v[96:99], v[116:119], v[228:231]
    ds_read_b64 v[108:109], v208 offset:1728
    buffer_load_dwordx4 a[68:71], v15, s[44:47], s92 offen offset:1024 sc1
    v_mfma_f32_16x16x32_bf16 v[232:235], v[96:99], v[120:123], v[232:235]
    ds_read_b64 v[110:111], v208 offset:1736
    v_mfma_f32_16x16x32_bf16 v[236:239], v[96:99], v[124:127], v[236:239]
    ds_read_b128 v[60:63], v209 offset:768
    v_mfma_f32_16x16x32_bf16 v[240:243], v[96:99], v[32:35], v[240:243]
    s_waitcnt lgkmcnt(6)
    v_mfma_f32_16x16x32_bf16 v[228:231], v[100:103], v[132:135], v[228:231]
    ds_read_b64 v[96:97], v208 offset:1792
    buffer_load_dwordx4 a[72:75], v15, s[44:47], s92 offen offset:2048 sc1
    v_mfma_f32_16x16x32_bf16 v[232:235], v[100:103], v[136:139], v[232:235]
    ds_read_b64 v[98:99], v208 offset:1800
    v_mfma_f32_16x16x32_bf16 v[236:239], v[100:103], v[140:143], v[236:239]
    ds_read_b128 v[32:35], v209 offset:704
    v_mfma_f32_16x16x32_bf16 v[240:243], v[100:103], v[48:51], v[240:243]
    s_waitcnt lgkmcnt(6)
    v_mfma_f32_16x16x32_bf16 v[228:231], v[104:107], v[20:23], v[228:231]
    ds_read_b64 v[100:101], v208 offset:1856
    buffer_load_dwordx4 a[76:79], v15, s[44:47], s92 offen offset:3072 sc1
    v_mfma_f32_16x16x32_bf16 v[232:235], v[104:107], v[24:27], v[232:235]
    ds_read_b64 v[102:103], v208 offset:1864
    s_add_u32 s92, s92, 4096
    v_mfma_f32_16x16x32_bf16 v[236:239], v[104:107], v[28:31], v[236:239]
    ds_read_b128 v[48:51], v209 offset:640
    v_mfma_f32_16x16x32_bf16 v[240:243], v[104:107], v[64:67], v[240:243]
    s_waitcnt lgkmcnt(6)
    v_mfma_f32_16x16x32_bf16 v[228:231], v[108:111], v[60:63], v[228:231]
    ds_read_b64 v[104:105], v208 offset:1920
    buffer_load_dwordx4 a[80:83], v15, s[44:47], s92 offen offset:0 sc1
    v_mfma_f32_16x16x32_bf16 v[232:235], v[108:111], v[76:79], v[232:235]
    ds_read_b64 v[106:107], v208 offset:1928
    v_mfma_f32_16x16x32_bf16 v[236:239], v[108:111], v[92:95], v[236:239]
    ds_read_b128 v[64:67], v209 offset:576
    v_mfma_f32_16x16x32_bf16 v[240:243], v[108:111], v[80:83], v[240:243]
    s_waitcnt lgkmcnt(6)
    v_mfma_f32_16x16x32_bf16 v[228:231], v[96:99], v[32:35], v[228:231]
    ds_read_b64 v[108:109], v208 offset:1984
    buffer_load_dwordx4 a[84:87], v15, s[44:47], s92 offen offset:1024 sc1
    v_mfma_f32_16x16x32_bf16 v[232:235], v[96:99], v[36:39], v[232:235]
    ds_read_b64 v[110:111], v208 offset:1992
    v_mfma_f32_16x16x32_bf16 v[236:239], v[96:99], v[40:43], v[236:239]
    ds_read_b128 v[80:83], v209 offset:512
    v_mfma_f32_16x16x32_bf16 v[240:243], v[96:99], v[112:115], v[240:243]
    s_waitcnt lgkmcnt(6)
    v_mfma_f32_16x16x32_bf16 v[228:231], v[100:103], v[48:51], v[228:231]
    ds_read_b64 v[96:97], v208 offset:2048
    buffer_load_dwordx4 a[88:91], v15, s[44:47], s92 offen offset:2048 sc1
    v_mfma_f32_16x16x32_bf16 v[232:235], v[100:103], v[52:55], v[232:235]
    ds_read_b64 v[98:99], v208 offset:2056
    v_mfma_f32_16x16x32_bf16 v[236:239], v[100:103], v[56:59], v[236:239]
    ds_read_b128 v[112:115], v209 offset:448
    v_mfma_f32_16x16x32_bf16 v[240:243], v[100:103], v[128:131], v[240:243]
    s_waitcnt lgkmcnt(6)
    v_mfma_f32_16x16x32_bf16 v[228:231], v[104:107], v[64:67], v[228:231]
    ds_read_b64 v[100:101], v208 offset:2112
    buffer_load_dwordx4 a[92:95], v15, s[44:47], s92 offen offset:3072 sc1
    v_mfma_f32_16x16x32_bf16 v[232:235], v[104:107], v[68:71], v[232:235]
    ds_read_b64 v[102:103], v208 offset:2120
    s_add_u32 s92, s92, 4096
    v_mfma_f32_16x16x32_bf16 v[236:239], v[104:107], v[72:75], v[236:239]
    ds_read_b128 v[128:131], v209 offset:384
    v_mfma_f32_16x16x32_bf16 v[240:243], v[104:107], v[16:19], v[240:243]
    s_waitcnt lgkmcnt(6)
    v_mfma_f32_16x16x32_bf16 v[228:231], v[108:111], v[80:83], v[228:231]
    ds_read_b64 v[104:105], v208 offset:2176
    buffer_load_dwordx4 a[96:99], v15, s[44:47], s92 offen offset:0 sc1
    v_mfma_f32_16x16x32_bf16 v[232:235], v[108:111], v[84:87], v[232:235]
    ds_read_b64 v[106:107], v208 offset:2184
    v_mfma_f32_16x16x32_bf16 v[236:239], v[108:111], v[88:91], v[236:239]
    ds_read_b128 v[16:19], v209 offset:320
    v_mfma_f32_16x16x32_bf16 v[240:243], v[108:111], v[44:47], v[240:243]
    s_waitcnt lgkmcnt(6)
    v_mfma_f32_16x16x32_bf16 v[228:231], v[96:99], v[112:115], v[228:231]
    ds_read_b64 v[108:109], v208 offset:2240
    buffer_load_dwordx4 a[100:103], v15, s[44:47], s92 offen offset:1024 sc1
    v_mfma_f32_16x16x32_bf16 v[232:235], v[96:99], v[116:119], v[232:235]
    ds_read_b64 v[110:111], v208 offset:2248
    v_mfma_f32_16x16x32_bf16 v[236:239], v[96:99], v[120:123], v[236:239]
    ds_read_b128 v[44:47], v209 offset:256
    v_mfma_f32_16x16x32_bf16 v[240:243], v[96:99], v[124:127], v[240:243]
    s_waitcnt lgkmcnt(6)
    v_mfma_f32_16x16x32_bf16 v[228:231], v[100:103], v[128:131], v[228:231]
    ds_read_b64 v[96:97], v208 offset:2304
    buffer_load_dwordx4 a[104:107], v15, s[44:47], s92 offen offset:2048 sc1
    v_mfma_f32_16x16x32_bf16 v[232:235], v[100:103], v[132:135], v[232:235]
    ds_read_b64 v[98:99], v208 offset:2312
    v_mfma_f32_16x16x32_bf16 v[236:239], v[100:103], v[136:139], v[236:239]
    ds_read_b128 v[124:127], v209 offset:192
    v_mfma_f32_16x16x32_bf16 v[240:243], v[100:103], v[140:143], v[240:243]
    s_waitcnt lgkmcnt(6)
    v_mfma_f32_16x16x32_bf16 v[228:231], v[104:107], v[16:19], v[228:231]
    ds_read_b64 v[100:101], v208 offset:2368
    buffer_load_dwordx4 a[108:111], v15, s[44:47], s92 offen offset:3072 sc1
    v_mfma_f32_16x16x32_bf16 v[232:235], v[104:107], v[20:23], v[232:235]
    ds_read_b64 v[102:103], v208 offset:2376
    s_add_u32 s92, s92, 4096
    v_mfma_f32_16x16x32_bf16 v[236:239], v[104:107], v[24:27], v[236:239]
    ds_read_b128 v[140:143], v209 offset:128
    v_mfma_f32_16x16x32_bf16 v[240:243], v[104:107], v[28:31], v[240:243]
    s_waitcnt lgkmcnt(6)
    v_mfma_f32_16x16x32_bf16 v[228:231], v[108:111], v[44:47], v[228:231]
    ds_read_b64 v[104:105], v208 offset:2432
    buffer_load_dwordx4 a[112:115], v15, s[44:47], s92 offen offset:0 sc1
    v_mfma_f32_16x16x32_bf16 v[232:235], v[108:111], v[60:63], v[232:235]
    ds_read_b64 v[106:107], v208 offset:2440
    v_mfma_f32_16x16x32_bf16 v[236:239], v[108:111], v[76:79], v[236:239]
    ds_read_b128 v[28:31], v209 offset:64
    v_mfma_f32_16x16x32_bf16 v[240:243], v[108:111], v[92:95], v[240:243]
    s_waitcnt lgkmcnt(6)
    v_mfma_f32_16x16x32_bf16 v[228:231], v[96:99], v[124:127], v[228:231]
    ds_read_b64 v[108:109], v208 offset:2496
    buffer_load_dwordx4 a[116:119], v15, s[44:47], s92 offen offset:1024 sc1
    v_mfma_f32_16x16x32_bf16 v[232:235], v[96:99], v[32:35], v[232:235]
    ds_read_b64 v[110:111], v208 offset:2504
    v_mfma_f32_16x16x32_bf16 v[236:239], v[96:99], v[36:39], v[236:239]
    ds_read_b128 v[92:95], v209 offset:0
    v_mfma_f32_16x16x32_bf16 v[240:243], v[96:99], v[40:43], v[240:243]
    s_waitcnt lgkmcnt(6)
    v_mfma_f32_16x16x32_bf16 v[228:231], v[100:103], v[140:143], v[228:231]
    ds_read_b64 v[96:97], v208 offset:2560
    buffer_load_dwordx4 a[120:123], v15, s[44:47], s92 offen offset:2048 sc1
    v_mfma_f32_16x16x32_bf16 v[232:235], v[100:103], v[48:51], v[232:235]
    ds_read_b64 v[98:99], v208 offset:2568
    v_mfma_f32_16x16x32_bf16 v[236:239], v[100:103], v[52:55], v[236:239]
    v_mfma_f32_16x16x32_bf16 v[240:243], v[100:103], v[56:59], v[240:243]
    s_waitcnt lgkmcnt(5)
    v_mfma_f32_16x16x32_bf16 v[228:231], v[104:107], v[28:31], v[228:231]
    ds_read_b64 v[100:101], v208 offset:2624
    buffer_load_dwordx4 a[124:127], v15, s[44:47], s92 offen offset:3072 sc1
    v_mfma_f32_16x16x32_bf16 v[232:235], v[104:107], v[64:67], v[232:235]
    ds_read_b64 v[102:103], v208 offset:2632
    s_add_u32 s92, s92, 4096
    v_mfma_f32_16x16x32_bf16 v[236:239], v[104:107], v[68:71], v[236:239]
    v_mfma_f32_16x16x32_bf16 v[240:243], v[104:107], v[72:75], v[240:243]
    s_waitcnt lgkmcnt(4)
    v_mfma_f32_16x16x32_bf16 v[228:231], v[108:111], v[92:95], v[228:231]
    ds_read_b64 v[104:105], v208 offset:2688
    buffer_load_dwordx4 a[128:131], v15, s[44:47], s92 offen offset:0 sc1
    v_mfma_f32_16x16x32_bf16 v[232:235], v[108:111], v[80:83], v[232:235]
    ds_read_b64 v[106:107], v208 offset:2696
    v_mfma_f32_16x16x32_bf16 v[236:239], v[108:111], v[84:87], v[236:239]
    v_mfma_f32_16x16x32_bf16 v[240:243], v[108:111], v[88:91], v[240:243]
    s_waitcnt lgkmcnt(4)
    v_mfma_f32_16x16x32_bf16 v[232:235], v[96:99], v[112:115], v[232:235]
    ds_read_b64 v[108:109], v208 offset:2752
    buffer_load_dwordx4 a[132:135], v15, s[44:47], s92 offen offset:1024 sc1
    v_mfma_f32_16x16x32_bf16 v[236:239], v[96:99], v[116:119], v[236:239]
    ds_read_b64 v[110:111], v208 offset:2760
    v_mfma_f32_16x16x32_bf16 v[240:243], v[96:99], v[120:123], v[240:243]
    s_waitcnt lgkmcnt(4)
    v_mfma_f32_16x16x32_bf16 v[232:235], v[100:103], v[128:131], v[232:235]
    ds_read_b64 v[96:97], v208 offset:2816
    buffer_load_dwordx4 a[136:139], v15, s[44:47], s92 offen offset:2048 sc1
    v_mfma_f32_16x16x32_bf16 v[236:239], v[100:103], v[132:135], v[236:239]
    ds_read_b64 v[98:99], v208 offset:2824
    v_mfma_f32_16x16x32_bf16 v[240:243], v[100:103], v[136:139], v[240:243]
    s_waitcnt lgkmcnt(4)
    v_mfma_f32_16x16x32_bf16 v[232:235], v[104:107], v[16:19], v[232:235]
    ds_read_b64 v[100:101], v208 offset:2880
    buffer_load_dwordx4 a[140:143], v15, s[44:47], s92 offen offset:3072 sc1
    s_add_u32 s92, s92, 4096
    v_mfma_f32_16x16x32_bf16 v[236:239], v[104:107], v[20:23], v[236:239]
    ds_read_b64 v[102:103], v208 offset:2888
    v_cvt_pk_bf16_f32 v244, v228, v229
    v_cvt_pk_bf16_f32 v245, v230, v231
    v_mfma_f32_16x16x32_bf16 v[240:243], v[104:107], v[24:27], v[240:243]
    s_mov_b32 s97, 1310720
    buffer_store_dwordx2 v[244:245], v211, s[84:87], s97 offen sc1
    s_waitcnt lgkmcnt(4)
    v_mfma_f32_16x16x32_bf16 v[232:235], v[108:111], v[44:47], v[232:235]
    ds_read_b64 v[104:105], v208 offset:2944
    buffer_load_dwordx4 a[144:147], v15, s[44:47], s92 offen offset:0 sc1
    v_mfma_f32_16x16x32_bf16 v[236:239], v[108:111], v[60:63], v[236:239]
    ds_read_b64 v[106:107], v208 offset:2952
    v_mfma_f32_16x16x32_bf16 v[240:243], v[108:111], v[76:79], v[240:243]
    s_waitcnt lgkmcnt(4)
    v_mfma_f32_16x16x32_bf16 v[232:235], v[96:99], v[124:127], v[232:235]
    ds_read_b64 v[108:109], v208 offset:3008
    buffer_load_dwordx4 a[148:151], v15, s[44:47], s92 offen offset:1024 sc1
    v_mfma_f32_16x16x32_bf16 v[236:239], v[96:99], v[32:35], v[236:239]
    ds_read_b64 v[110:111], v208 offset:3016
    v_mfma_f32_16x16x32_bf16 v[240:243], v[96:99], v[36:39], v[240:243]
    s_waitcnt lgkmcnt(4)
    v_mfma_f32_16x16x32_bf16 v[232:235], v[100:103], v[140:143], v[232:235]
    ds_read_b64 v[96:97], v208 offset:3072
    buffer_load_dwordx4 a[152:155], v15, s[44:47], s92 offen offset:2048 sc1
    v_mfma_f32_16x16x32_bf16 v[236:239], v[100:103], v[48:51], v[236:239]
    ds_read_b64 v[98:99], v208 offset:3080
    v_mfma_f32_16x16x32_bf16 v[240:243], v[100:103], v[52:55], v[240:243]
    s_waitcnt lgkmcnt(4)
    v_mfma_f32_16x16x32_bf16 v[232:235], v[104:107], v[28:31], v[232:235]
    ds_read_b64 v[100:101], v208 offset:3136
    v_mfma_f32_16x16x32_bf16 v[236:239], v[104:107], v[64:67], v[236:239]
    ds_read_b64 v[102:103], v208 offset:3144
    v_mfma_f32_16x16x32_bf16 v[240:243], v[104:107], v[68:71], v[240:243]
    s_waitcnt lgkmcnt(4)
    v_mfma_f32_16x16x32_bf16 v[232:235], v[108:111], v[92:95], v[232:235]
    ds_read_b64 v[104:105], v208 offset:3200
    v_mfma_f32_16x16x32_bf16 v[236:239], v[108:111], v[80:83], v[236:239]
    ds_read_b64 v[106:107], v208 offset:3208
    v_mfma_f32_16x16x32_bf16 v[240:243], v[108:111], v[84:87], v[240:243]
    s_waitcnt lgkmcnt(4)
    v_mfma_f32_16x16x32_bf16 v[236:239], v[96:99], v[112:115], v[236:239]
    ds_read_b64 v[108:109], v208 offset:3264
    v_mfma_f32_16x16x32_bf16 v[240:243], v[96:99], v[116:119], v[240:243]
    ds_read_b64 v[110:111], v208 offset:3272
    s_waitcnt lgkmcnt(4)
    v_mfma_f32_16x16x32_bf16 v[236:239], v[100:103], v[128:131], v[236:239]
    ds_read_b64 v[96:97], v208 offset:3328
    v_mfma_f32_16x16x32_bf16 v[240:243], v[100:103], v[132:135], v[240:243]
    ds_read_b64 v[98:99], v208 offset:3336
    s_waitcnt lgkmcnt(4)
    v_mfma_f32_16x16x32_bf16 v[236:239], v[104:107], v[16:19], v[236:239]
    ds_read_b64 v[100:101], v208 offset:3392
    v_cvt_pk_bf16_f32 v246, v232, v233
    v_cvt_pk_bf16_f32 v247, v234, v235
    v_mfma_f32_16x16x32_bf16 v[240:243], v[104:107], v[20:23], v[240:243]
    ds_read_b64 v[102:103], v208 offset:3400
    s_mov_b32 s97, 1638400
    buffer_store_dwordx2 v[246:247], v211, s[84:87], s97 offen sc1
    s_waitcnt lgkmcnt(4)
    v_mfma_f32_16x16x32_bf16 v[236:239], v[108:111], v[44:47], v[236:239]
    ds_read_b64 v[104:105], v208 offset:3456
    v_mfma_f32_16x16x32_bf16 v[240:243], v[108:111], v[60:63], v[240:243]
    ds_read_b64 v[106:107], v208 offset:3464
    s_waitcnt lgkmcnt(4)
    v_mfma_f32_16x16x32_bf16 v[236:239], v[96:99], v[124:127], v[236:239]
    ds_read_b64 v[108:109], v208 offset:3520
    v_mfma_f32_16x16x32_bf16 v[240:243], v[96:99], v[32:35], v[240:243]
    ds_read_b64 v[110:111], v208 offset:3528
    s_waitcnt lgkmcnt(4)
    v_mfma_f32_16x16x32_bf16 v[236:239], v[100:103], v[140:143], v[236:239]
    ds_read_b64 v[96:97], v208 offset:3584
    v_mfma_f32_16x16x32_bf16 v[240:243], v[100:103], v[48:51], v[240:243]
    ds_read_b64 v[98:99], v208 offset:3592
    s_waitcnt lgkmcnt(4)
    v_mfma_f32_16x16x32_bf16 v[236:239], v[104:107], v[28:31], v[236:239]
    ds_read_b64 v[100:101], v208 offset:3648
    v_mfma_f32_16x16x32_bf16 v[240:243], v[104:107], v[64:67], v[240:243]
    ds_read_b64 v[102:103], v208 offset:3656
    s_waitcnt lgkmcnt(4)
    v_mfma_f32_16x16x32_bf16 v[236:239], v[108:111], v[92:95], v[236:239]
    ds_read_b64 v[104:105], v208 offset:3712
    v_mfma_f32_16x16x32_bf16 v[240:243], v[108:111], v[80:83], v[240:243]
    ds_read_b64 v[106:107], v208 offset:3720
    s_waitcnt lgkmcnt(4)
    v_mfma_f32_16x16x32_bf16 v[240:243], v[96:99], v[112:115], v[240:243]
    ds_read_b64 v[108:109], v208 offset:3776
    ds_read_b64 v[110:111], v208 offset:3784
    s_waitcnt lgkmcnt(4)
    v_mfma_f32_16x16x32_bf16 v[240:243], v[100:103], v[128:131], v[240:243]
    ds_read_b64 v[96:97], v208 offset:3840
    ds_read_b64 v[98:99], v208 offset:3848
    s_waitcnt lgkmcnt(4)
    v_mfma_f32_16x16x32_bf16 v[240:243], v[104:107], v[16:19], v[240:243]
    ds_read_b64 v[100:101], v208 offset:3904
    ds_read_b64 v[102:103], v208 offset:3912
    s_waitcnt lgkmcnt(4)
    v_mfma_f32_16x16x32_bf16 v[240:243], v[108:111], v[44:47], v[240:243]
    ds_read_b64 v[104:105], v208 offset:3968
    ds_read_b64 v[106:107], v208 offset:3976
    s_waitcnt lgkmcnt(4)
    v_mfma_f32_16x16x32_bf16 v[240:243], v[96:99], v[124:127], v[240:243]
    ds_read_b64 v[108:109], v208 offset:4032
    ds_read_b64 v[110:111], v208 offset:4040
    v_cvt_pk_bf16_f32 v248, v236, v237
    v_cvt_pk_bf16_f32 v249, v238, v239
    s_mov_b32 s97, 1966080
    buffer_store_dwordx2 v[248:249], v211, s[84:87], s97 offen sc1
    s_waitcnt lgkmcnt(4)
    v_mfma_f32_16x16x32_bf16 v[240:243], v[100:103], v[140:143], v[240:243]
    s_waitcnt lgkmcnt(2)
    v_mfma_f32_16x16x32_bf16 v[240:243], v[104:107], v[28:31], v[240:243]
    s_waitcnt lgkmcnt(0)
    v_mfma_f32_16x16x32_bf16 v[240:243], v[108:111], v[92:95], v[240:243]
    s_nop 7
    v_cvt_pk_bf16_f32 v250, v240, v241
    v_cvt_pk_bf16_f32 v251, v242, v243
    s_mov_b32 s97, 2293760
    buffer_store_dwordx2 v[250:251], v211, s[84:87], s97 offen sc1
    s_branch L_gemm1
L_work:
    s_sub_u32 s73, s62, 27
    s_lshl_b32 s73, s73, 3
    s_add_u32 s73, s73, s61
    s_mul_i32 s73, s73, 3
    s_add_u32 s73, s73, s60
    v_and_b32 v1, 3, v0
    v_lshrrev_b32 v2, 2, v0
    v_lshrrev_b32 v3, 4, v0
    v_and_b32 v7, 15, v0
    v_mov_b32 v11, 0x3f803f80
    v_mov_b32 v125, 0x40000000
    v_mov_b32 v4, 0
    s_waitcnt lgkmcnt(0)
    global_load_dword v212, v4, s[34:35] sc1
    s_mul_i32 s20, s60, 20480
    s_add_u32 s20, s20, 81920
    s_mov_b32 s19, 0x40000000
    s_cmp_lt_u32 s73, 112
    s_cbranch_scc1 L_dma1
    s_barrier
    s_branch L_nodma1
L_dma1:
    s_mul_i32 s72, s73, 147
    s_lshr_b32 s72, s72, 10
    s_mul_i32 s72, s72, 13
    s_add_u32 s72, s72, s73
    s_add_u32 s72, s72, 13
    s_mul_i32 s64, s72, 205
    s_lshr_b32 s64, s64, 12
    s_mul_i32 s65, s64, 20
    s_sub_u32 s65, s72, s65
    s_mul_i32 s14, s64, 192
    s_mul_i32 s66, s65, 98304
    s_add_u32 s14, s14, s66
    s_mul_i32 s15, s64, 245760
    s_mul_i32 s66, s65, 3072
    s_add_u32 s15, s15, s66
    s_add_u32 s15, s15, 1048576
    s_mul_i32 s18, s64, 24576
    s_lshl_b32 s66, s65, 6
    s_add_u32 s18, s18, s66
    s_add_u32 s18, s18, 131072
    s_lshl_b32 s19, s72, 6
    s_add_u32 s19, s19, 32768
    s_mov_b32 s48, s24
    s_mov_b32 s49, s25
    s_mov_b32 s50, 0x1e0000
    s_mov_b32 s51, 0x20000
    s_mov_b32 s52, s26
    s_mov_b32 s53, s27
    s_mov_b32 s54, 0x1e0000
    s_mov_b32 s55, 0x20000
    v_add_u32_e64 v4, 0, v0
    v_mul_u32_u24 v5, 171, v4
    v_lshrrev_b32 v5, 11, v5
    v_mul_u32_u24 v6, 12, v5
    v_sub_u32 v4, v4, v6
    v_lshrrev_b32 v6, 1, v5
    v_and_b32 v6, 2, v6
    v_xor_b32 v4, v4, v6
    v_mul_u32_u24 v5, 3072, v5
    v_lshl_add_u32 v120, v4, 4, v5
    v_add_u32 v4, 64, v0
    v_mul_u32_u24 v5, 171, v4
    v_lshrrev_b32 v5, 11, v5
    v_mul_u32_u24 v6, 12, v5
    v_sub_u32 v4, v4, v6
    v_lshrrev_b32 v6, 1, v5
    v_and_b32 v6, 2, v6
    v_xor_b32_e64 v4, v4, v6
    v_mul_u32_u24 v5, 3072, v5
    v_lshl_add_u32 v121, v4, 4, v5
    v_add_u32 v4, 128, v0
    v_mul_u32_u24 v5, 171, v4
    v_lshrrev_b32 v5, 11, v5
    v_mul_u32_u24 v6, 12, v5
    v_sub_u32 v4, v4, v6
    v_lshrrev_b32 v6, 1, v5
    v_and_b32 v6, 2, v6
    v_xor_b32 v4, v4, v6
    v_mul_u32_u24 v5, 3072, v5
    v_lshl_add_u32 v122, v4, 4, v5
    s_barrier
    s_add_u32 m0, s20, 0
    s_nop 0
    buffer_load_dwordx4 v120, s[48:51], s14 offen lds
    s_add_u32 m0, s20, 1024
    s_nop 0
    buffer_load_dwordx4 v121, s[48:51], s14 offen lds
    s_add_u32 m0, s20, 2048
    s_nop 0
    buffer_load_dwordx4 v122, s[48:51], s14 offen lds
    s_add_u32 m0, s20, 6144
    s_nop 0
    buffer_load_dwordx4 v120, s[52:55], s14 offen lds
    s_add_u32 m0, s20, 7168
    s_nop 0
    buffer_load_dwordx4 v121, s[52:55], s14 offen lds
    s_add_u32 m0, s20, 8192
    s_nop 0
    buffer_load_dwordx4 v122, s[52:55], s14 offen lds
    s_add_u32 m0, s20, 3072
    s_add_u32 s14, s14, 49152
    buffer_load_dwordx4 v120, s[48:51], s14 offen lds
    s_add_u32 m0, s20, 4096
    s_nop 0
    buffer_load_dwordx4 v121, s[48:51], s14 offen lds
    s_add_u32 m0, s20, 5120
    s_nop 0
    buffer_load_dwordx4 v122, s[48:51], s14 offen lds
    s_add_u32 m0, s20, 9216
    s_nop 0
    buffer_load_dwordx4 v120, s[52:55], s14 offen lds
    s_add_u32 m0, s20, 10240
    s_nop 0
    buffer_load_dwordx4 v121, s[52:55], s14 offen lds
    s_add_u32 m0, s20, 11264
    s_nop 0
    buffer_load_dwordx4 v122, s[52:55], s14 offen lds
    v_mul_u32_u24 v4, 192, v2
    v_add_u32 v4, s20, v4
    v_and_b32 v5, 1, v3
    v_lshlrev_b32 v5, 5, v5
    v_xor_b32 v6, 32, v5
    v_lshl_add_u32 v134, v1, 3, v4
    v_add_u32 v132, v134, v5
    v_add_u32 v133, v134, v6
    v_and_b32 v134, 1, v1
    v_lshl_add_u32 v4, v134, 3, v4
    v_lshrrev_b32 v134, 1, v1
    v_mul_u32_u24 v134, 6144, v134
    v_add_u32 v4, v4, v134
    v_add_u32 v134, v4, v5
    v_add_u32 v135, v4, v6
    v_lshlrev_b32 v4, 11, v7
    v_lshl_add_u32 v4, v3, 4, v4
    v_cmp_gt_u32 vcc, 12, v7
    v_mov_b32 v5, 0x40000000
    s_nop 0
    v_cndmask_b32 v125, v5, v4, vcc
L_nodma1:
    s_lshr_b32 s64, s61, 1
    s_lshl_b32 s64, s64, 2
    s_lshr_b32 s65, s62, 3
    s_add_u32 s76, s64, s65
    s_and_b32 s64, s61, 1
    s_lshl_b32 s64, s64, 3
    s_and_b32 s80, s62, 7
    s_add_u32 s77, s64, s80
    s_lshl_b32 s64, s61, 1
    s_lshr_b32 s65, s62, 4
    s_add_u32 s78, s64, s65
    s_bfe_u32 s79, s62, 0x10003
    s_mov_b32 s44, s34
    s_mov_b32 s45, s35
    s_mov_b32 s46, 0x11a0000
    s_mov_b32 s47, 0x20000
    s_add_u32 s40, s34, 0x920000
    s_addc_u32 s41, s35, 0
    s_mov_b32 s42, 0x280000
    s_mov_b32 s43, 0x20000
    s_lshl_b32 s64, s77, 2
    s_add_u32 s64, s64, s60
    s_mul_i32 s64, s64, 61440
    s_add_u32 s92, s64, 1048576
    s_waitcnt vmcnt(0)
    v_readfirstlane_b32 s63, v212
    s_nop 1
    s_mul_i32 s63, s63, 0x41c64e6d
    s_add_u32 s63, s63, 0x3c6ef35f
    v_mov_b32_e64 v12, 0x40000000
    v_writelane_b32 v12, 0, 0
    v_mov_b32 v13, s63
    s_cmp_lt_u32 s73, 112
    s_cbranch_scc1 L_job1
    s_barrier
    s_branch L_nojob1
L_job1:
    v_cmp_eq_u32 vcc, 0, v7
    s_nop 1
    v_cndmask_b32 v204, 0, v11, vcc
    v_cndmask_b32 v205, 0, v11, vcc
    v_cndmask_b32 v206, 0, v11, vcc
    v_cndmask_b32 v207, 0, v11, vcc
    ds_read_b64_tr_b16 v[136:137], v132 offset:0
    ds_read_b64_tr_b16 v[138:139], v132 offset:3072
    ds_read_b64_tr_b16 v[140:141], v132 offset:6144
    ds_read_b64_tr_b16 v[142:143], v132 offset:9216
    ds_read_b64_tr_b16 v[144:145], v134 offset:128
    ds_read_b64_tr_b16 v[146:147], v134 offset:3200
    ds_read_b64_tr_b16 v[148:149], v133 offset:0
    ds_read_b64_tr_b16 v[150:151], v133 offset:3072
    ds_read_b64_tr_b16 v[152:153], v133 offset:6144
    ds_read_b64_tr_b16 v[154:155], v133 offset:9216
    ds_read_b64_tr_b16 v[156:157], v134 offset:144
    ds_read_b64_tr_b16 v[158:159], v134 offset:3216
    ds_read_b64_tr_b16 v[160:161], v132 offset:64
    ds_read_b64_tr_b16 v[162:163], v132 offset:3136
    ds_read_b64_tr_b16 v[164:165], v132 offset:6208
    ds_read_b64_tr_b16 v[166:167], v132 offset:9280
    ds_read_b64_tr_b16 v[168:169], v135 offset:128
    ds_read_b64_tr_b16 v[170:171], v135 offset:3200
    ds_read_b64_tr_b16 v[172:173], v133 offset:64
    ds_read_b64_tr_b16 v[174:175], v133 offset:3136
    ds_read_b64_tr_b16 v[176:177], v133 offset:6208
    ds_read_b64_tr_b16 v[178:179], v133 offset:9280
    ds_read_b64_tr_b16 v[180:181], v135 offset:144
    ds_read_b64_tr_b16 v[182:183], v135 offset:3216
    s_waitcnt lgkmcnt(15)
    buffer_store_dwordx4 v[136:139], v15, s[44:47], s15 offen offset:0 sc1
    buffer_store_dwordx4 v[140:143], v15, s[44:47], s15 offen offset:1024 sc1
    buffer_store_dwordx4 v[144:147], v15, s[44:47], s15 offen offset:2048 sc1
    s_waitcnt lgkmcnt(12)
    s_add_u32 s15, s15, 61440
    buffer_store_dwordx4 v[148:151], v15, s[44:47], s15 offen offset:0 sc1
    buffer_store_dwordx4 v[152:155], v15, s[44:47], s15 offen offset:1024 sc1
    buffer_store_dwordx4 v[156:159], v15, s[44:47], s15 offen offset:2048 sc1
    s_waitcnt lgkmcnt(0)
    s_add_u32 s15, s15, 61440
    buffer_store_dwordx4 v[160:163], v15, s[44:47], s15 offen offset:0 sc1
    buffer_store_dwordx4 v[164:167], v15, s[44:47], s15 offen offset:1024 sc1
    buffer_store_dwordx4 v[168:171], v15, s[44:47], s15 offen offset:2048 sc1
    s_waitcnt lgkmcnt(0)
    s_add_u32 s15, s15, 61440
    buffer_store_dwordx4 v[172:175], v15, s[44:47], s15 offen offset:0 sc1
    buffer_store_dwordx4 v[176:179], v15, s[44:47], s15 offen offset:1024 sc1
    buffer_store_dwordx4 v[180:183], v15, s[44:47], s15 offen offset:2048 sc1
    v_mov_b32_dpp v184, v204 row_ror:1 row_mask:0xf bank_mask:0xf
    v_mov_b32_dpp v185, v205 row_ror:1 row_mask:0xf bank_mask:0xf
    v_mov_b32_dpp v186, v206 row_ror:1 row_mask:0xf bank_mask:0xf
    v_mov_b32_dpp v187, v207 row_ror:1 row_mask:0xf bank_mask:0xf
    v_mfma_f32_16x16x32_bf16 v[208:211], v[136:139], v[204:207], 0
    v_mov_b32_dpp v204, v184 row_ror:1 row_mask:0xf bank_mask:0xf
    v_mov_b32_dpp v205, v185 row_ror:1 row_mask:0xf bank_mask:0xf
    v_mov_b32_dpp v206, v186 row_ror:1 row_mask:0xf bank_mask:0xf
    v_mov_b32_dpp v207, v187 row_ror:1 row_mask:0xf bank_mask:0xf
    v_mfma_f32_16x16x32_bf16 v[208:211], v[140:143], v[184:187], v[208:211]
    v_mov_b32_dpp v184, v204 row_ror:1 row_mask:0xf bank_mask:0xf
    v_mov_b32_dpp v185, v205 row_ror:1 row_mask:0xf bank_mask:0xf
    v_mov_b32_dpp v186, v206 row_ror:1 row_mask:0xf bank_mask:0xf
    v_mov_b32_dpp v187, v207 row_ror:1 row_mask:0xf bank_mask:0xf
    v_mfma_f32_16x16x32_bf16 v[208:211], v[144:147], v[204:207], v[208:211]
    v_mov_b32_dpp v204, v184 row_ror:1 row_mask:0xf bank_mask:0xf
    v_mov_b32_dpp v205, v185 row_ror:1 row_mask:0xf bank_mask:0xf
    v_mov_b32_dpp v206, v186 row_ror:1 row_mask:0xf bank_mask:0xf
    v_mov_b32_dpp v207, v187 row_ror:1 row_mask:0xf bank_mask:0xf
    v_mfma_f32_16x16x32_bf16 v[208:211], v[148:151], v[184:187], v[208:211]
    v_mov_b32_dpp v184, v204 row_ror:1 row_mask:0xf bank_mask:0xf
    v_mov_b32_dpp v185, v205 row_ror:1 row_mask:0xf bank_mask:0xf
    v_mov_b32_dpp v186, v206 row_ror:1 row_mask:0xf bank_mask:0xf
    v_mov_b32_dpp v187, v207 row_ror:1 row_mask:0xf bank_mask:0xf
    v_mfma_f32_16x16x32_bf16 v[208:211], v[152:155], v[204:207], v[208:211]
    v_mov_b32_dpp v204, v184 row_ror:1 row_mask:0xf bank_mask:0xf
    v_mov_b32_dpp v205, v185 row_ror:1 row_mask:0xf bank_mask:0xf
    v_mov_b32_dpp v206, v186 row_ror:1 row_mask:0xf bank_mask:0xf
    v_mov_b32_dpp v207, v187 row_ror:1 row_mask:0xf bank_mask:0xf
    v_mfma_f32_16x16x32_bf16 v[208:211], v[156:159], v[184:187], v[208:211]
    v_mov_b32_dpp v184, v204 row_ror:1 row_mask:0xf bank_mask:0xf
    v_mov_b32_dpp v185, v205 row_ror:1 row_mask:0xf bank_mask:0xf
    v_mov_b32_dpp v186, v206 row_ror:1 row_mask:0xf bank_mask:0xf
    v_mov_b32_dpp v187, v207 row_ror:1 row_mask:0xf bank_mask:0xf
    v_mfma_f32_16x16x32_bf16 v[208:211], v[160:163], v[204:207], v[208:211]
    v_mov_b32_dpp v204, v184 row_ror:1 row_mask:0xf bank_mask:0xf
    v_mov_b32_dpp v205, v185 row_ror:1 row_mask:0xf bank_mask:0xf
    v_mov_b32_dpp v206, v186 row_ror:1 row_mask:0xf bank_mask:0xf
    v_mov_b32_dpp v207, v187 row_ror:1 row_mask:0xf bank_mask:0xf
    v_mfma_f32_16x16x32_bf16 v[208:211], v[164:167], v[184:187], v[208:211]
    v_mov_b32_dpp v184, v204 row_ror:1 row_mask:0xf bank_mask:0xf
    v_mov_b32_dpp v185, v205 row_ror:1 row_mask:0xf bank_mask:0xf
    v_mov_b32_dpp v186, v206 row_ror:1 row_mask:0xf bank_mask:0xf
    v_mov_b32_dpp v187, v207 row_ror:1 row_mask:0xf bank_mask:0xf
    v_mfma_f32_16x16x32_bf16 v[208:211], v[168:171], v[204:207], v[208:211]
    v_mov_b32_dpp v204, v184 row_ror:1 row_mask:0xf bank_mask:0xf
    v_mov_b32_dpp v205, v185 row_ror:1 row_mask:0xf bank_mask:0xf
    v_mov_b32_dpp v206, v186 row_ror:1 row_mask:0xf bank_mask:0xf
    v_mov_b32_dpp v207, v187 row_ror:1 row_mask:0xf bank_mask:0xf
    v_mfma_f32_16x16x32_bf16 v[208:211], v[172:175], v[184:187], v[208:211]
    v_mov_b32_dpp v184, v204 row_ror:1 row_mask:0xf bank_mask:0xf
    v_mov_b32_dpp v185, v205 row_ror:1 row_mask:0xf bank_mask:0xf
    v_mov_b32_dpp v186, v206 row_ror:1 row_mask:0xf bank_mask:0xf
    v_mov_b32_dpp v187, v207 row_ror:1 row_mask:0xf bank_mask:0xf
    v_mfma_f32_16x16x32_bf16 v[208:211], v[176:179], v[204:207], v[208:211]
    s_nop 0
    v_mfma_f32_16x16x32_bf16 v[208:211], v[180:183], v[184:187], v[208:211]
    s_nop 7
    buffer_store_dwordx4 v[208:211], v125, s[44:47], s18 offen sc1
    s_mov_b32 s19, 0x40000000
    s_waitcnt vmcnt(0)
    s_barrier
L_nojob1:
    s_cmp_lt_u32 s73, 96
    s_cbranch_scc1 L_nojob2
    s_add_u32 s67, s73, 120
    s_mul_i32 s64, s67, 205
    s_lshr_b32 s64, s64, 10
    s_mul_i32 s65, s64, 5
    s_sub_u32 s65, s67, s65
    s_mul_i32 s14, s64, 40960
    s_lshl_b32 s66, s65, 8
    s_add_u32 s14, s14, s66
    s_mul_i32 s15, s64, 5120
    s_add_u32 s15, s15, 4980736
    s_lshl_b32 s18, s65, 3
    s_lshl_b32 s21, s67, 6
    s_add_u32 s21, s21, 73728
    s_mov_b32 s48, s28
    s_mov_b32 s49, s29
    s_mov_b32 s50, 0x1e0000
    s_mov_b32 s51, 0x20000
    v_lshrrev_b32 v4, 4, v0
    v_and_b32 v5, 15, v0
    v_lshlrev_b32 v6, 1, v4
    v_xor_b32_e64 v5, v5, v6
    v_mul_u32_u24 v4, 1280, v4
    v_lshl_add_u32 v120, v5, 4, v4
    v_xor_b32_e64 v5, 8, v5
    v_lshl_add_u32 v121, v5, 4, v4
    v_add_u32 v121, 5120, v121
    s_add_u32 m0, s20, 0
    s_nop 0
    buffer_load_dwordx4 v120, s[48:51], s14 offen lds
    s_add_u32 m0, s20, 1024
    s_nop 0
    buffer_load_dwordx4 v121, s[48:51], s14 offen lds
    s_add_u32 m0, s20, 2048
    s_add_u32 s14, s14, 10240
    buffer_load_dwordx4 v120, s[48:51], s14 offen lds
    s_add_u32 m0, s20, 3072
    s_nop 0
    buffer_load_dwordx4 v121, s[48:51], s14 offen lds
    s_add_u32 m0, s20, 4096
    s_add_u32 s14, s14, 10240
    buffer_load_dwordx4 v120, s[48:51], s14 offen lds
    s_add_u32 m0, s20, 5120
    s_nop 0
    s_nop 0
    buffer_load_dwordx4 v121, s[48:51], s14 offen lds
    s_add_u32 m0, s20, 6144
    s_add_u32 s14, s14, 10240
    buffer_load_dwordx4 v120, s[48:51], s14 offen lds
    s_add_u32 m0, s20, 7168
    s_nop 0
    buffer_load_dwordx4 v121, s[48:51], s14 offen lds
    s_waitcnt vmcnt(0)
    buffer_store_dword v13, v12, s[44:47], s19 offen sc1
    v_lshrrev_b32 v48, 2, v0
    v_and_b32 v49, 7, v48
    v_lshlrev_b32 v48, 8, v48
    v_lshl_add_u32 v48, v49, 5, v48
    v_and_b32 v49, 3, v0
    v_lshl_add_u32 v48, v49, 3, v48
    v_xor_b32 v49, 0, v48
    v_add_u32 v49, s20, v49
    ds_read_b64_tr_b16 v[16:17], v49
    ds_read_b64_tr_b16 v[18:19], v49 offset:4096
    v_xor_b32 v49, 32, v48
    v_add_u32 v49, s20, v49
    ds_read_b64_tr_b16 v[20:21], v49
    ds_read_b64_tr_b16 v[22:23], v49 offset:4096
    v_xor_b32 v49, 64, v48
    v_add_u32 v49, s20, v49
    ds_read_b64_tr_b16 v[24:25], v49
    ds_read_b64_tr_b16 v[26:27], v49 offset:4096
    v_xor_b32 v49, 96, v48
    v_add_u32_e64 v49, s20, v49
    ds_read_b64_tr_b16 v[28:29], v49
    ds_read_b64_tr_b16 v[30:31], v49 offset:4096
    v_xor_b32 v49, 128, v48
    v_add_u32_e64 v49, s20, v49
    ds_read_b64_tr_b16 v[32:33], v49
    ds_read_b64_tr_b16 v[34:35], v49 offset:4096
    v_xor_b32 v49, 160, v48
    v_add_u32_e64 v49, s20, v49
    ds_read_b64_tr_b16 v[36:37], v49
    ds_read_b64_tr_b16 v[38:39], v49 offset:4096
    v_xor_b32 v49, 192, v48
    v_add_u32_e64 v49, s20, v49
    ds_read_b64_tr_b16 v[40:41], v49
    ds_read_b64_tr_b16 v[42:43], v49 offset:4096
    v_xor_b32 v49, 224, v48
    v_add_u32_e64 v49, s20, v49
    ds_read_b64_tr_b16 v[44:45], v49
    ds_read_b64_tr_b16 v[46:47], v49 offset:4096
    s_add_u32 s64, s18, 0
    s_mul_i32 s65, s64, 52
    s_lshr_b32 s65, s65, 8
    s_mul_i32 s65, s65, 240640
    s_lshl_b32 s64, s64, 10
    s_add_u32 s64, s64, s65
    s_add_u32 s64, s64, s15
    s_waitcnt lgkmcnt(8)
    buffer_store_dwordx4 v[16:19], v15, s[44:47], s64 offen sc1
    s_add_u32 s64, s18, 1
    s_mul_i32 s65, s64, 52
    s_lshr_b32 s65, s65, 8
    s_mul_i32 s65, s65, 240640
    s_lshl_b32 s64, s64, 10
    s_add_u32 s64, s64, s65
    s_add_u32 s64, s64, s15
    buffer_store_dwordx4 v[20:23], v15, s[44:47], s64 offen sc1
    s_add_u32 s64, s18, 2
    s_mul_i32 s65, s64, 52
    s_lshr_b32 s65, s65, 8
    s_mul_i32 s65, s65, 240640
    s_lshl_b32 s64, s64, 10
    s_add_u32 s64, s64, s65
    s_add_u32 s64, s64, s15
    buffer_store_dwordx4 v[24:27], v15, s[44:47], s64 offen sc1
    s_add_u32 s64, s18, 3
    s_mul_i32 s65, s64, 52
    s_lshr_b32 s65, s65, 8
    s_mul_i32 s65, s65, 240640
    s_lshl_b32 s64, s64, 10
    s_add_u32 s64, s64, s65
    s_add_u32 s64, s64, s15
    buffer_store_dwordx4 v[28:31], v15, s[44:47], s64 offen sc1
    s_add_u32 s64, s18, 4
    s_mul_i32 s65, s64, 52
    s_lshr_b32 s65, s65, 8
    s_mul_i32 s65, s65, 240640
    s_lshl_b32 s64, s64, 10
    s_add_u32 s64, s64, s65
    s_add_u32 s64, s64, s15
    s_waitcnt lgkmcnt(0)
    buffer_store_dwordx4 v[32:35], v15, s[44:47], s64 offen sc1
    s_add_u32 s64, s18, 5
    s_mul_i32 s65, s64, 52
    s_lshr_b32 s65, s65, 8
    s_mul_i32 s65, s65, 240640
    s_lshl_b32 s64, s64, 10
    s_add_u32 s64, s64, s65
    s_add_u32 s64, s64, s15
    buffer_store_dwordx4 v[36:39], v15, s[44:47], s64 offen sc1
    s_add_u32 s64, s18, 6
    s_mul_i32 s65, s64, 52
    s_lshr_b32 s65, s65, 8
    s_mul_i32 s65, s65, 240640
    s_lshl_b32 s64, s64, 10
    s_add_u32 s64, s64, s65
    s_add_u32 s64, s64, s15
    buffer_store_dwordx4 v[40:43], v15, s[44:47], s64 offen sc1
    s_add_u32 s64, s18, 7
    s_mul_i32 s65, s64, 52
    s_lshr_b32 s65, s65, 8
    s_mul_i32 s65, s65, 240640
    s_lshl_b32 s64, s64, 10
    s_add_u32 s64, s64, s65
    s_add_u32 s64, s64, s15
    buffer_store_dwordx4 v[44:47], v15, s[44:47], s64 offen sc1
    s_mov_b32 s19, s21
L_nojob2:
L_jobs_done:
    s_mul_i32 s64, s77, 1280
    s_add_u32 s64, s64, 32768
    v_min_u32 v1, 12, v0
    v_lshl_add_u32 v1, v1, 6, s64
    buffer_load_dword v2, v1, s[44:47], 0 offen sc1
    s_waitcnt vmcnt(0)
    buffer_store_dword v13, v12, s[44:47], s19 offen sc1
    s_waitcnt vmcnt(1)
    v_cmp_ne_u32 vcc, s63, v2
    s_cbranch_vccz L_pdone_5
    s_mov_b32 s82, 0
L_poll_4:
    buffer_load_dword v2, v1, s[44:47], 0 offen sc1
    s_waitcnt vmcnt(0)
    v_cmp_ne_u32 vcc, s63, v2
    s_cbranch_vccz L_pdone_5
    s_add_u32 s82, s82, 1
    s_cmp_lt_u32 s82, 400000
    s_cbranch_scc1 L_poll_4
L_pdone_5:
    buffer_load_dwordx4 a[0:3], v15, s[44:47], s92 offen offset:0 sc1
    buffer_load_dwordx4 a[4:7], v15, s[44:47], s92 offen offset:1024 sc1
    buffer_load_dwordx4 a[8:11], v15, s[44:47], s92 offen offset:2048 sc1
    buffer_load_dwordx4 a[12:15], v15, s[44:47], s92 offen offset:3072 sc1
    s_add_u32 s92, s92, 4096
    buffer_load_dwordx4 a[16:19], v15, s[44:47], s92 offen offset:0 sc1
    buffer_load_dwordx4 a[20:23], v15, s[44:47], s92 offen offset:1024 sc1
    buffer_load_dwordx4 a[24:27], v15, s[44:47], s92 offen offset:2048 sc1
    buffer_load_dwordx4 a[28:31], v15, s[44:47], s92 offen offset:3072 sc1
    s_add_u32 s92, s92, 4096
    s_branch L_gsetup
L_aux:
    s_mov_b32 s20, 10240
    s_mov_b32 s19, 0x40000000
    s_cmp_lt_u32 s62, 27
    s_cbranch_scc1 L_aux_j
    v_mov_b32_e64 v4, 0x40000000
    buffer_load_dword v214, v4, s[36:39], 0 offen
    buffer_load_dword v214, v4, s[36:39], 0 offen
    buffer_load_dword v214, v4, s[36:39], 0 offen
    buffer_load_dword v214, v4, s[36:39], 0 offen
    buffer_load_dword v214, v4, s[36:39], 0 offen
    buffer_load_dword v214, v4, s[36:39], 0 offen
    buffer_load_dword v214, v4, s[36:39], 0 offen
    buffer_load_dword v214, v4, s[36:39], 0 offen
    buffer_load_dword v214, v4, s[36:39], 0 offen
    buffer_load_dword v214, v4, s[36:39], 0 offen
    buffer_load_dword v214, v4, s[36:39], 0 offen
    buffer_load_dword v214, v4, s[36:39], 0 offen
    s_branch L_aux_nj
L_aux_j:
    s_min_u32 s67, s2, 207
    s_mul_i32 s68, s67, 79
    s_lshr_b32 s68, s68, 10
    s_mul_i32 s68, s68, 7
    s_add_u32 s67, s67, s68
    s_mul_i32 s64, s67, 205
    s_lshr_b32 s64, s64, 12
    s_mul_i32 s65, s64, 20
    s_sub_u32 s65, s67, s65
    s_mul_i32 s14, s64, 192
    s_mul_i32 s66, s65, 98304
    s_add_u32 s14, s14, s66
    s_mul_i32 s15, s64, 245760
    s_mul_i32 s66, s65, 3072
    s_add_u32 s15, s15, s66
    s_add_u32 s15, s15, 1048576
    s_mul_i32 s18, s64, 24576
    s_lshl_b32 s66, s65, 6
    s_add_u32 s18, s18, s66
    s_add_u32 s18, s18, 131072
    s_lshl_b32 s19, s67, 6
    s_add_u32 s19, s19, 32768
    s_mov_b32 s48, s24
    s_mov_b32 s49, s25
    s_mov_b32 s50, 0x1e0000
    s_mov_b32 s51, 0x20000
    s_mov_b32 s52, s26
    s_mov_b32 s53, s27
    s_mov_b32 s54, 0x1e0000
    s_mov_b32 s55, 0x20000
    v_add_u32 v4, 0, v0
    v_mul_u32_u24 v5, 171, v4
    v_lshrrev_b32 v5, 11, v5
    v_mul_u32_u24 v6, 12, v5
    v_sub_u32 v4, v4, v6
    v_lshrrev_b32 v6, 1, v5
    v_and_b32 v6, 2, v6
    v_xor_b32 v4, v4, v6
    v_mul_u32_u24 v5, 3072, v5
    v_lshl_add_u32 v120, v4, 4, v5
    v_add_u32 v4, 64, v0
    v_mul_u32_u24 v5, 171, v4
    v_lshrrev_b32 v5, 11, v5
    v_mul_u32_u24 v6, 12, v5
    v_sub_u32 v4, v4, v6
    v_lshrrev_b32 v6, 1, v5
    v_and_b32 v6, 2, v6
    v_xor_b32 v4, v4, v6
    v_mul_u32_u24 v5, 3072, v5
    v_lshl_add_u32 v121, v4, 4, v5
    v_add_u32 v4, 128, v0
    v_mul_u32_u24 v5, 171, v4
    v_lshrrev_b32 v5, 11, v5
    v_mul_u32_u24 v6, 12, v5
    v_sub_u32 v4, v4, v6
    v_lshrrev_b32 v6, 1, v5
    v_and_b32 v6, 2, v6
    v_xor_b32 v4, v4, v6
    v_mul_u32_u24 v5, 3072, v5
    v_lshl_add_u32 v122, v4, 4, v5
    s_add_u32 m0, s20, 0
    s_nop 0
    buffer_load_dwordx4 v120, s[48:51], s14 offen lds
    s_add_u32 m0, s20, 1024
    s_nop 0
    buffer_load_dwordx4 v121, s[48:51], s14 offen lds
    s_add_u32 m0, s20, 2048
    s_nop 0
    buffer_load_dwordx4 v122, s[48:51], s14 offen lds
    s_add_u32 m0, s20, 6144
    s_nop 0
    buffer_load_dwordx4 v120, s[52:55], s14 offen lds
    s_add_u32 m0, s20, 7168
    s_nop 0
    buffer_load_dwordx4 v121, s[52:55], s14 offen lds
    s_add_u32 m0, s20, 8192
    s_nop 0
    buffer_load_dwordx4 v122, s[52:55], s14 offen lds
    s_add_u32 m0, s20, 3072
    s_add_u32 s14, s14, 49152
    buffer_load_dwordx4 v120, s[48:51], s14 offen lds
    s_add_u32 m0, s20, 4096
    s_nop 0
    buffer_load_dwordx4 v121, s[48:51], s14 offen lds
    s_add_u32 m0, s20, 5120
    s_nop 0
    buffer_load_dwordx4 v122, s[48:51], s14 offen lds
    s_add_u32 m0, s20, 9216
    s_nop 0
    buffer_load_dwordx4 v120, s[52:55], s14 offen lds
    s_add_u32 m0, s20, 10240
    s_nop 0
    buffer_load_dwordx4 v121, s[52:55], s14 offen lds
    s_add_u32 m0, s20, 11264
    s_nop 0
    buffer_load_dwordx4 v122, s[52:55], s14 offen lds
L_aux_nj:
    s_lshr_b32 s64, s61, 1
    s_lshl_b32 s64, s64, 2
    s_lshr_b32 s65, s62, 3
    s_add_u32 s76, s64, s65
    s_and_b32 s64, s61, 1
    s_lshl_b32 s64, s64, 3
    s_and_b32 s80, s62, 7
    s_add_u32 s77, s64, s80
    s_lshl_b32 s64, s61, 1
    s_lshr_b32 s65, s62, 4
    s_add_u32 s78, s64, s65
    s_bfe_u32 s79, s62, 0x10003
    s_mov_b32 s44, s34
    s_mov_b32 s45, s35
    s_mov_b32 s46, 0x11a0000
    s_mov_b32 s47, 0x20000
    s_add_u32 s40, s34, 0x920000
    s_addc_u32 s41, s35, 0
    s_mov_b32 s42, 0x280000
    s_mov_b32 s43, 0x20000
    s_lshl_b32 s64, s77, 2
    s_add_u32 s64, s64, s60
    s_mul_i32 s64, s64, 61440
    s_add_u32 s92, s64, 1048576
    s_min_u32 s64, s62, 26
    s_mul_i32 s64, s64, 3
    s_mul_i32 s65, s61, 80
    s_add_u32 s64, s64, s65
    s_lshl_b32 s64, s64, 12
    s_add_u32 s73, s64, 6946816
    v_and_b32 v1, 3, v0
    v_lshrrev_b32 v2, 2, v0
    v_lshrrev_b32 v3, 4, v0
    v_and_b32 v7, 15, v0
    v_mul_u32_u24 v4, 192, v2
    v_add_u32 v4, s20, v4
    v_and_b32 v5, 1, v3
    v_lshlrev_b32 v5, 5, v5
    v_xor_b32 v6, 32, v5
    v_lshl_add_u32 v134, v1, 3, v4
    v_add_u32 v132, v134, v5
    v_add_u32 v133, v134, v6
    v_and_b32 v134, 1, v1
    v_lshl_add_u32 v4, v134, 3, v4
    v_lshrrev_b32 v134, 1, v1
    v_mul_u32_u24 v134, 6144, v134
    v_add_u32 v4, v4, v134
    v_add_u32 v134, v4, v5
    v_add_u32 v135, v4, v6
    v_lshlrev_b32 v4, 11, v7
    v_lshl_add_u32 v4, v3, 4, v4
    v_cmp_gt_u32 vcc, 12, v7
    v_mov_b32 v5, 0x40000000
    s_nop 0
    v_cndmask_b32 v125, v5, v4, vcc
    v_and_b32 v4, 3, v2
    v_lshl_add_u32 v5, v3, 3, 3
    v_sub_u32 v4, v5, v4
    v_mul_u32_u24 v4, 320, v4
    v_lshl_add_u32 v4, v1, 3, v4
    v_add_u32 v4, 0, v4
    v_and_b32 v5, 1, v3
    v_lshlrev_b32 v5, 5, v5
    v_xor_b32 v6, 32, v5
    v_add_u32 v8, v4, v5
    v_add_u32 v9, v4, v6
    v_lshlrev_b32 v10, 12, v7
    v_lshl_add_u32 v10, v3, 4, v10
    v_mov_b32 v11, 0x3f803f80
    v_mov_b32 v4, 0
    v_mov_b32 v5, 0
    v_mov_b32 v6, 0
    v_mov_b32 v213, 0
    s_waitcnt vmcnt(23)
    ds_read_b64_tr_b16 v[56:57], v8 offset:1280
    ds_read_b64_tr_b16 v[58:59], v8 offset:0
    ds_read_b64_tr_b16 v[60:61], v9 offset:1280
    ds_read_b64_tr_b16 v[62:63], v9 offset:0
    ds_read_b64_tr_b16 v[64:65], v8 offset:1344
    ds_read_b64_tr_b16 v[66:67], v8 offset:64
    ds_read_b64_tr_b16 v[68:69], v9 offset:1344
    ds_read_b64_tr_b16 v[70:71], v9 offset:64
    ds_read_b64_tr_b16 v[72:73], v8 offset:1408
    ds_read_b64_tr_b16 v[74:75], v8 offset:128
    ds_read_b64_tr_b16 v[76:77], v9 offset:1408
    ds_read_b64_tr_b16 v[78:79], v9 offset:128
    ds_read_b64_tr_b16 v[80:81], v8 offset:1472
    ds_read_b64_tr_b16 v[82:83], v8 offset:192
    ds_read_b64_tr_b16 v[84:85], v9 offset:1472
    ds_read_b64_tr_b16 v[86:87], v9 offset:192
    ds_read_b64_tr_b16 v[88:89], v8 offset:1536
    ds_read_b64_tr_b16 v[90:91], v8 offset:256
    ds_read_b64_tr_b16 v[92:93], v9 offset:1536
    ds_read_b64_tr_b16 v[94:95], v9 offset:256
    s_waitcnt lgkmcnt(14)
    buffer_store_dwordx4 v[56:59], v10, s[44:47], s72 offen sc1
    s_add_u32 s72, s72, 65536
    buffer_store_dwordx4 v[60:63], v10, s[44:47], s72 offen sc1
    s_add_u32 s72, s72, 65536
    buffer_store_dwordx4 v[64:67], v10, s[44:47], s72 offen sc1
    s_add_u32 s72, s72, 65536
    s_waitcnt lgkmcnt(8)
    buffer_store_dwordx4 v[68:71], v10, s[44:47], s72 offen sc1
    s_add_u32 s72, s72, 65536
    buffer_store_dwordx4 v[72:75], v10, s[44:47], s72 offen sc1
    s_add_u32 s72, s72, 65536
    buffer_store_dwordx4 v[76:79], v10, s[44:47], s72 offen sc1
    s_add_u32 s72, s72, 65536
    s_waitcnt lgkmcnt(0)
    buffer_store_dwordx4 v[80:83], v10, s[44:47], s72 offen sc1
    s_nop 0
    s_add_u32 s72, s72, 65536
    buffer_store_dwordx4 v[84:87], v10, s[44:47], s72 offen sc1
    s_add_u32 s72, s72, 65536
    buffer_store_dwordx4 v[88:91], v10, s[44:47], s72 offen sc1
    s_add_u32 s72, s72, 65536
    buffer_store_dwordx4 v[92:95], v10, s[44:47], s72 offen sc1
    s_cmp_lt_u32 s62, 27
    s_cbranch_scc1 L_aux_nb
    s_barrier
L_aux_nb:
    s_waitcnt vmcnt(22)
    v_dot2c_f32_bf16 v4, v16, v11
    v_dot2c_f32_bf16 v6, v16, v16
    v_dot2c_f32_bf16 v5, v17, v11
    v_dot2c_f32_bf16 v213, v17, v17
    v_dot2c_f32_bf16 v4, v18, v11
    v_dot2c_f32_bf16 v6, v18, v18
    v_dot2c_f32_bf16 v5, v19, v11
    v_dot2c_f32_bf16 v213, v19, v19
    v_dot2c_f32_bf16 v4, v20, v11
    v_dot2c_f32_bf16 v6, v20, v20
    v_dot2c_f32_bf16 v5, v21, v11
    v_dot2c_f32_bf16 v213, v21, v21
    v_dot2c_f32_bf16 v4, v22, v11
    v_dot2c_f32_bf16 v6, v22, v22
    v_dot2c_f32_bf16 v5, v23, v11
    v_dot2c_f32_bf16 v213, v23, v23
    v_dot2c_f32_bf16 v4, v24, v11
    v_dot2c_f32_bf16 v6, v24, v24
    v_dot2c_f32_bf16 v5, v25, v11
    v_dot2c_f32_bf16 v213, v25, v25
    v_dot2c_f32_bf16 v4, v26, v11
    v_dot2c_f32_bf16 v6, v26, v26
    v_dot2c_f32_bf16 v5, v27, v11
    v_dot2c_f32_bf16 v213, v27, v27
    v_dot2c_f32_bf16 v4, v28, v11
    v_dot2c_f32_bf16 v6, v28, v28
    v_dot2c_f32_bf16 v5, v29, v11
    v_dot2c_f32_bf16 v213, v29, v29
    v_dot2c_f32_bf16 v4, v30, v11
    v_dot2c_f32_bf16 v6, v30, v30
    v_dot2c_f32_bf16 v5, v31, v11
    v_dot2c_f32_bf16 v213, v31, v31
    v_dot2c_f32_bf16 v4, v32, v11
    v_dot2c_f32_bf16 v6, v32, v32
    v_dot2c_f32_bf16 v5, v33, v11
    v_dot2c_f32_bf16 v213, v33, v33
    v_dot2c_f32_bf16 v4, v34, v11
    v_dot2c_f32_bf16 v6, v34, v34
    v_dot2c_f32_bf16 v5, v35, v11
    v_dot2c_f32_bf16 v213, v35, v35
    v_dot2c_f32_bf16 v4, v36, v11
    v_dot2c_f32_bf16 v6, v36, v36
    v_dot2c_f32_bf16 v5, v37, v11
    v_dot2c_f32_bf16 v213, v37, v37
    v_dot2c_f32_bf16 v4, v38, v11
    v_dot2c_f32_bf16 v6, v38, v38
    v_dot2c_f32_bf16 v5, v39, v11
    v_dot2c_f32_bf16 v213, v39, v39
    v_dot2c_f32_bf16 v4, v40, v11
    v_dot2c_f32_bf16 v6, v40, v40
    v_dot2c_f32_bf16 v5, v41, v11
    v_dot2c_f32_bf16 v213, v41, v41
    v_dot2c_f32_bf16 v4, v42, v11
    v_dot2c_f32_bf16 v6, v42, v42
    v_dot2c_f32_bf16 v5, v43, v11
    v_dot2c_f32_bf16 v213, v43, v43
    v_dot2c_f32_bf16 v4, v44, v11
    v_dot2c_f32_bf16 v6, v44, v44
    v_dot2c_f32_bf16 v5, v45, v11
    v_dot2c_f32_bf16 v213, v45, v45
    v_dot2c_f32_bf16 v4, v46, v11
    v_dot2c_f32_bf16 v6, v46, v46
    v_dot2c_f32_bf16 v5, v47, v11
    v_dot2c_f32_bf16 v213, v47, v47
    v_dot2c_f32_bf16 v4, v48, v11
    v_dot2c_f32_bf16 v6, v48, v48
    v_dot2c_f32_bf16 v5, v49, v11
    v_dot2c_f32_bf16 v213, v49, v49
    v_dot2c_f32_bf16 v4, v50, v11
    v_dot2c_f32_bf16 v6, v50, v50
    v_dot2c_f32_bf16 v5, v51, v11
    v_dot2c_f32_bf16 v213, v51, v51
    v_dot2c_f32_bf16 v4, v52, v11
    v_dot2c_f32_bf16 v6, v52, v52
    v_dot2c_f32_bf16 v5, v53, v11
    v_dot2c_f32_bf16 v213, v53, v53
    v_dot2c_f32_bf16 v4, v54, v11
    v_dot2c_f32_bf16 v6, v54, v54
    v_dot2c_f32_bf16 v5, v55, v11
    v_dot2c_f32_bf16 v213, v55, v55
    v_readfirstlane_b32 s63, v212
    s_nop 1
    s_mul_i32 s63, s63, 0x41c64e6d
    s_add_u32 s63, s63, 0x3c6ef35f
    s_nop 0
    v_add_f32 v4, v4, v5
    v_add_f32 v6, v6, v213
    s_nop 0
    v_add_f32_dpp v4, v4, v4 quad_perm:[1,0,3,2] row_mask:0xf bank_mask:0xf
    v_add_f32_dpp v6, v6, v6 quad_perm:[1,0,3,2] row_mask:0xf bank_mask:0xf
    s_nop 0
    v_add_f32_dpp v4, v4, v4 quad_perm:[2,3,0,1] row_mask:0xf bank_mask:0xf
    v_add_f32_dpp v6, v6, v6 quad_perm:[2,3,0,1] row_mask:0xf bank_mask:0xf
    s_nop 0
    v_add_f32_dpp v4, v4, v4 row_half_mirror row_mask:0xf bank_mask:0xf
    v_add_f32_dpp v6, v6, v6 row_half_mirror row_mask:0xf bank_mask:0xf
    v_mul_f32 v4, 0x3acccccd, v4
    v_mul_f32 v6, 0x3acccccd, v6
    v_fma_f32 v6, -v4, v4, v6
    v_max_f32_e64 v6, 0, v6
    v_cvt_pk_bf16_f32 v6, v6, v6
    v_and_b32 v6, s83, v6
    v_add_f32 v6, 0x3727c5ac, v6
    v_cvt_pk_bf16_f32 v6, v6, v6
    v_and_b32 v6, s83, v6
    v_sqrt_f32 v6, v6
    v_cvt_pk_bf16_f32 v4, v4, v4
    v_and_b32 v4, s83, v4
    v_cvt_pk_bf16_f32 v6, v6, v6
    v_and_b32 v6, s83, v6
    v_rcp_f32 v6, v6
    s_cmp_eq_u32 s60, 3
    s_cselect_b32 s64, 0, 0x40000000
    v_mov_b32 v12, 0x40000000
    v_writelane_b32 v12, s64, 0
    v_mov_b32 v13, s63
    v_mov_b32_dpp v16, v6 row_shl:8 row_mask:0xf bank_mask:0xf
    v_mov_b32_dpp v5, v4 row_shl:8 row_mask:0xf bank_mask:0xf
    v_mov_b32 v17, v6
    v_mov_b32 v19, s63
    v_lshrrev_b32 v5, 16, v5
    v_or_b32 v18, v4, v5
    s_and_b32 s64, s2, 3
    s_lshl_b32 s64, s64, 12
    s_lshr_b32 s65, s2, 2
    s_lshl_b32 s65, s65, 6
    s_add_u32 s64, s64, s65
    s_add_u32 s72, s64, 4096
    v_cmp_eq_u32 vcc, 0, v7
    v_mov_b32 v4, 0x40000000
    s_nop 0
    v_cndmask_b32 v20, v4, v0, vcc
    s_waitcnt vmcnt(0)
    buffer_store_dwordx4 v[16:19], v20, s[44:47], s72 offen sc1
    s_cmp_lt_u32 s62, 27
    s_cbranch_scc1 L_aux_conv
    s_barrier
    s_lshl_b32 s72, s2, 4
    s_add_u32 s72, s72, 65536
    buffer_store_dword v13, v12, s[44:47], s72 offen sc1
    s_add_u32 s72, s72, 4096
    buffer_store_dword v13, v12, s[44:47], s72 offen sc1
    s_branch L_jobs_done
L_aux_conv:
    v_cmp_eq_u32 vcc, 0, v7
    s_nop 1
    v_cndmask_b32 v204, 0, v11, vcc
    v_cndmask_b32 v205, 0, v11, vcc
    v_cndmask_b32 v206, 0, v11, vcc
    v_cndmask_b32_e64 v207, 0, v11, vcc
    ds_read_b64_tr_b16 v[136:137], v132 offset:0
    ds_read_b64_tr_b16 v[138:139], v132 offset:3072
    ds_read_b64_tr_b16 v[140:141], v132 offset:6144
    ds_read_b64_tr_b16 v[142:143], v132 offset:9216
    ds_read_b64_tr_b16 v[144:145], v134 offset:128
    ds_read_b64_tr_b16 v[146:147], v134 offset:3200
    ds_read_b64_tr_b16 v[148:149], v133 offset:0
    ds_read_b64_tr_b16 v[150:151], v133 offset:3072
    ds_read_b64_tr_b16 v[152:153], v133 offset:6144
    ds_read_b64_tr_b16 v[154:155], v133 offset:9216
    ds_read_b64_tr_b16 v[156:157], v134 offset:144
    ds_read_b64_tr_b16 v[158:159], v134 offset:3216
    ds_read_b64_tr_b16 v[160:161], v132 offset:64
    ds_read_b64_tr_b16 v[162:163], v132 offset:3136
    ds_read_b64_tr_b16 v[164:165], v132 offset:6208
    ds_read_b64_tr_b16 v[166:167], v132 offset:9280
    ds_read_b64_tr_b16 v[168:169], v135 offset:128
    ds_read_b64_tr_b16 v[170:171], v135 offset:3200
    ds_read_b64_tr_b16 v[172:173], v133 offset:64
    ds_read_b64_tr_b16 v[174:175], v133 offset:3136
    ds_read_b64_tr_b16 v[176:177], v133 offset:6208
    ds_read_b64_tr_b16 v[178:179], v133 offset:9280
    ds_read_b64_tr_b16 v[180:181], v135 offset:144
    ds_read_b64_tr_b16 v[182:183], v135 offset:3216
    s_waitcnt lgkmcnt(15)
    buffer_store_dwordx4 v[136:139], v15, s[44:47], s15 offen offset:0 sc1
    buffer_store_dwordx4 v[140:143], v15, s[44:47], s15 offen offset:1024 sc1
    buffer_store_dwordx4 v[144:147], v15, s[44:47], s15 offen offset:2048 sc1
    s_waitcnt lgkmcnt(12)
    s_add_u32 s15, s15, 61440
    buffer_store_dwordx4 v[148:151], v15, s[44:47], s15 offen offset:0 sc1
    buffer_store_dwordx4 v[152:155], v15, s[44:47], s15 offen offset:1024 sc1
    buffer_store_dwordx4 v[156:159], v15, s[44:47], s15 offen offset:2048 sc1
    s_waitcnt lgkmcnt(0)
    s_add_u32 s15, s15, 61440
    buffer_store_dwordx4 v[160:163], v15, s[44:47], s15 offen offset:0 sc1
    buffer_store_dwordx4 v[164:167], v15, s[44:47], s15 offen offset:1024 sc1
    buffer_store_dwordx4 v[168:171], v15, s[44:47], s15 offen offset:2048 sc1
    s_waitcnt lgkmcnt(0)
    s_add_u32 s15, s15, 61440
    buffer_store_dwordx4 v[172:175], v15, s[44:47], s15 offen offset:0 sc1
    buffer_store_dwordx4 v[176:179], v15, s[44:47], s15 offen offset:1024 sc1
    buffer_store_dwordx4 v[180:183], v15, s[44:47], s15 offen offset:2048 sc1
    v_mov_b32_dpp v184, v204 row_ror:1 row_mask:0xf bank_mask:0xf
    v_mov_b32_dpp v185, v205 row_ror:1 row_mask:0xf bank_mask:0xf
    v_mov_b32_dpp v186, v206 row_ror:1 row_mask:0xf bank_mask:0xf
    v_mov_b32_dpp v187, v207 row_ror:1 row_mask:0xf bank_mask:0xf
    v_mfma_f32_16x16x32_bf16 v[208:211], v[136:139], v[204:207], 0
    v_mov_b32_dpp v204, v184 row_ror:1 row_mask:0xf bank_mask:0xf
    v_mov_b32_dpp v205, v185 row_ror:1 row_mask:0xf bank_mask:0xf
    v_mov_b32_dpp v206, v186 row_ror:1 row_mask:0xf bank_mask:0xf
    v_mov_b32_dpp v207, v187 row_ror:1 row_mask:0xf bank_mask:0xf
    v_mfma_f32_16x16x32_bf16 v[208:211], v[140:143], v[184:187], v[208:211]
    v_mov_b32_dpp v184, v204 row_ror:1 row_mask:0xf bank_mask:0xf
    v_mov_b32_dpp v185, v205 row_ror:1 row_mask:0xf bank_mask:0xf
    v_mov_b32_dpp v186, v206 row_ror:1 row_mask:0xf bank_mask:0xf
    v_mov_b32_dpp v187, v207 row_ror:1 row_mask:0xf bank_mask:0xf
    v_mfma_f32_16x16x32_bf16 v[208:211], v[144:147], v[204:207], v[208:211]
    v_mov_b32_dpp v204, v184 row_ror:1 row_mask:0xf bank_mask:0xf
    v_mov_b32_dpp v205, v185 row_ror:1 row_mask:0xf bank_mask:0xf
    v_mov_b32_dpp v206, v186 row_ror:1 row_mask:0xf bank_mask:0xf
    v_mov_b32_dpp v207, v187 row_ror:1 row_mask:0xf bank_mask:0xf
    v_mfma_f32_16x16x32_bf16 v[208:211], v[148:151], v[184:187], v[208:211]
    v_mov_b32_dpp v184, v204 row_ror:1 row_mask:0xf bank_mask:0xf
    v_mov_b32_dpp v185, v205 row_ror:1 row_mask:0xf bank_mask:0xf
    v_mov_b32_dpp v186, v206 row_ror:1 row_mask:0xf bank_mask:0xf
    v_mov_b32_dpp v187, v207 row_ror:1 row_mask:0xf bank_mask:0xf
    v_mfma_f32_16x16x32_bf16 v[208:211], v[152:155], v[204:207], v[208:211]
    v_mov_b32_dpp v204, v184 row_ror:1 row_mask:0xf bank_mask:0xf
    v_mov_b32_dpp v205, v185 row_ror:1 row_mask:0xf bank_mask:0xf
    v_mov_b32_dpp v206, v186 row_ror:1 row_mask:0xf bank_mask:0xf
    v_mov_b32_dpp v207, v187 row_ror:1 row_mask:0xf bank_mask:0xf
    v_mfma_f32_16x16x32_bf16 v[208:211], v[156:159], v[184:187], v[208:211]
    v_mov_b32_dpp v184, v204 row_ror:1 row_mask:0xf bank_mask:0xf
    v_mov_b32_dpp v185, v205 row_ror:1 row_mask:0xf bank_mask:0xf
    v_mov_b32_dpp v186, v206 row_ror:1 row_mask:0xf bank_mask:0xf
    v_mov_b32_dpp v187, v207 row_ror:1 row_mask:0xf bank_mask:0xf
    v_mfma_f32_16x16x32_bf16 v[208:211], v[160:163], v[204:207], v[208:211]
    v_mov_b32_dpp v204, v184 row_ror:1 row_mask:0xf bank_mask:0xf
    v_mov_b32_dpp v205, v185 row_ror:1 row_mask:0xf bank_mask:0xf
    v_mov_b32_dpp v206, v186 row_ror:1 row_mask:0xf bank_mask:0xf
    v_mov_b32_dpp v207, v187 row_ror:1 row_mask:0xf bank_mask:0xf
    v_mfma_f32_16x16x32_bf16 v[208:211], v[164:167], v[184:187], v[208:211]
    v_mov_b32_dpp v184, v204 row_ror:1 row_mask:0xf bank_mask:0xf
    v_mov_b32_dpp v185, v205 row_ror:1 row_mask:0xf bank_mask:0xf
    v_mov_b32_dpp v186, v206 row_ror:1 row_mask:0xf bank_mask:0xf
    v_mov_b32_dpp v187, v207 row_ror:1 row_mask:0xf bank_mask:0xf
    v_mfma_f32_16x16x32_bf16 v[208:211], v[168:171], v[204:207], v[208:211]
    v_mov_b32_dpp v204, v184 row_ror:1 row_mask:0xf bank_mask:0xf
    v_mov_b32_dpp v205, v185 row_ror:1 row_mask:0xf bank_mask:0xf
    v_mov_b32_dpp v206, v186 row_ror:1 row_mask:0xf bank_mask:0xf
    v_mov_b32_dpp v207, v187 row_ror:1 row_mask:0xf bank_mask:0xf
    v_mfma_f32_16x16x32_bf16 v[208:211], v[172:175], v[184:187], v[208:211]
    v_mov_b32_dpp v184, v204 row_ror:1 row_mask:0xf bank_mask:0xf
    v_mov_b32_dpp v185, v205 row_ror:1 row_mask:0xf bank_mask:0xf
    v_mov_b32_dpp v186, v206 row_ror:1 row_mask:0xf bank_mask:0xf
    v_mov_b32_dpp v187, v207 row_ror:1 row_mask:0xf bank_mask:0xf
    v_mfma_f32_16x16x32_bf16 v[208:211], v[176:179], v[204:207], v[208:211]
    s_nop 0
    v_mfma_f32_16x16x32_bf16 v[208:211], v[180:183], v[184:187], v[208:211]
    s_nop 7
    buffer_store_dwordx4 v[208:211], v125, s[44:47], s18 offen sc1
    s_mov_b32 s64, 4096
    s_mov_b32 s65, 8192
    s_mov_b32 s66, 12288
    s_mov_b32 s67, 16384
    buffer_load_dwordx4 v[56:59], v15, s[44:47], s64 offen offset:0 sc1
    buffer_load_dwordx4 v[60:63], v15, s[44:47], s65 offen offset:0 sc1
    buffer_load_dwordx4 v[64:67], v15, s[44:47], s66 offen offset:0 sc1
    buffer_load_dwordx4 v[68:71], v15, s[44:47], s67 offen offset:0 sc1
    buffer_load_dwordx4 v[72:75], v15, s[44:47], s64 offen offset:1024 sc1
    buffer_load_dwordx4 v[76:79], v15, s[44:47], s65 offen offset:1024 sc1
    buffer_load_dwordx4 v[80:83], v15, s[44:47], s66 offen offset:1024 sc1
    buffer_load_dwordx4 v[84:87], v15, s[44:47], s67 offen offset:1024 sc1
    s_waitcnt vmcnt(8)
    buffer_store_dword v13, v12, s[44:47], s19 offen sc1
    s_waitcnt vmcnt(1)
    v_and_b32 v4, v59, v63
    v_or_b32 v5, v59, v63
    v_bitop3_b32 v4, v4, v67, v71 bitop3:0x80
    v_or3_b32 v5, v5, v67, v71
    v_bitop3_b32 v4, v4, v75, v79 bitop3:0x80
    v_or3_b32 v5, v5, v75, v79
    v_bitop3_b32 v4, v4, v83, v87 bitop3:0x80
    v_or3_b32 v5, v5, v83, v87
    v_xor_b32 v4, s63, v4
    v_xor_b32 v5, s63, v5
    v_or_b32 v4, v4, v5
    v_cmp_ne_u32 vcc, 0, v4
    s_cbranch_vccz L_pdone_7
    s_mov_b32 s82, 0
L_poll_6:
    buffer_load_dwordx4 v[56:59], v15, s[44:47], s64 offen offset:0 sc1
    buffer_load_dwordx4 v[60:63], v15, s[44:47], s65 offen offset:0 sc1
    buffer_load_dwordx4 v[64:67], v15, s[44:47], s66 offen offset:0 sc1
    buffer_load_dwordx4 v[68:71], v15, s[44:47], s67 offen offset:0 sc1
    buffer_load_dwordx4 v[72:75], v15, s[44:47], s64 offen offset:1024 sc1
    buffer_load_dwordx4 v[76:79], v15, s[44:47], s65 offen offset:1024 sc1
    buffer_load_dwordx4 v[80:83], v15, s[44:47], s66 offen offset:1024 sc1
    buffer_load_dwordx4 v[84:87], v15, s[44:47], s67 offen offset:1024 sc1
    s_waitcnt vmcnt(0)
    v_and_b32 v4, v59, v63
    v_or_b32_e64 v5, v59, v63
    v_bitop3_b32 v4, v4, v67, v71 bitop3:0x80
    v_or3_b32 v5, v5, v67, v71
    v_bitop3_b32 v4, v4, v75, v79 bitop3:0x80
    v_or3_b32 v5, v5, v75, v79
    v_bitop3_b32 v4, v4, v83, v87 bitop3:0x80
    v_or3_b32 v5, v5, v83, v87
    v_xor_b32 v4, s63, v4
    v_xor_b32 v5, s63, v5
    v_or_b32 v4, v4, v5
    v_cmp_ne_u32 vcc, 0, v4
    s_cbranch_vccz L_pdone_7
    s_add_u32 s82, s82, 1
    s_cmp_lt_u32 s82, 400000
    s_cbranch_scc1 L_poll_6
L_pdone_7:
    s_add_u32 s72, s73, 0
    s_mov_b32 m0, 151008
    s_nop 0
    buffer_load_dwordx4 v15, s[44:47], s72 offen sc1 lds
    s_add_u32 s72, s73, 1024
    s_mov_b32 m0, 152032
    s_nop 0
    buffer_load_dwordx4 v15, s[44:47], s72 offen sc1 lds
    s_add_u32 s72, s73, 4096
    s_mov_b32 m0, 155168
    s_nop 0
    buffer_load_dwordx4 v15, s[44:47], s72 offen sc1 lds
    s_add_u32 s72, s73, 5120
    s_mov_b32 m0, 156192
    s_nop 0
    buffer_load_dwordx4 v15, s[44:47], s72 offen sc1 lds
    s_add_u32 s72, s73, 8192
    s_mov_b32 m0, 159328
    s_nop 0
    buffer_load_dwordx4 v15, s[44:47], s72 offen sc1 lds
    s_add_u32 s72, s73, 9216
    s_mov_b32 m0, 160352
    s_nop 0
    buffer_load_dwordx4 v15, s[44:47], s72 offen sc1 lds
    buffer_load_dwordx4 v[88:91], v15, s[44:47], s64 offen offset:2048 sc1
    buffer_load_dwordx4 v[92:95], v15, s[44:47], s65 offen offset:2048 sc1
    buffer_load_dwordx4 v[96:99], v15, s[44:47], s66 offen offset:2048 sc1
    buffer_load_dwordx4 v[100:103], v15, s[44:47], s67 offen offset:2048 sc1
    buffer_load_dwordx4 v[104:107], v15, s[44:47], s64 offen offset:3072 sc1
    buffer_load_dwordx4 v[108:111], v15, s[44:47], s65 offen offset:3072 sc1
    buffer_load_dwordx4 v[112:115], v15, s[44:47], s66 offen offset:3072 sc1
    buffer_load_dwordx4 v[116:119], v15, s[44:47], s67 offen offset:3072 sc1
    v_lshlrev_b32 v4, 16, v58
    v_and_b32 v5, s83, v58
    v_pk_mul_f32 v[58:59], v[4:5], v[56:57] neg_lo:[1,0] neg_hi:[1,0]
    v_lshlrev_b32 v4, 16, v62
    v_and_b32 v5, s83, v62
    v_pk_mul_f32 v[62:63], v[4:5], v[60:61] neg_lo:[1,0] neg_hi:[1,0]
    v_lshlrev_b32 v4, 16, v66
    v_and_b32 v5, s83, v66
    v_pk_mul_f32 v[66:67], v[4:5], v[64:65] neg_lo:[1,0] neg_hi:[1,0]
    v_lshlrev_b32 v4, 16, v70
    v_and_b32 v5, s83, v70
    v_pk_mul_f32 v[70:71], v[4:5], v[68:69] neg_lo:[1,0] neg_hi:[1,0]
    v_lshlrev_b32 v4, 16, v74
    v_and_b32 v5, s83, v74
    v_pk_mul_f32 v[74:75], v[4:5], v[72:73] neg_lo:[1,0] neg_hi:[1,0]
    v_lshlrev_b32 v4, 16, v78
    v_and_b32 v5, s83, v78
    v_pk_mul_f32 v[78:79], v[4:5], v[76:77] neg_lo:[1,0] neg_hi:[1,0]
    v_lshlrev_b32 v4, 16, v82
    v_and_b32 v5, s83, v82
    v_pk_mul_f32 v[82:83], v[4:5], v[80:81] neg_lo:[1,0] neg_hi:[1,0]
    v_lshlrev_b32 v4, 16, v86
    v_and_b32 v5, s83, v86
    v_pk_mul_f32 v[86:87], v[4:5], v[84:85] neg_lo:[1,0] neg_hi:[1,0]
    v_add_u32 v8, 151008, v15
    v_add_u32 v9, 137664, v15
    s_waitcnt vmcnt(8)
    ds_read_b128 v[16:19], v8 offset:0
    s_nop 0
    ds_read_b128 v[20:23], v8 offset:4160
    ds_read_b128 v[24:27], v8 offset:8320
    ds_read_b128 v[28:31], v8 offset:1024
    ds_read_b128 v[32:35], v8 offset:5184
    ds_read_b128 v[36:39], v8 offset:9344
    s_waitcnt lgkmcnt(4)
    v_lshlrev_b32 v216, 16, v16
    v_and_b32 v217, s83, v16
    v_lshlrev_b32 v218, 16, v17
    v_and_b32 v219, s83, v17
    v_lshlrev_b32 v220, 16, v18
    v_and_b32 v221, s83, v18
    v_lshlrev_b32 v222, 16, v19
    v_and_b32_e64 v223, s83, v19
    v_pk_fma_f32 v[216:217], v[216:217], v[68:69], v[70:71]
    v_pk_fma_f32 v[218:219], v[218:219], v[64:65], v[66:67]
    v_pk_fma_f32 v[220:221], v[220:221], v[60:61], v[62:63]
    v_pk_fma_f32 v[222:223], v[222:223], v[56:57], v[58:59]
    v_cvt_pk_bf16_f32 v232, v216, v217
    v_cvt_pk_bf16_f32 v233, v218, v219
    v_cvt_pk_bf16_f32 v234, v220, v221
    v_cvt_pk_bf16_f32 v235, v222, v223
    ds_write_b128 v9, v[232:235] offset:0
    v_lshlrev_b32 v224, 16, v20
    v_and_b32 v225, s83, v20
    v_lshlrev_b32 v226, 16, v21
    v_and_b32 v227, s83, v21
    v_lshlrev_b32 v228, 16, v22
    v_and_b32 v229, s83, v22
    v_lshlrev_b32 v230, 16, v23
    v_and_b32 v231, s83, v23
    v_pk_fma_f32 v[224:225], v[224:225], v[68:69], v[70:71]
    v_pk_fma_f32 v[226:227], v[226:227], v[64:65], v[66:67]
    v_pk_fma_f32 v[228:229], v[228:229], v[60:61], v[62:63]
    v_pk_fma_f32 v[230:231], v[230:231], v[56:57], v[58:59]
    v_cvt_pk_bf16_f32 v236, v224, v225
    v_cvt_pk_bf16_f32 v237, v226, v227
    v_cvt_pk_bf16_f32 v238, v228, v229
    v_cvt_pk_bf16_f32 v239, v230, v231
    ds_write_b128 v9, v[236:239] offset:4608
    s_waitcnt lgkmcnt(2)
    v_lshlrev_b32 v216, 16, v24
    v_and_b32 v217, s83, v24
    v_lshlrev_b32 v218, 16, v25
    v_and_b32 v219, s83, v25
    v_lshlrev_b32 v220, 16, v26
    v_and_b32 v221, s83, v26
    v_lshlrev_b32 v222, 16, v27
    v_and_b32_e64 v223, s83, v27
    v_pk_fma_f32 v[216:217], v[216:217], v[68:69], v[70:71]
    v_pk_fma_f32 v[218:219], v[218:219], v[64:65], v[66:67]
    v_pk_fma_f32 v[220:221], v[220:221], v[60:61], v[62:63]
    v_pk_fma_f32 v[222:223], v[222:223], v[56:57], v[58:59]
    v_cvt_pk_bf16_f32 v232, v216, v217
    v_cvt_pk_bf16_f32 v233, v218, v219
    v_cvt_pk_bf16_f32 v234, v220, v221
    v_cvt_pk_bf16_f32 v235, v222, v223
    ds_write_b128 v9, v[232:235] offset:9216
    v_lshlrev_b32 v224, 16, v28
    v_and_b32 v225, s83, v28
    v_lshlrev_b32 v226, 16, v29
    v_and_b32 v227, s83, v29
    v_lshlrev_b32 v228, 16, v30
    v_and_b32 v229, s83, v30
    v_lshlrev_b32 v230, 16, v31
    v_and_b32 v231, s83, v31
    v_pk_fma_f32 v[224:225], v[224:225], v[84:85], v[86:87]
    v_pk_fma_f32 v[226:227], v[226:227], v[80:81], v[82:83]
    v_pk_fma_f32 v[228:229], v[228:229], v[76:77], v[78:79]
    v_pk_fma_f32 v[230:231], v[230:231], v[72:73], v[74:75]
    v_cvt_pk_bf16_f32 v236, v224, v225
    v_cvt_pk_bf16_f32 v237, v226, v227
    v_cvt_pk_bf16_f32 v238, v228, v229
    v_cvt_pk_bf16_f32 v239, v230, v231
    ds_write_b128 v9, v[236:239] offset:1024
    v_lshlrev_b32 v216, 16, v32
    v_and_b32 v217, s83, v32
    v_lshlrev_b32 v218, 16, v33
    v_and_b32 v219, s83, v33
    v_lshlrev_b32 v220, 16, v34
    v_and_b32 v221, s83, v34
    v_lshlrev_b32 v222, 16, v35
    v_and_b32 v223, s83, v35
    v_pk_fma_f32 v[216:217], v[216:217], v[84:85], v[86:87]
    v_pk_fma_f32 v[218:219], v[218:219], v[80:81], v[82:83]
    v_pk_fma_f32 v[220:221], v[220:221], v[76:77], v[78:79]
    v_pk_fma_f32 v[222:223], v[222:223], v[72:73], v[74:75]
    v_cvt_pk_bf16_f32 v232, v216, v217
    v_cvt_pk_bf16_f32 v233, v218, v219
    v_cvt_pk_bf16_f32 v234, v220, v221
    v_cvt_pk_bf16_f32 v235, v222, v223
    ds_write_b128 v9, v[232:235] offset:5632
    v_lshlrev_b32 v224, 16, v36
    v_and_b32 v225, s83, v36
    v_lshlrev_b32 v226, 16, v37
    v_and_b32 v227, s83, v37
    v_lshlrev_b32 v228, 16, v38
    v_and_b32 v229, s83, v38
    v_lshlrev_b32 v230, 16, v39
    v_and_b32 v231, s83, v39
    v_pk_fma_f32 v[224:225], v[224:225], v[84:85], v[86:87]
    v_pk_fma_f32 v[226:227], v[226:227], v[80:81], v[82:83]
    v_pk_fma_f32 v[228:229], v[228:229], v[76:77], v[78:79]
    v_pk_fma_f32 v[230:231], v[230:231], v[72:73], v[74:75]
    v_cvt_pk_bf16_f32 v236, v224, v225
    v_cvt_pk_bf16_f32 v237, v226, v227
    v_cvt_pk_bf16_f32 v238, v228, v229
    v_cvt_pk_bf16_f32 v239, v230, v231
    ds_write_b128 v9, v[236:239] offset:10240
    s_waitcnt lgkmcnt(0)
    s_barrier
    s_waitcnt vmcnt(0)
    v_and_b32 v4, v91, v95
    v_or_b32_e64 v5, v91, v95
    v_bitop3_b32 v4, v4, v99, v103 bitop3:0x80
    v_or3_b32 v5, v5, v99, v103
    v_bitop3_b32 v4, v4, v107, v111 bitop3:0x80
    v_or3_b32 v5, v5, v107, v111
    v_bitop3_b32 v4, v4, v115, v119 bitop3:0x80
    v_or3_b32 v5, v5, v115, v119
    v_xor_b32 v4, s63, v4
    v_xor_b32 v5, s63, v5
    v_or_b32 v4, v4, v5
    v_cmp_ne_u32 vcc, 0, v4
    s_cbranch_vccz L_pdone_9
    s_mov_b32 s82, 0
L_poll_8:
    buffer_load_dwordx4 v[88:91], v15, s[44:47], s64 offen offset:2048 sc1
    buffer_load_dwordx4 v[92:95], v15, s[44:47], s65 offen offset:2048 sc1
    buffer_load_dwordx4 v[96:99], v15, s[44:47], s66 offen offset:2048 sc1
    buffer_load_dwordx4 v[100:103], v15, s[44:47], s67 offen offset:2048 sc1
    buffer_load_dwordx4 v[104:107], v15, s[44:47], s64 offen offset:3072 sc1
    buffer_load_dwordx4 v[108:111], v15, s[44:47], s65 offen offset:3072 sc1
    buffer_load_dwordx4 v[112:115], v15, s[44:47], s66 offen offset:3072 sc1
    buffer_load_dwordx4 v[116:119], v15, s[44:47], s67 offen offset:3072 sc1
    s_waitcnt vmcnt(0)
    v_and_b32 v4, v91, v95
    v_or_b32_e64 v5, v91, v95
    v_bitop3_b32 v4, v4, v99, v103 bitop3:0x80
    v_or3_b32 v5, v5, v99, v103
    v_bitop3_b32 v4, v4, v107, v111 bitop3:0x80
    v_or3_b32 v5, v5, v107, v111
    v_bitop3_b32 v4, v4, v115, v119 bitop3:0x80
    v_or3_b32 v5, v5, v115, v119
    v_xor_b32 v4, s63, v4
    v_xor_b32 v5, s63, v5
    v_or_b32 v4, v4, v5
    v_cmp_ne_u32 vcc, 0, v4
    s_cbranch_vccz L_pdone_9
    s_add_u32 s82, s82, 1
    s_cmp_lt_u32 s82, 400000
    s_cbranch_scc1 L_poll_8
L_pdone_9:
    s_add_u32 s72, s73, 2048
    s_mov_b32 m0, 153056
    s_nop 0
    buffer_load_dwordx4 v15, s[44:47], s72 offen sc1 lds
    s_add_u32 s72, s73, 3072
    s_mov_b32 m0, 154080
    s_nop 0
    buffer_load_dwordx4 v15, s[44:47], s72 offen sc1 lds
    s_add_u32 s72, s73, 6144
    s_mov_b32 m0, 157216
    s_nop 0
    buffer_load_dwordx4 v15, s[44:47], s72 offen sc1 lds
    s_add_u32 s72, s73, 7168
    s_mov_b32 m0, 158240
    s_nop 0
    buffer_load_dwordx4 v15, s[44:47], s72 offen sc1 lds
    s_add_u32 s72, s73, 10240
    s_mov_b32 m0, 161376
    s_nop 0
    buffer_load_dwordx4 v15, s[44:47], s72 offen sc1 lds
    s_add_u32 s72, s73, 11264
    s_mov_b32 m0, 162400
    s_nop 0
    buffer_load_dwordx4 v15, s[44:47], s72 offen sc1 lds
    s_mul_i32 s64, s77, 1280
    s_add_u32 s64, s64, 32768
    v_min_u32 v1, 12, v0
    v_lshl_add_u32 v1, v1, 6, s64
    buffer_load_dword v2, v1, s[44:47], 0 offen sc1
    s_mov_b32 s20, 22528
    s_mul_i32 s64, s2, 205
    s_lshr_b32 s64, s64, 10
    s_mul_i32 s65, s64, 5
    s_sub_u32 s65, s2, s65
    s_mul_i32 s14, s64, 40960
    s_lshl_b32 s66, s65, 8
    s_add_u32 s14, s14, s66
    s_mul_i32 s15, s64, 5120
    s_add_u32 s15, s15, 4980736
    s_lshl_b32 s18, s65, 3
    s_lshl_b32 s21, s2, 6
    s_add_u32 s21, s21, 73728
    s_mov_b32 s48, s28
    s_mov_b32 s49, s29
    s_mov_b32 s50, 0x1e0000
    s_mov_b32 s51, 0x20000
    v_lshrrev_b32 v4, 4, v0
    v_and_b32 v5, 15, v0
    v_lshlrev_b32 v6, 1, v4
    v_xor_b32 v5, v5, v6
    v_mul_u32_u24 v4, 1280, v4
    v_lshl_add_u32 v120, v5, 4, v4
    v_xor_b32 v5, 8, v5
    v_lshl_add_u32 v121, v5, 4, v4
    v_add_u32 v121, 5120, v121
    s_add_u32 m0, s20, 0
    s_nop 0
    buffer_load_dwordx4 v120, s[48:51], s14 offen lds
    s_add_u32 m0, s20, 1024
    s_nop 0
    buffer_load_dwordx4 v121, s[48:51], s14 offen lds
    s_add_u32 m0, s20, 2048
    s_add_u32 s14, s14, 10240
    buffer_load_dwordx4 v120, s[48:51], s14 offen lds
    s_add_u32 m0, s20, 3072
    s_nop 0
    buffer_load_dwordx4 v121, s[48:51], s14 offen lds
    s_add_u32 m0, s20, 4096
    s_add_u32 s14, s14, 10240
    buffer_load_dwordx4 v120, s[48:51], s14 offen lds
    s_add_u32 m0, s20, 5120
    s_nop 0
    buffer_load_dwordx4 v121, s[48:51], s14 offen lds
    s_add_u32 m0, s20, 6144
    s_add_u32 s14, s14, 10240
    buffer_load_dwordx4 v120, s[48:51], s14 offen lds
    s_add_u32 m0, s20, 7168
    s_nop 0
    buffer_load_dwordx4 v121, s[48:51], s14 offen lds
    v_lshlrev_b32 v4, 16, v90
    v_and_b32 v5, s83, v90
    v_pk_mul_f32 v[90:91], v[4:5], v[88:89] neg_lo:[1,0] neg_hi:[1,0]
    v_lshlrev_b32 v4, 16, v94
    v_and_b32 v5, s83, v94
    v_pk_mul_f32 v[94:95], v[4:5], v[92:93] neg_lo:[1,0] neg_hi:[1,0]
    v_lshlrev_b32 v4, 16, v98
    v_and_b32 v5, s83, v98
    v_pk_mul_f32 v[98:99], v[4:5], v[96:97] neg_lo:[1,0] neg_hi:[1,0]
    v_lshlrev_b32 v4, 16, v102
    v_and_b32 v5, s83, v102
    v_pk_mul_f32 v[102:103], v[4:5], v[100:101] neg_lo:[1,0] neg_hi:[1,0]
    v_lshlrev_b32 v4, 16, v106
    v_and_b32 v5, s83, v106
    v_pk_mul_f32 v[106:107], v[4:5], v[104:105] neg_lo:[1,0] neg_hi:[1,0]
    v_lshlrev_b32 v4, 16, v110
    v_and_b32 v5, s83, v110
    v_pk_mul_f32 v[110:111], v[4:5], v[108:109] neg_lo:[1,0] neg_hi:[1,0]
    v_lshlrev_b32 v4, 16, v114
    v_and_b32 v5, s83, v114
    v_pk_mul_f32 v[114:115], v[4:5], v[112:113] neg_lo:[1,0] neg_hi:[1,0]
    v_lshlrev_b32 v4, 16, v118
    v_and_b32 v5, s83, v118
    v_pk_mul_f32 v[118:119], v[4:5], v[116:117] neg_lo:[1,0] neg_hi:[1,0]
    s_waitcnt vmcnt(9)
    s_nop 0
    ds_read_b128 v[16:19], v8 offset:2048
    ds_read_b128 v[20:23], v8 offset:6208
    ds_read_b128 v[24:27], v8 offset:10368
    ds_read_b128 v[28:31], v8 offset:3072
    ds_read_b128 v[32:35], v8 offset:7232
    ds_read_b128 v[36:39], v8 offset:11392
    s_waitcnt lgkmcnt(4)
    v_lshlrev_b32 v216, 16, v16
    v_and_b32 v217, s83, v16
    v_lshlrev_b32 v218, 16, v17
    v_and_b32 v219, s83, v17
    v_lshlrev_b32 v220, 16, v18
    v_and_b32 v221, s83, v18
    v_lshlrev_b32 v222, 16, v19
    v_and_b32_e64 v223, s83, v19
    v_pk_fma_f32 v[216:217], v[216:217], v[100:101], v[102:103]
    v_pk_fma_f32 v[218:219], v[218:219], v[96:97], v[98:99]
    v_pk_fma_f32 v[220:221], v[220:221], v[92:93], v[94:95]
    v_pk_fma_f32 v[222:223], v[222:223], v[88:89], v[90:91]
    v_cvt_pk_bf16_f32 v232, v216, v217
    v_cvt_pk_bf16_f32 v233, v218, v219
    v_cvt_pk_bf16_f32 v234, v220, v221
    v_cvt_pk_bf16_f32 v235, v222, v223
    ds_write_b128 v9, v[232:235] offset:2048
    v_lshlrev_b32 v224, 16, v20
    v_and_b32 v225, s83, v20
    v_lshlrev_b32 v226, 16, v21
    v_and_b32 v227, s83, v21
    v_lshlrev_b32 v228, 16, v22
    v_and_b32 v229, s83, v22
    v_lshlrev_b32 v230, 16, v23
    v_and_b32 v231, s83, v23
    v_pk_fma_f32 v[224:225], v[224:225], v[100:101], v[102:103]
    v_pk_fma_f32 v[226:227], v[226:227], v[96:97], v[98:99]
    v_pk_fma_f32 v[228:229], v[228:229], v[92:93], v[94:95]
    v_pk_fma_f32 v[230:231], v[230:231], v[88:89], v[90:91]
    v_cvt_pk_bf16_f32 v236, v224, v225
    v_cvt_pk_bf16_f32 v237, v226, v227
    v_cvt_pk_bf16_f32 v238, v228, v229
    v_cvt_pk_bf16_f32 v239, v230, v231
    ds_write_b128 v9, v[236:239] offset:6656
    s_waitcnt lgkmcnt(2)
    v_lshlrev_b32 v216, 16, v24
    v_and_b32 v217, s83, v24
    v_lshlrev_b32 v218, 16, v25
    v_and_b32 v219, s83, v25
    v_lshlrev_b32 v220, 16, v26
    v_and_b32 v221, s83, v26
    v_lshlrev_b32 v222, 16, v27
    v_and_b32_e64 v223, s83, v27
    v_pk_fma_f32 v[216:217], v[216:217], v[100:101], v[102:103]
    v_pk_fma_f32 v[218:219], v[218:219], v[96:97], v[98:99]
    v_pk_fma_f32 v[220:221], v[220:221], v[92:93], v[94:95]
    v_pk_fma_f32 v[222:223], v[222:223], v[88:89], v[90:91]
    v_cvt_pk_bf16_f32 v232, v216, v217
    v_cvt_pk_bf16_f32 v233, v218, v219
    v_cvt_pk_bf16_f32 v234, v220, v221
    v_cvt_pk_bf16_f32 v235, v222, v223
    ds_write_b128 v9, v[232:235] offset:11264
    v_lshlrev_b32 v224, 16, v28
    v_and_b32 v225, s83, v28
    v_lshlrev_b32 v226, 16, v29
    v_and_b32 v227, s83, v29
    v_lshlrev_b32 v228, 16, v30
    v_and_b32 v229, s83, v30
    v_lshlrev_b32 v230, 16, v31
    v_and_b32 v231, s83, v31
    v_pk_fma_f32 v[224:225], v[224:225], v[116:117], v[118:119]
    v_pk_fma_f32 v[226:227], v[226:227], v[112:113], v[114:115]
    v_pk_fma_f32 v[228:229], v[228:229], v[108:109], v[110:111]
    v_pk_fma_f32 v[230:231], v[230:231], v[104:105], v[106:107]
    v_cvt_pk_bf16_f32 v236, v224, v225
    v_cvt_pk_bf16_f32 v237, v226, v227
    v_cvt_pk_bf16_f32 v238, v228, v229
    v_cvt_pk_bf16_f32 v239, v230, v231
    ds_write_b128 v9, v[236:239] offset:3072
    v_lshlrev_b32 v216, 16, v32
    v_and_b32 v217, s83, v32
    v_lshlrev_b32 v218, 16, v33
    v_and_b32 v219, s83, v33
    v_lshlrev_b32 v220, 16, v34
    v_and_b32 v221, s83, v34
    v_lshlrev_b32 v222, 16, v35
    v_and_b32 v223, s83, v35
    v_pk_fma_f32 v[216:217], v[216:217], v[116:117], v[118:119]
    v_pk_fma_f32 v[218:219], v[218:219], v[112:113], v[114:115]
    v_pk_fma_f32 v[220:221], v[220:221], v[108:109], v[110:111]
    v_pk_fma_f32 v[222:223], v[222:223], v[104:105], v[106:107]
    v_cvt_pk_bf16_f32 v232, v216, v217
    v_cvt_pk_bf16_f32 v233, v218, v219
    v_cvt_pk_bf16_f32 v234, v220, v221
    v_cvt_pk_bf16_f32 v235, v222, v223
    ds_write_b128 v9, v[232:235] offset:7680
    v_lshlrev_b32 v224, 16, v36
    v_and_b32 v225, s83, v36
    v_lshlrev_b32 v226, 16, v37
    v_and_b32 v227, s83, v37
    v_lshlrev_b32 v228, 16, v38
    v_and_b32 v229, s83, v38
    v_lshlrev_b32 v230, 16, v39
    v_and_b32 v231, s83, v39
    v_pk_fma_f32 v[224:225], v[224:225], v[116:117], v[118:119]
    v_pk_fma_f32 v[226:227], v[226:227], v[112:113], v[114:115]
    v_pk_fma_f32 v[228:229], v[228:229], v[108:109], v[110:111]
    v_pk_fma_f32 v[230:231], v[230:231], v[104:105], v[106:107]
    v_cvt_pk_bf16_f32 v236, v224, v225
    v_cvt_pk_bf16_f32 v237, v226, v227
    v_cvt_pk_bf16_f32 v238, v228, v229
    v_cvt_pk_bf16_f32 v239, v230, v231
    ds_write_b128 v9, v[236:239] offset:12288
    s_waitcnt lgkmcnt(0)
    s_barrier
    s_waitcnt vmcnt(8)
    v_cmp_ne_u32 vcc, s63, v2
    s_cbranch_vccz L_pdone_11
    s_mov_b32 s82, 0
L_poll_10:
    buffer_load_dword v2, v1, s[44:47], 0 offen sc1
    s_waitcnt vmcnt(0)
    v_cmp_ne_u32 vcc, s63, v2
    s_cbranch_vccz L_pdone_11
    s_add_u32 s82, s82, 1
    s_cmp_lt_u32 s82, 400000
    s_cbranch_scc1 L_poll_10
L_pdone_11:
    buffer_load_dwordx4 a[0:3], v15, s[44:47], s92 offen offset:0 sc1
    buffer_load_dwordx4 a[4:7], v15, s[44:47], s92 offen offset:1024 sc1
    s_nop 0
    buffer_load_dwordx4 a[8:11], v15, s[44:47], s92 offen offset:2048 sc1
    buffer_load_dwordx4 a[12:15], v15, s[44:47], s92 offen offset:3072 sc1
    s_add_u32 s92, s92, 4096
    buffer_load_dwordx4 a[16:19], v15, s[44:47], s92 offen offset:0 sc1
    buffer_load_dwordx4 a[20:23], v15, s[44:47], s92 offen offset:1024 sc1
    buffer_load_dwordx4 a[24:27], v15, s[44:47], s92 offen offset:2048 sc1
    buffer_load_dwordx4 a[28:31], v15, s[44:47], s92 offen offset:3072 sc1
    s_add_u32 s92, s92, 4096
L_gsetup:
    v_lshrrev_b32 v4, 3, v0
    v_bfe_u32 v5, v0, 1, 2
    v_lshrrev_b32 v3, 4, v0
    v_xor_b32 v5, v5, v3
    v_and_b32 v3, 1, v0
    v_lshl_add_u32 v5, v5, 1, v3
    v_lshlrev_b32 v5, 4, v5
    v_lshl_add_u32 v5, v4, 7, v5
    s_mul_i32 s64, s76, 81920
    v_add_u32 v14, s64, v5
    v_lshrrev_b32 v3, 2, v0
    v_and_b32 v4, 3, v0
    v_lshlrev_b32 v4, 3, v4
    v_lshl_add_u32 v4, v3, 7, v4
    v_bfe_u32 v5, v0, 3, 2
    v_xor_b32 v5, s60, v5
    v_lshl_add_u32 v144, v5, 5, v4
    v_xor_b32 v145, 32, v144
    v_xor_b32 v146, 64, v144
    v_xor_b32 v147, 96, v144
    v_mov_b32 v172, 0x3f803f80
    v_mov_b32 v173, 0x3f803f80
    v_mov_b32 v174, 0x3f803f80
    v_mov_b32 v175, 0x3f803f80
    s_lshl_b32 s93, s60, 12
    s_cmp_eq_u32 s60, 3
    s_cselect_b32 s64, 0, 0x40000000
    v_mov_b32 v12, 0x40000000
    v_writelane_b32 v12, s64, 0
    v_mov_b32 v13, s63
    s_lshl_b32 s72, s2, 4
    s_add_u32 s72, s72, 69632
    v_and_b32 v10, 15, v0
    v_lshrrev_b32 v11, 4, v0
    v_lshlrev_b32 v4, 6, v10
    v_lshl_add_u32 v4, v11, 4, v4
    v_cmp_gt_u32 vcc, 4, v10
    v_mov_b32 v5, 0x40000000
    s_lshl_b32 s64, s77, 2
    s_add_u32 s64, s64, s60
    v_cndmask_b32 v5, v5, v4, vcc
    s_mul_i32 s64, s64, 6144
    s_add_u32 s22, s64, 131072
    s_add_u32 s23, s22, 4096
    s_cmp_lg_u32 s60, 3
    s_cbranch_scc1 L_bb_done
    s_cmp_ge_u32 s62, 27
    s_cbranch_scc1 L_nobb
    s_barrier
    s_sub_u32 s64, s72, 4096
    buffer_store_dword v13, v12, s[44:47], s64 offen sc1
    s_cmp_eq_u32 s2, 0
    s_cselect_b32 s64, 2048, 0x40000000
    buffer_store_dword v13, v12, s[44:47], s64 offen sc1
    s_waitcnt vmcnt(2)
    v_lshrrev_b32 v48, 2, v0
    v_and_b32 v49, 7, v48
    v_lshlrev_b32 v48, 8, v48
    v_lshl_add_u32 v48, v49, 5, v48
    v_and_b32 v49, 3, v0
    v_lshl_add_u32 v48, v49, 3, v48
    v_xor_b32 v49, 0, v48
    v_add_u32_e64 v49, s20, v49
    ds_read_b64_tr_b16 v[16:17], v49
    ds_read_b64_tr_b16 v[18:19], v49 offset:4096
    v_xor_b32 v49, 32, v48
    v_add_u32 v49, s20, v49
    ds_read_b64_tr_b16 v[20:21], v49
    ds_read_b64_tr_b16 v[22:23], v49 offset:4096
    v_xor_b32 v49, 64, v48
    v_add_u32 v49, s20, v49
    ds_read_b64_tr_b16 v[24:25], v49
    ds_read_b64_tr_b16 v[26:27], v49 offset:4096
    v_xor_b32 v49, 96, v48
    v_add_u32_e64 v49, s20, v49
    ds_read_b64_tr_b16 v[28:29], v49
    ds_read_b64_tr_b16 v[30:31], v49 offset:4096
    v_xor_b32 v49, 128, v48
    v_add_u32_e64 v49, s20, v49
    ds_read_b64_tr_b16 v[32:33], v49
    ds_read_b64_tr_b16 v[34:35], v49 offset:4096
    v_xor_b32 v49, 160, v48
    v_add_u32_e64 v49, s20, v49
    ds_read_b64_tr_b16 v[36:37], v49
    ds_read_b64_tr_b16 v[38:39], v49 offset:4096
    v_xor_b32 v49, 192, v48
    v_add_u32_e64 v49, s20, v49
    ds_read_b64_tr_b16 v[40:41], v49
    ds_read_b64_tr_b16 v[42:43], v49 offset:4096
    v_xor_b32 v49, 224, v48
    v_add_u32 v49, s20, v49
    ds_read_b64_tr_b16 v[44:45], v49
    ds_read_b64_tr_b16 v[46:47], v49 offset:4096
    s_add_u32 s64, s18, 0
    s_mul_i32 s65, s64, 52
    s_lshr_b32 s65, s65, 8
    s_mul_i32 s65, s65, 240640
    s_lshl_b32 s64, s64, 10
    s_add_u32 s64, s64, s65
    s_add_u32 s64, s64, s15
    s_waitcnt lgkmcnt(8)
    buffer_store_dwordx4 v[16:19], v15, s[44:47], s64 offen sc1
    s_add_u32 s64, s18, 1
    s_mul_i32 s65, s64, 52
    s_lshr_b32 s65, s65, 8
    s_mul_i32 s65, s65, 240640
    s_lshl_b32 s64, s64, 10
    s_add_u32 s64, s64, s65
    s_add_u32 s64, s64, s15
    buffer_store_dwordx4 v[20:23], v15, s[44:47], s64 offen sc1
    s_add_u32 s64, s18, 2
    s_mul_i32 s65, s64, 52
    s_lshr_b32 s65, s65, 8
    s_mul_i32 s65, s65, 240640
    s_lshl_b32 s64, s64, 10
    s_add_u32 s64, s64, s65
    s_add_u32 s64, s64, s15
    buffer_store_dwordx4 v[24:27], v15, s[44:47], s64 offen sc1
    s_add_u32 s64, s18, 3
    s_mul_i32 s65, s64, 52
    s_lshr_b32 s65, s65, 8
    s_mul_i32 s65, s65, 240640
    s_lshl_b32 s64, s64, 10
    s_add_u32 s64, s64, s65
    s_add_u32 s64, s64, s15
    buffer_store_dwordx4 v[28:31], v15, s[44:47], s64 offen sc1
    s_add_u32 s64, s18, 4
    s_mul_i32 s65, s64, 52
    s_lshr_b32 s65, s65, 8
    s_mul_i32 s65, s65, 240640
    s_lshl_b32 s64, s64, 10
    s_add_u32 s64, s64, s65
    s_add_u32 s64, s64, s15
    s_waitcnt lgkmcnt(0)
    buffer_store_dwordx4 v[32:35], v15, s[44:47], s64 offen sc1
    s_add_u32 s64, s18, 5
    s_mul_i32 s65, s64, 52
    s_lshr_b32 s65, s65, 8
    s_mul_i32 s65, s65, 240640
    s_lshl_b32 s64, s64, 10
    s_add_u32 s64, s64, s65
    s_add_u32 s64, s64, s15
    buffer_store_dwordx4 v[36:39], v15, s[44:47], s64 offen sc1
    s_add_u32 s64, s18, 6
    s_mul_i32 s65, s64, 52
    s_lshr_b32 s65, s65, 8
    s_mul_i32 s65, s65, 240640
    s_lshl_b32 s64, s64, 10
    s_add_u32 s64, s64, s65
    s_add_u32 s64, s64, s15
    buffer_store_dwordx4 v[40:43], v15, s[44:47], s64 offen sc1
    s_add_u32 s64, s18, 7
    s_mul_i32 s65, s64, 52
    s_lshr_b32 s65, s65, 8
    s_mul_i32 s65, s65, 240640
    s_lshl_b32 s64, s64, 10
    s_add_u32 s64, s64, s65
    s_add_u32 s64, s64, s15
    buffer_store_dwordx4 v[44:47], v15, s[44:47], s64 offen sc1
    s_branch L_cw_ok
L_nobb:
    s_mov_b32 s64, 2048
    s_mov_b32 s21, 0x40000000
    s_mov_b64 exec, 1
    buffer_load_dword v2, v12, s[44:47], s64 offen sc1
    s_waitcnt vmcnt(0)
    v_cmp_ne_u32 vcc, s63, v2
    s_cbranch_vccz L_pdone_13
    s_mov_b32 s82, 0
L_poll_12:
    buffer_load_dword v2, v12, s[44:47], s64 offen sc1
    s_waitcnt vmcnt(0)
    v_cmp_ne_u32 vcc, s63, v2
    s_cbranch_vccz L_pdone_13
    s_add_u32 s82, s82, 1
    s_cmp_lt_u32 s82, 400000
    s_cbranch_scc1 L_poll_12
L_pdone_13:
    s_mov_b64 exec, -1
L_bb_done:
L_cw_ok:
    s_cmp_eq_u32 s60, 3
    s_cbranch_scc1 L_w3
    buffer_load_dwordx4 a[32:35], v15, s[44:47], s92 offen offset:0 sc1
    buffer_load_dwordx4 a[36:39], v15, s[44:47], s92 offen offset:1024 sc1
    buffer_load_dwordx4 a[40:43], v15, s[44:47], s92 offen offset:2048 sc1
    buffer_load_dwordx4 a[44:47], v15, s[44:47], s92 offen offset:3072 sc1
    s_add_u32 s92, s92, 4096
    buffer_load_dwordx4 a[48:51], v15, s[44:47], s92 offen offset:0 sc1
    buffer_load_dwordx4 a[52:55], v15, s[44:47], s92 offen offset:1024 sc1
    buffer_load_dwordx4 a[56:59], v15, s[44:47], s92 offen offset:2048 sc1
    buffer_load_dwordx4 a[60:63], v15, s[44:47], s92 offen offset:3072 sc1
    s_add_u32 s92, s92, 4096
    buffer_load_dwordx4 a[64:67], v15, s[44:47], s92 offen offset:0 sc1
    buffer_load_dwordx4 a[68:71], v15, s[44:47], s92 offen offset:1024 sc1
    buffer_load_dwordx4 a[72:75], v15, s[44:47], s92 offen offset:2048 sc1
    buffer_load_dwordx4 a[76:79], v15, s[44:47], s92 offen offset:3072 sc1
    s_add_u32 s92, s92, 4096
    buffer_load_dwordx4 a[80:83], v15, s[44:47], s92 offen offset:0 sc1
    buffer_load_dwordx4 a[84:87], v15, s[44:47], s92 offen offset:1024 sc1
    buffer_load_dwordx4 a[88:91], v15, s[44:47], s92 offen offset:2048 sc1
    buffer_load_dwordx4 a[92:95], v15, s[44:47], s92 offen offset:3072 sc1
    s_add_u32 s92, s92, 4096
    buffer_load_dwordx4 a[96:99], v15, s[44:47], s92 offen offset:0 sc1
    buffer_load_dwordx4 a[100:103], v15, s[44:47], s92 offen offset:1024 sc1
    buffer_load_dwordx4 a[104:107], v15, s[44:47], s92 offen offset:2048 sc1
    buffer_load_dwordx4 a[108:111], v15, s[44:47], s92 offen offset:3072 sc1
    s_add_u32 s92, s92, 4096
    buffer_load_dwordx4 a[112:115], v15, s[44:47], s92 offen offset:0 sc1
    buffer_load_dwordx4 a[116:119], v15, s[44:47], s92 offen offset:1024 sc1
    buffer_load_dwordx4 a[120:123], v15, s[44:47], s92 offen offset:2048 sc1
    buffer_load_dwordx4 a[124:127], v15, s[44:47], s92 offen offset:3072 sc1
    s_add_u32 s92, s92, 4096
    buffer_load_dwordx4 a[128:131], v15, s[44:47], s92 offen offset:0 sc1
    buffer_load_dwordx4 a[132:135], v15, s[44:47], s92 offen offset:1024 sc1
    buffer_load_dwordx4 a[136:139], v15, s[44:47], s92 offen offset:2048 sc1
    buffer_load_dwordx4 a[140:143], v15, s[44:47], s92 offen offset:3072 sc1
    s_add_u32 s92, s92, 4096
    buffer_load_dwordx4 a[144:147], v15, s[44:47], s92 offen offset:0 sc1
    buffer_load_dwordx4 a[148:151], v15, s[44:47], s92 offen offset:1024 sc1
    buffer_load_dwordx4 a[152:155], v15, s[44:47], s92 offen offset:2048 sc1
    s_getpc_b64 s[4:5]
L_pc_14:
    s_add_u32 s4, s4, sequential_preLN__ssm_conv_s4d__glu_gated_bilinear__prompt_kernel+25984-L_pc_14
    s_addc_u32 s5, s5, 0
    s_mov_b32 s6, 16384
    s_mov_b32 s7, 0x20000
    v_lshlrev_b32 v2, 7, v0
    s_lshl_b32 s3, s60, 13
    buffer_load_dword a255, v2, s[4:7], s3 offen
    s_branch L_gemm1
L_w3:
    s_mov_b32 s75, 65536
    buffer_load_dwordx4 a[32:35], v15, s[44:47], s92 offen offset:0 sc1
    buffer_load_dwordx4 a[36:39], v15, s[44:47], s92 offen offset:1024 sc1
    s_nop 0
    buffer_load_dwordx4 a[40:43], v15, s[44:47], s92 offen offset:2048 sc1
    buffer_load_dwordx4 a[44:47], v15, s[44:47], s92 offen offset:3072 sc1
    s_add_u32 s92, s92, 4096
    buffer_load_dwordx4 a[48:51], v15, s[44:47], s92 offen offset:0 sc1
    buffer_load_dwordx4 a[52:55], v15, s[44:47], s92 offen offset:1024 sc1
    buffer_load_dwordx4 a[56:59], v15, s[44:47], s92 offen offset:2048 sc1
    s_waitcnt vmcnt(7)
    buffer_store_dword v13, v12, s[44:47], s21 offen sc1
    buffer_load_dwordx4 a[60:63], v15, s[44:47], s92 offen offset:3072 sc1
    s_add_u32 s92, s92, 4096
    s_waitcnt vmcnt(7)
    buffer_load_dwordx4 a[64:67], v15, s[44:47], s92 offen offset:0 sc1
    s_waitcnt vmcnt(7)
    s_nop 0
    buffer_load_dwordx4 a[68:71], v15, s[44:47], s92 offen offset:1024 sc1
    buffer_load_dword v84, v15, s[44:47], s75 offen offset:0 sc1
    buffer_load_dword v85, v15, s[44:47], s75 offen offset:1024 sc1
    buffer_load_dword v86, v15, s[44:47], s75 offen offset:2048 sc1
    buffer_load_dword v87, v15, s[44:47], s75 offen offset:3072 sc1
    s_waitcnt vmcnt(0)
    v_and_b32 v88, v84, v85
    v_or_b32_e64 v89, v84, v85
    v_bitop3_b32 v88, v88, v86, v87 bitop3:0x80
    v_or3_b32 v89, v89, v86, v87
    v_xor_b32 v88, s63, v88
    v_xor_b32 v89, s63, v89
    v_or_b32 v88, v88, v89
    v_cmp_ne_u32 vcc, 0, v88
    s_cbranch_vccz L_pdone_16
    s_mov_b32 s82, 0
L_poll_15:
    buffer_load_dword v84, v15, s[44:47], s75 offen offset:0 sc1
    buffer_load_dword v85, v15, s[44:47], s75 offen offset:1024 sc1
    buffer_load_dword v86, v15, s[44:47], s75 offen offset:2048 sc1
    buffer_load_dword v87, v15, s[44:47], s75 offen offset:3072 sc1
    s_waitcnt vmcnt(0)
    v_and_b32 v88, v84, v85
    v_or_b32 v89, v84, v85
    v_bitop3_b32 v88, v88, v86, v87 bitop3:0x80
    v_or3_b32 v89, v89, v86, v87
    v_xor_b32 v88, s63, v88
    v_xor_b32 v89, s63, v89
    v_or_b32 v88, v88, v89
    v_cmp_ne_u32 vcc, 0, v88
    s_cbranch_vccz L_pdone_16
    s_add_u32 s82, s82, 1
    s_cmp_lt_u32 s82, 400000
    s_cbranch_scc1 L_poll_15
L_pdone_16:
    s_mov_b32 m0, 0
    s_mov_b32 s97, 0
    buffer_load_dwordx4 v14, s[40:43], s97 offen offset:0 sc1 lds
    buffer_load_dwordx4 v14, s[40:43], s97 offen offset:1024 sc1 lds
    buffer_load_dwordx4 v14, s[40:43], s97 offen offset:2048 sc1 lds
    buffer_load_dwordx4 v14, s[40:43], s97 offen offset:3072 sc1 lds
    s_mov_b32 m0, 4096
    s_mov_b32 s97, 4096
    buffer_load_dwordx4 v14, s[40:43], s97 offen offset:0 sc1 lds
    buffer_load_dwordx4 v14, s[40:43], s97 offen offset:1024 sc1 lds
    buffer_load_dwordx4 v14, s[40:43], s97 offen offset:2048 sc1 lds
    buffer_load_dwordx4 v14, s[40:43], s97 offen offset:3072 sc1 lds
    s_mov_b32 m0, 8192
    s_mov_b32 s97, 8192
    buffer_load_dwordx4 v14, s[40:43], s97 offen offset:0 sc1 lds
    buffer_load_dwordx4 v14, s[40:43], s97 offen offset:1024 sc1 lds
    buffer_load_dwordx4 v14, s[40:43], s97 offen offset:2048 sc1 lds
    buffer_load_dwordx4 v14, s[40:43], s97 offen offset:3072 sc1 lds
    s_mov_b32 m0, 12288
    s_mov_b32 s97, 12288
    buffer_load_dwordx4 v14, s[40:43], s97 offen offset:0 sc1 lds
    buffer_load_dwordx4 v14, s[40:43], s97 offen offset:1024 sc1 lds
    buffer_load_dwordx4 v14, s[40:43], s97 offen offset:2048 sc1 lds
    buffer_load_dwordx4 v14, s[40:43], s97 offen offset:3072 sc1 lds
    s_mov_b32 m0, 16384
    s_mov_b32 s97, 16384
    buffer_load_dwordx4 v14, s[40:43], s97 offen offset:0 sc1 lds
    buffer_load_dwordx4 v14, s[40:43], s97 offen offset:1024 sc1 lds
    buffer_load_dwordx4 v14, s[40:43], s97 offen offset:2048 sc1 lds
    buffer_load_dwordx4 v14, s[40:43], s97 offen offset:3072 sc1 lds
    s_mov_b32 m0, 20480
    s_mov_b32 s97, 20480
    s_waitcnt vmcnt(18)
    buffer_load_dwordx4 v14, s[40:43], s97 offen offset:0 sc1 lds
    buffer_load_dwordx4 v14, s[40:43], s97 offen offset:1024 sc1 lds
    s_waitcnt vmcnt(18)
    buffer_load_dwordx4 v14, s[40:43], s97 offen offset:2048 sc1 lds
    buffer_load_dwordx4 v14, s[40:43], s97 offen offset:3072 sc1 lds
    s_mov_b32 m0, 24576
    s_mov_b32 s97, 24576
    s_waitcnt vmcnt(18)
    buffer_load_dwordx4 v14, s[40:43], s97 offen offset:0 sc1 lds
    buffer_load_dwordx4 v14, s[40:43], s97 offen offset:1024 sc1 lds
    s_waitcnt vmcnt(18)
    buffer_load_dwordx4 v14, s[40:43], s97 offen offset:2048 sc1 lds
    buffer_load_dwordx4 v14, s[40:43], s97 offen offset:3072 sc1 lds
    s_mov_b32 m0, 28672
    s_mov_b32 s97, 28672
    s_waitcnt vmcnt(18)
    buffer_load_dwordx4 v14, s[40:43], s97 offen offset:0 sc1 lds
    buffer_load_dwordx4 v14, s[40:43], s97 offen offset:1024 sc1 lds
    s_waitcnt vmcnt(18)
    buffer_load_dwordx4 v14, s[40:43], s97 offen offset:2048 sc1 lds
    buffer_load_dwordx4 v14, s[40:43], s97 offen offset:3072 sc1 lds
    buffer_load_dwordx4 a[72:75], v15, s[44:47], s92 offen offset:2048 sc1
    buffer_load_dwordx4 a[76:79], v15, s[44:47], s92 offen offset:3072 sc1
    s_add_u32 s92, s92, 4096
    buffer_load_dwordx4 a[80:83], v15, s[44:47], s92 offen offset:0 sc1
    buffer_load_dwordx4 a[84:87], v15, s[44:47], s92 offen offset:1024 sc1
    buffer_load_dwordx4 a[88:91], v15, s[44:47], s92 offen offset:2048 sc1
    buffer_load_dwordx4 a[92:95], v15, s[44:47], s92 offen offset:3072 sc1
    s_add_u32 s92, s92, 4096
    buffer_load_dwordx4 a[96:99], v15, s[44:47], s92 offen offset:0 sc1
    buffer_load_dwordx4 a[100:103], v15, s[44:47], s92 offen offset:1024 sc1
    buffer_load_dwordx4 a[104:107], v15, s[44:47], s92 offen offset:2048 sc1
    buffer_load_dwordx4 a[108:111], v15, s[44:47], s92 offen offset:3072 sc1
    s_add_u32 s92, s92, 4096
    buffer_load_dwordx4 a[112:115], v15, s[44:47], s92 offen offset:0 sc1
    buffer_load_dwordx4 a[116:119], v15, s[44:47], s92 offen offset:1024 sc1
    buffer_load_dwordx4 a[120:123], v15, s[44:47], s92 offen offset:2048 sc1
    buffer_load_dwordx4 a[124:127], v15, s[44:47], s92 offen offset:3072 sc1
    s_add_u32 s92, s92, 4096
    buffer_load_dwordx4 a[128:131], v15, s[44:47], s92 offen offset:0 sc1
    buffer_load_dwordx4 a[132:135], v15, s[44:47], s92 offen offset:1024 sc1
    buffer_load_dwordx4 a[136:139], v15, s[44:47], s92 offen offset:2048 sc1
    buffer_load_dwordx4 a[140:143], v15, s[44:47], s92 offen offset:3072 sc1
    s_add_u32 s92, s92, 4096
    buffer_load_dwordx4 a[144:147], v15, s[44:47], s92 offen offset:0 sc1
    buffer_load_dwordx4 a[148:151], v15, s[44:47], s92 offen offset:1024 sc1
    buffer_load_dwordx4 a[152:155], v15, s[44:47], s92 offen offset:2048 sc1
    s_cmp_eq_u32 s2, 0
    s_cselect_b32 s64, 0, 0x40000000
    buffer_store_dword v13, v12, s[44:47], s64 offen sc1
    s_mov_b32 s75, 69632
L_gemm1:
    s_waitcnt vmcnt(34)
    s_cmp_eq_u32 s60, 3
    s_cbranch_scc1 L_nodrain
    s_waitcnt vmcnt(0)
L_nodrain:
    s_barrier
    ds_read_b64_tr_b16 v[112:113], v144 offset:0
    ds_read_b64_tr_b16 v[114:115], v144 offset:2048
    s_nop 0
    ds_read_b64_tr_b16 v[116:117], v145 offset:0
    ds_read_b64_tr_b16 v[118:119], v145 offset:2048
    ds_read_b64_tr_b16 v[120:121], v146 offset:0
    ds_read_b64_tr_b16 v[122:123], v146 offset:2048
    ds_read_b64_tr_b16 v[124:125], v147 offset:0
    ds_read_b64_tr_b16 v[126:127], v147 offset:2048
    s_waitcnt lgkmcnt(0)
    v_mfma_f32_16x16x32_bf16 v[16:19], a[0:3], v[112:115], 0
    ds_read_b64_tr_b16 v[128:129], v144 offset:4096
    buffer_store_dword v13, v12, s[44:47], s72 offen sc1
    v_mfma_f32_16x16x32_bf16 v[20:23], a[4:7], v[112:115], 0
    ds_read_b64_tr_b16 v[130:131], v144 offset:6144
    s_add_u32 m0, s93, 32768
    v_mfma_f32_16x16x32_bf16 v[24:27], a[8:11], v[112:115], 0
    ds_read_b64_tr_b16 v[132:133], v145 offset:4096
    s_add_u32 s97, s93, 32768
    v_mfma_f32_16x16x32_bf16 v[156:159], v[112:115], v[112:115], 0
    ds_read_b64_tr_b16 v[134:135], v145 offset:6144
    buffer_load_dwordx4 v14, s[40:43], s97 offen offset:0 sc1 lds
    v_mfma_f32_16x16x32_bf16 v[160:163], v[172:175], v[112:115], 0
    ds_read_b64_tr_b16 v[136:137], v146 offset:4096
    buffer_load_dwordx4 v14, s[40:43], s97 offen offset:1024 sc1 lds
    v_mfma_f32_16x16x32_bf16 v[28:31], a[0:3], v[116:119], 0
    ds_read_b64_tr_b16 v[138:139], v146 offset:6144
    s_mul_i32 s64, s80, 5
    v_mfma_f32_16x16x32_bf16 v[32:35], a[4:7], v[116:119], 0
    ds_read_b64_tr_b16 v[140:141], v147 offset:4096
    s_add_u32 s65, s64, 4
    v_mfma_f32_16x16x32_bf16 v[36:39], a[8:11], v[116:119], 0
    ds_read_b64_tr_b16 v[142:143], v147 offset:6144
    s_lshr_b32 s64, s64, 3
    v_mfma_f32_16x16x32_bf16 v[40:43], a[0:3], v[120:123], 0
    s_lshr_b32 s65, s65, 3
    v_mfma_f32_16x16x32_bf16 v[44:47], a[4:7], v[120:123], 0
    s_sub_u32 s65, s65, s64
    v_mfma_f32_16x16x32_bf16 v[48:51], a[8:11], v[120:123], 0
    s_mul_i32 s66, s60, 60
    v_mfma_f32_16x16x32_bf16 v[52:55], a[0:3], v[124:127], 0
    s_add_u32 s64, s64, s66
    v_mfma_f32_16x16x32_bf16 v[56:59], a[4:7], v[124:127], 0
    v_mfma_f32_16x16x32_bf16 v[60:63], a[8:11], v[124:127], 0
    s_waitcnt lgkmcnt(0)
    v_mfma_f32_16x16x32_bf16 v[16:19], a[12:15], v[128:131], v[16:19]
    ds_read_b64_tr_b16 v[112:113], v144 offset:8192
    buffer_load_dwordx4 v14, s[40:43], s97 offen offset:2048 sc1 lds
    v_mfma_f32_16x16x32_bf16 v[20:23], a[16:19], v[128:131], v[20:23]
    ds_read_b64_tr_b16 v[114:115], v144 offset:10240
    buffer_load_dwordx4 v14, s[40:43], s97 offen offset:3072 sc1 lds
    v_mfma_f32_16x16x32_bf16 v[24:27], a[20:23], v[128:131], v[24:27]
    ds_read_b64_tr_b16 v[116:117], v145 offset:8192
    v_mfma_f32_16x16x32_bf16 v[156:159], v[128:131], v[128:131], v[156:159]
    ds_read_b64_tr_b16 v[118:119], v145 offset:10240
    s_lshl_b32 s64, s64, 6
    v_mfma_f32_16x16x32_bf16 v[160:163], v[172:175], v[128:131], v[160:163]
    ds_read_b64_tr_b16 v[120:121], v146 offset:8192
    s_add_u32 s64, s64, 73728
    v_mfma_f32_16x16x32_bf16 v[28:31], a[12:15], v[132:135], v[28:31]
    ds_read_b64_tr_b16 v[122:123], v146 offset:10240
    v_min_u32 v253, 23, v0
    v_mfma_f32_16x16x32_bf16 v[32:35], a[16:19], v[132:135], v[32:35]
    ds_read_b64_tr_b16 v[124:125], v147 offset:8192
    v_and_b32 v188, 1, v253
    v_mfma_f32_16x16x32_bf16 v[36:39], a[20:23], v[132:135], v[36:39]
    ds_read_b64_tr_b16 v[126:127], v147 offset:10240
    v_mul_u32_u24 v188, s65, v188
    v_mfma_f32_16x16x32_bf16 v[40:43], a[12:15], v[136:139], v[40:43]
    v_lshrrev_b32 v253, 1, v253
    v_mfma_f32_16x16x32_bf16 v[44:47], a[16:19], v[136:139], v[44:47]
    v_mfma_f32_16x16x32_bf16 v[48:51], a[20:23], v[136:139], v[48:51]
    v_mfma_f32_16x16x32_bf16 v[52:55], a[12:15], v[140:143], v[52:55]
    v_mfma_f32_16x16x32_bf16 v[56:59], a[16:19], v[140:143], v[56:59]
    v_mfma_f32_16x16x32_bf16 v[60:63], a[20:23], v[140:143], v[60:63]
    s_waitcnt lgkmcnt(0)
    v_mfma_f32_16x16x32_bf16 v[16:19], a[24:27], v[112:115], v[16:19]
    ds_read_b64_tr_b16 v[128:129], v144 offset:12288
    v_mad_u32_u24 v253, v253, 5, v188
    v_mfma_f32_16x16x32_bf16 v[20:23], a[28:31], v[112:115], v[20:23]
    ds_read_b64_tr_b16 v[130:131], v144 offset:14336
    v_lshl_add_u32 v253, v253, 6, s64
    v_mfma_f32_16x16x32_bf16 v[24:27], a[32:35], v[112:115], v[24:27]
    ds_read_b64_tr_b16 v[132:133], v145 offset:12288
    s_lshl_b32 s96, s80, 2
    v_mfma_f32_16x16x32_bf16 v[156:159], v[112:115], v[112:115], v[156:159]
    ds_read_b64_tr_b16 v[134:135], v145 offset:14336
    s_add_u32 s96, s96, s60
    v_mfma_f32_16x16x32_bf16 v[160:163], v[172:175], v[112:115], v[160:163]
    ds_read_b64_tr_b16 v[136:137], v146 offset:12288
    s_mul_i32 s96, s96, 61440
    v_mfma_f32_16x16x32_bf16 v[28:31], a[24:27], v[116:119], v[28:31]
    ds_read_b64_tr_b16 v[138:139], v146 offset:14336
    s_add_u32 s96, s96, 4980736
    v_mfma_f32_16x16x32_bf16 v[32:35], a[28:31], v[116:119], v[32:35]
    ds_read_b64_tr_b16 v[140:141], v147 offset:12288
    buffer_load_dwordx4 a[156:159], v15, s[44:47], s92 offen offset:3072 sc1
    v_mfma_f32_16x16x32_bf16 v[36:39], a[32:35], v[116:119], v[36:39]
    ds_read_b64_tr_b16 v[142:143], v147 offset:14336
    s_add_u32 s92, s92, 4096
    v_mfma_f32_16x16x32_bf16 v[40:43], a[24:27], v[120:123], v[40:43]
    buffer_load_dwordx4 a[160:163], v15, s[44:47], s92 offen offset:0 sc1
    v_mfma_f32_16x16x32_bf16 v[44:47], a[28:31], v[120:123], v[44:47]
    buffer_load_dwordx4 a[164:167], v15, s[44:47], s92 offen offset:1024 sc1
    v_mfma_f32_16x16x32_bf16 v[48:51], a[32:35], v[120:123], v[48:51]
    s_add_u32 m0, s93, 49152
    v_mfma_f32_16x16x32_bf16 v[52:55], a[24:27], v[124:127], v[52:55]
    s_add_u32 s97, s93, 49152
    v_mfma_f32_16x16x32_bf16 v[56:59], a[28:31], v[124:127], v[56:59]
    buffer_load_dwordx4 v14, s[40:43], s97 offen offset:0 sc1 lds
    v_mfma_f32_16x16x32_bf16 v[60:63], a[32:35], v[124:127], v[60:63]
    s_waitcnt vmcnt(9)
    s_barrier
    s_waitcnt lgkmcnt(0)
    v_mfma_f32_16x16x32_bf16 v[16:19], a[36:39], v[128:131], v[16:19]
    ds_read_b64_tr_b16 v[112:113], v144 offset:16384
    v_mfma_f32_16x16x32_bf16 v[20:23], a[40:43], v[128:131], v[20:23]
    ds_read_b64_tr_b16 v[114:115], v144 offset:18432
    buffer_load_dwordx4 a[168:171], v15, s[44:47], s92 offen offset:2048 sc1
    v_mfma_f32_16x16x32_bf16 v[24:27], a[44:47], v[128:131], v[24:27]
    ds_read_b64_tr_b16 v[116:117], v145 offset:16384
    buffer_load_dwordx4 a[172:175], v15, s[44:47], s92 offen offset:3072 sc1
    v_mfma_f32_16x16x32_bf16 v[156:159], v[128:131], v[128:131], v[156:159]
    ds_read_b64_tr_b16 v[118:119], v145 offset:18432
    buffer_load_dword v1, v253, s[44:47], 0 offen sc1
    v_mfma_f32_16x16x32_bf16 v[160:163], v[172:175], v[128:131], v[160:163]
    ds_read_b64_tr_b16 v[120:121], v146 offset:16384
    buffer_load_dwordx4 v14, s[40:43], s97 offen offset:1024 sc1 lds
    v_mfma_f32_16x16x32_bf16 v[28:31], a[36:39], v[132:135], v[28:31]
    ds_read_b64_tr_b16 v[122:123], v146 offset:18432
    buffer_load_dwordx4 v14, s[40:43], s97 offen offset:2048 sc1 lds
    v_mfma_f32_16x16x32_bf16 v[32:35], a[40:43], v[132:135], v[32:35]
    ds_read_b64_tr_b16 v[124:125], v147 offset:16384
    v_mfma_f32_16x16x32_bf16 v[36:39], a[44:47], v[132:135], v[36:39]
    ds_read_b64_tr_b16 v[126:127], v147 offset:18432
    v_mfma_f32_16x16x32_bf16 v[40:43], a[36:39], v[136:139], v[40:43]
    v_mfma_f32_16x16x32_bf16 v[44:47], a[40:43], v[136:139], v[44:47]
    v_mfma_f32_16x16x32_bf16 v[48:51], a[44:47], v[136:139], v[48:51]
    v_mfma_f32_16x16x32_bf16 v[52:55], a[36:39], v[140:143], v[52:55]
    v_mfma_f32_16x16x32_bf16 v[56:59], a[40:43], v[140:143], v[56:59]
    v_mfma_f32_16x16x32_bf16 v[60:63], a[44:47], v[140:143], v[60:63]
    s_waitcnt lgkmcnt(0)
    v_mfma_f32_16x16x32_bf16 v[16:19], a[48:51], v[112:115], v[16:19]
    ds_read_b64_tr_b16 v[128:129], v144 offset:20480
    s_add_u32 s92, s92, 4096
    v_mfma_f32_16x16x32_bf16 v[20:23], a[52:55], v[112:115], v[20:23]
    ds_read_b64_tr_b16 v[130:131], v144 offset:22528
    buffer_load_dwordx4 a[176:179], v15, s[44:47], s92 offen offset:0 sc1
    v_mfma_f32_16x16x32_bf16 v[24:27], a[56:59], v[112:115], v[24:27]
    ds_read_b64_tr_b16 v[132:133], v145 offset:20480
    v_mfma_f32_16x16x32_bf16 v[156:159], v[112:115], v[112:115], v[156:159]
    ds_read_b64_tr_b16 v[134:135], v145 offset:22528
    buffer_load_dwordx4 v14, s[40:43], s97 offen offset:3072 sc1 lds
    v_mfma_f32_16x16x32_bf16 v[160:163], v[172:175], v[112:115], v[160:163]
    ds_read_b64_tr_b16 v[136:137], v146 offset:20480
    v_mfma_f32_16x16x32_bf16 v[28:31], a[48:51], v[116:119], v[28:31]
    ds_read_b64_tr_b16 v[138:139], v146 offset:22528
    v_mfma_f32_16x16x32_bf16 v[32:35], a[52:55], v[116:119], v[32:35]
    ds_read_b64_tr_b16 v[140:141], v147 offset:20480
    v_mfma_f32_16x16x32_bf16 v[36:39], a[56:59], v[116:119], v[36:39]
    ds_read_b64_tr_b16 v[142:143], v147 offset:22528
    v_mfma_f32_16x16x32_bf16 v[40:43], a[48:51], v[120:123], v[40:43]
    v_mfma_f32_16x16x32_bf16 v[44:47], a[52:55], v[120:123], v[44:47]
    v_mfma_f32_16x16x32_bf16 v[48:51], a[56:59], v[120:123], v[48:51]
    v_mfma_f32_16x16x32_bf16 v[52:55], a[48:51], v[124:127], v[52:55]
    v_mfma_f32_16x16x32_bf16 v[56:59], a[52:55], v[124:127], v[56:59]
    v_mfma_f32_16x16x32_bf16 v[60:63], a[56:59], v[124:127], v[60:63]
    s_waitcnt lgkmcnt(0)
    v_mfma_f32_16x16x32_bf16 v[16:19], a[60:63], v[128:131], v[16:19]
    ds_read_b64_tr_b16 v[112:113], v144 offset:24576
    buffer_load_dwordx4 a[180:183], v15, s[44:47], s92 offen offset:1024 sc1
    v_mfma_f32_16x16x32_bf16 v[20:23], a[64:67], v[128:131], v[20:23]
    ds_read_b64_tr_b16 v[114:115], v144 offset:26624
    buffer_load_dwordx4 a[184:187], v15, s[44:47], s92 offen offset:2048 sc1
    v_mfma_f32_16x16x32_bf16 v[24:27], a[68:71], v[128:131], v[24:27]
    ds_read_b64_tr_b16 v[116:117], v145 offset:24576
    buffer_load_dwordx4 a[188:191], v15, s[44:47], s92 offen offset:3072 sc1
    v_mfma_f32_16x16x32_bf16 v[156:159], v[128:131], v[128:131], v[156:159]
    ds_read_b64_tr_b16 v[118:119], v145 offset:26624
    s_add_u32 m0, s93, 65536
    v_mfma_f32_16x16x32_bf16 v[160:163], v[172:175], v[128:131], v[160:163]
    ds_read_b64_tr_b16 v[120:121], v146 offset:24576
    s_add_u32 s97, s93, 65536
    v_mfma_f32_16x16x32_bf16 v[28:31], a[60:63], v[132:135], v[28:31]
    ds_read_b64_tr_b16 v[122:123], v146 offset:26624
    buffer_load_dwordx4 v14, s[40:43], s97 offen offset:0 sc1 lds
    v_mfma_f32_16x16x32_bf16 v[32:35], a[64:67], v[132:135], v[32:35]
    ds_read_b64_tr_b16 v[124:125], v147 offset:24576
    v_mfma_f32_16x16x32_bf16 v[36:39], a[68:71], v[132:135], v[36:39]
    ds_read_b64_tr_b16 v[126:127], v147 offset:26624
    v_mfma_f32_16x16x32_bf16 v[40:43], a[60:63], v[136:139], v[40:43]
    v_mfma_f32_16x16x32_bf16 v[44:47], a[64:67], v[136:139], v[44:47]
    v_mfma_f32_16x16x32_bf16 v[48:51], a[68:71], v[136:139], v[48:51]
    v_mfma_f32_16x16x32_bf16 v[52:55], a[60:63], v[140:143], v[52:55]
    v_mfma_f32_16x16x32_bf16 v[56:59], a[64:67], v[140:143], v[56:59]
    v_mfma_f32_16x16x32_bf16 v[60:63], a[68:71], v[140:143], v[60:63]
    s_waitcnt vmcnt(20)
    s_waitcnt lgkmcnt(0)
    v_mfma_f32_16x16x32_bf16 v[16:19], a[72:75], v[112:115], v[16:19]
    ds_read_b64_tr_b16 v[128:129], v144 offset:28672
    s_add_u32 s92, s92, 4096
    v_mfma_f32_16x16x32_bf16 v[20:23], a[76:79], v[112:115], v[20:23]
    ds_read_b64_tr_b16 v[130:131], v144 offset:30720
    v_mfma_f32_16x16x32_bf16 v[24:27], a[80:83], v[112:115], v[24:27]
    ds_read_b64_tr_b16 v[132:133], v145 offset:28672
    buffer_load_dwordx4 a[192:195], v15, s[44:47], s92 offen offset:0 sc1
    v_mfma_f32_16x16x32_bf16 v[156:159], v[112:115], v[112:115], v[156:159]
    ds_read_b64_tr_b16 v[134:135], v145 offset:30720
    buffer_load_dwordx4 v14, s[40:43], s97 offen offset:1024 sc1 lds
    v_mfma_f32_16x16x32_bf16 v[160:163], v[172:175], v[112:115], v[160:163]
    ds_read_b64_tr_b16 v[136:137], v146 offset:28672
    buffer_load_dwordx4 v14, s[40:43], s97 offen offset:2048 sc1 lds
    v_mfma_f32_16x16x32_bf16 v[28:31], a[72:75], v[116:119], v[28:31]
    ds_read_b64_tr_b16 v[138:139], v146 offset:30720
    s_cmp_lg_u32 s60, 3
    s_cbranch_scc1 L_n3_17
    buffer_load_dword v84, v15, s[44:47], s75 offen offset:0 sc1
    buffer_load_dword v85, v15, s[44:47], s75 offen offset:1024 sc1
    buffer_load_dword v86, v15, s[44:47], s75 offen offset:2048 sc1
    buffer_load_dword v87, v15, s[44:47], s75 offen offset:3072 sc1
L_n3_17:
    v_mfma_f32_16x16x32_bf16 v[32:35], a[76:79], v[116:119], v[32:35]
    ds_read_b64_tr_b16 v[140:141], v147 offset:28672
    v_mfma_f32_16x16x32_bf16 v[36:39], a[80:83], v[116:119], v[36:39]
    ds_read_b64_tr_b16 v[142:143], v147 offset:30720
    v_mfma_f32_16x16x32_bf16 v[40:43], a[72:75], v[120:123], v[40:43]
    v_mfma_f32_16x16x32_bf16 v[44:47], a[76:79], v[120:123], v[44:47]
    v_mfma_f32_16x16x32_bf16 v[48:51], a[80:83], v[120:123], v[48:51]
    v_mfma_f32_16x16x32_bf16 v[52:55], a[72:75], v[124:127], v[52:55]
    v_mfma_f32_16x16x32_bf16 v[56:59], a[76:79], v[124:127], v[56:59]
    v_mfma_f32_16x16x32_bf16 v[60:63], a[80:83], v[124:127], v[60:63]
    s_waitcnt vmcnt(18)
    s_barrier
    s_waitcnt lgkmcnt(0)
    v_mfma_f32_16x16x32_bf16 v[16:19], a[84:87], v[128:131], v[16:19]
    ds_read_b64_tr_b16 v[112:113], v144 offset:32768
    s_waitcnt vmcnt(11)
    v_cmp_ne_u32 vcc, s63, v1
    s_cbranch_vccz L_pdone_19
    s_mov_b32 s82, 0
L_poll_18:
    buffer_load_dword v1, v253, s[44:47], 0 offen sc1
    s_waitcnt vmcnt(0)
    v_cmp_ne_u32 vcc, s63, v1
    s_cbranch_vccz L_pdone_19
    s_add_u32 s82, s82, 1
    s_cmp_lt_u32 s82, 400000
    s_cbranch_scc1 L_poll_18
L_pdone_19:
    v_mfma_f32_16x16x32_bf16 v[20:23], a[88:91], v[128:131], v[20:23]
    ds_read_b64_tr_b16 v[114:115], v144 offset:34816
    buffer_load_dwordx4 a[196:199], v15, s[44:47], s92 offen offset:1024 sc1
    v_mfma_f32_16x16x32_bf16 v[24:27], a[92:95], v[128:131], v[24:27]
    ds_read_b64_tr_b16 v[116:117], v145 offset:32768
    buffer_load_dwordx4 a[200:203], v15, s[44:47], s92 offen offset:2048 sc1
    v_mfma_f32_16x16x32_bf16 v[156:159], v[128:131], v[128:131], v[156:159]
    ds_read_b64_tr_b16 v[118:119], v145 offset:34816
    v_mfma_f32_16x16x32_bf16 v[160:163], v[172:175], v[128:131], v[160:163]
    ds_read_b64_tr_b16 v[120:121], v146 offset:32768
    buffer_load_dwordx4 v14, s[40:43], s97 offen offset:3072 sc1 lds
    v_mfma_f32_16x16x32_bf16 v[28:31], a[84:87], v[132:135], v[28:31]
    ds_read_b64_tr_b16 v[122:123], v146 offset:34816
    v_mfma_f32_16x16x32_bf16 v[32:35], a[88:91], v[132:135], v[32:35]
    ds_read_b64_tr_b16 v[124:125], v147 offset:32768
    v_mfma_f32_16x16x32_bf16 v[36:39], a[92:95], v[132:135], v[36:39]
    ds_read_b64_tr_b16 v[126:127], v147 offset:34816
    v_mfma_f32_16x16x32_bf16 v[40:43], a[84:87], v[136:139], v[40:43]
    v_mfma_f32_16x16x32_bf16 v[44:47], a[88:91], v[136:139], v[44:47]
    v_mfma_f32_16x16x32_bf16 v[48:51], a[92:95], v[136:139], v[48:51]
    v_mfma_f32_16x16x32_bf16 v[52:55], a[84:87], v[140:143], v[52:55]
    v_mfma_f32_16x16x32_bf16 v[56:59], a[88:91], v[140:143], v[56:59]
    v_mfma_f32_16x16x32_bf16 v[60:63], a[92:95], v[140:143], v[60:63]
    s_waitcnt lgkmcnt(0)
    v_mfma_f32_16x16x32_bf16 v[16:19], a[96:99], v[112:115], v[16:19]
    ds_read_b64_tr_b16 v[128:129], v144 offset:36864
    buffer_load_dwordx4 v[176:179], v4, s[44:47], s22 offen offset:0 sc1
    v_mfma_f32_16x16x32_bf16 v[20:23], a[100:103], v[112:115], v[20:23]
    ds_read_b64_tr_b16 v[130:131], v144 offset:38912
    buffer_load_dwordx4 v[64:67], v5, s[44:47], s22 offen offset:1024 sc1
    v_mfma_f32_16x16x32_bf16 v[24:27], a[104:107], v[112:115], v[24:27]
    ds_read_b64_tr_b16 v[132:133], v145 offset:36864
    buffer_load_dwordx4 v[180:183], v4, s[44:47], s22 offen offset:2048 sc1
    v_mfma_f32_16x16x32_bf16 v[156:159], v[112:115], v[112:115], v[156:159]
    ds_read_b64_tr_b16 v[134:135], v145 offset:38912
    buffer_load_dwordx4 v[68:71], v5, s[44:47], s22 offen offset:3072 sc1
    v_mfma_f32_16x16x32_bf16 v[160:163], v[172:175], v[112:115], v[160:163]
    ds_read_b64_tr_b16 v[136:137], v146 offset:36864
    buffer_load_dwordx4 a[204:207], v15, s[44:47], s92 offen offset:3072 sc1
    v_mfma_f32_16x16x32_bf16 v[28:31], a[96:99], v[116:119], v[28:31]
    ds_read_b64_tr_b16 v[138:139], v146 offset:38912
    s_add_u32 s92, s92, 4096
    v_mfma_f32_16x16x32_bf16 v[32:35], a[100:103], v[116:119], v[32:35]
    ds_read_b64_tr_b16 v[140:141], v147 offset:36864
    buffer_load_dwordx4 a[208:211], v15, s[44:47], s92 offen offset:0 sc1
    v_mfma_f32_16x16x32_bf16 v[36:39], a[104:107], v[116:119], v[36:39]
    ds_read_b64_tr_b16 v[142:143], v147 offset:38912
    v_add_u32 v148, 0x10000, v144
    v_mfma_f32_16x16x32_bf16 v[40:43], a[96:99], v[120:123], v[40:43]
    v_add_u32 v149, 0x10000, v145
    v_mfma_f32_16x16x32_bf16 v[44:47], a[100:103], v[120:123], v[44:47]
    v_add_u32 v150, 0x10000, v146
    v_mfma_f32_16x16x32_bf16 v[48:51], a[104:107], v[120:123], v[48:51]
    v_mfma_f32_16x16x32_bf16 v[52:55], a[96:99], v[124:127], v[52:55]
    v_mfma_f32_16x16x32_bf16 v[56:59], a[100:103], v[124:127], v[56:59]
    v_mfma_f32_16x16x32_bf16 v[60:63], a[104:107], v[124:127], v[60:63]
    s_waitcnt lgkmcnt(0)
    v_mfma_f32_16x16x32_bf16 v[16:19], a[108:111], v[128:131], v[16:19]
    ds_read_b64_tr_b16 v[112:113], v144 offset:40960
    buffer_load_dwordx4 v[184:187], v4, s[44:47], s23 offen offset:0 sc1
    v_mfma_f32_16x16x32_bf16 v[20:23], a[112:115], v[128:131], v[20:23]
    ds_read_b64_tr_b16 v[114:115], v144 offset:43008
    buffer_load_dwordx4 v[72:75], v5, s[44:47], s23 offen offset:1024 sc1
    v_mfma_f32_16x16x32_bf16 v[24:27], a[116:119], v[128:131], v[24:27]
    ds_read_b64_tr_b16 v[116:117], v145 offset:40960
    v_mfma_f32_16x16x32_bf16 v[156:159], v[128:131], v[128:131], v[156:159]
    ds_read_b64_tr_b16 v[118:119], v145 offset:43008
    buffer_load_dwordx4 a[212:215], v15, s[44:47], s92 offen offset:1024 sc1
    v_mfma_f32_16x16x32_bf16 v[160:163], v[172:175], v[128:131], v[160:163]
    ds_read_b64_tr_b16 v[120:121], v146 offset:40960
    v_mfma_f32_16x16x32_bf16 v[28:31], a[108:111], v[132:135], v[28:31]
    ds_read_b64_tr_b16 v[122:123], v146 offset:43008
    buffer_load_dwordx4 a[216:219], v15, s[44:47], s92 offen offset:2048 sc1
    v_mfma_f32_16x16x32_bf16 v[32:35], a[112:115], v[132:135], v[32:35]
    ds_read_b64_tr_b16 v[124:125], v147 offset:40960
    v_add_u32 v151, 0x10000, v147
    v_mfma_f32_16x16x32_bf16 v[36:39], a[116:119], v[132:135], v[36:39]
    ds_read_b64_tr_b16 v[126:127], v147 offset:43008
    v_add_u32 v152, 0x20000, v144
    v_mfma_f32_16x16x32_bf16 v[40:43], a[108:111], v[136:139], v[40:43]
    v_add_u32 v153, 0x20000, v145
    v_mfma_f32_16x16x32_bf16 v[44:47], a[112:115], v[136:139], v[44:47]
    v_mfma_f32_16x16x32_bf16 v[48:51], a[116:119], v[136:139], v[48:51]
    v_mfma_f32_16x16x32_bf16 v[52:55], a[108:111], v[140:143], v[52:55]
    v_mfma_f32_16x16x32_bf16 v[56:59], a[112:115], v[140:143], v[56:59]
    v_mfma_f32_16x16x32_bf16 v[60:63], a[116:119], v[140:143], v[60:63]
    s_waitcnt vmcnt(10)
    s_cmp_lg_u32 s60, 3
    s_cbranch_scc1 L_n3_20
    s_waitcnt vmcnt(13)
    v_and_b32 v88, v84, v85
    v_or_b32 v89, v84, v85
    v_bitop3_b32 v88, v88, v86, v87 bitop3:0x80
    v_or3_b32 v89, v89, v86, v87
    v_xor_b32 v88, s63, v88
    v_xor_b32 v89, s63, v89
    v_or_b32 v88, v88, v89
    v_cmp_ne_u32 vcc, 0, v88
    s_cbranch_vccz L_pdone_22
    s_mov_b32 s82, 0
L_poll_21:
    buffer_load_dword v84, v15, s[44:47], s75 offen offset:0 sc1
    buffer_load_dword v85, v15, s[44:47], s75 offen offset:1024 sc1
    buffer_load_dword v86, v15, s[44:47], s75 offen offset:2048 sc1
    buffer_load_dword v87, v15, s[44:47], s75 offen offset:3072 sc1
    s_waitcnt vmcnt(0)
    v_and_b32 v88, v84, v85
    v_or_b32_e64 v89, v84, v85
    v_bitop3_b32 v88, v88, v86, v87 bitop3:0x80
    v_or3_b32 v89, v89, v86, v87
    v_xor_b32 v88, s63, v88
    v_xor_b32 v89, s63, v89
    v_or_b32 v88, v88, v89
    v_cmp_ne_u32 vcc, 0, v88
    s_cbranch_vccz L_pdone_22
    s_add_u32 s82, s82, 1
    s_cmp_lt_u32 s82, 400000
    s_cbranch_scc1 L_poll_21
L_pdone_22:
L_n3_20:
    s_barrier
    s_waitcnt lgkmcnt(0)
    v_mfma_f32_16x16x32_bf16 v[16:19], a[120:123], v[112:115], v[16:19]
    ds_read_b64_tr_b16 v[128:129], v144 offset:45056
    buffer_load_dwordx4 a[220:223], v15, s[44:47], s92 offen offset:3072 sc1
    v_mfma_f32_16x16x32_bf16 v[20:23], a[124:127], v[112:115], v[20:23]
    ds_read_b64_tr_b16 v[130:131], v144 offset:47104
    s_add_u32 s92, s92, 4096
    v_mfma_f32_16x16x32_bf16 v[24:27], a[128:131], v[112:115], v[24:27]
    ds_read_b64_tr_b16 v[132:133], v145 offset:45056
    buffer_load_dwordx4 a[224:227], v15, s[44:47], s92 offen offset:0 sc1
    v_mfma_f32_16x16x32_bf16 v[156:159], v[112:115], v[112:115], v[156:159]
    ds_read_b64_tr_b16 v[134:135], v145 offset:47104
    v_add_u32 v154, 0x20000, v146
    v_mfma_f32_16x16x32_bf16 v[160:163], v[172:175], v[112:115], v[160:163]
    ds_read_b64_tr_b16 v[136:137], v146 offset:45056
    v_add_u32 v155, 0x20000, v147
    v_mfma_f32_16x16x32_bf16 v[28:31], a[120:123], v[116:119], v[28:31]
    ds_read_b64_tr_b16 v[138:139], v146 offset:47104
    s_add_u32 m0, s93, 81920
    v_mfma_f32_16x16x32_bf16 v[32:35], a[124:127], v[116:119], v[32:35]
    ds_read_b64_tr_b16 v[140:141], v147 offset:45056
    s_add_u32 s97, s93, 1310720
    v_mfma_f32_16x16x32_bf16 v[36:39], a[128:131], v[116:119], v[36:39]
    ds_read_b64_tr_b16 v[142:143], v147 offset:47104
    buffer_load_dwordx4 v14, s[40:43], s97 offen offset:0 sc1 lds
    v_mfma_f32_16x16x32_bf16 v[40:43], a[120:123], v[120:123], v[40:43]
    buffer_load_dwordx4 v14, s[40:43], s97 offen offset:1024 sc1 lds
    v_mfma_f32_16x16x32_bf16 v[44:47], a[124:127], v[120:123], v[44:47]
    v_mfma_f32_16x16x32_bf16 v[48:51], a[128:131], v[120:123], v[48:51]
    v_mfma_f32_16x16x32_bf16 v[52:55], a[120:123], v[124:127], v[52:55]
    v_mfma_f32_16x16x32_bf16 v[56:59], a[124:127], v[124:127], v[56:59]
    v_mfma_f32_16x16x32_bf16 v[60:63], a[128:131], v[124:127], v[60:63]
    s_waitcnt lgkmcnt(0)
    v_mfma_f32_16x16x32_bf16 v[16:19], a[132:135], v[128:131], v[16:19]
    ds_read_b64_tr_b16 v[112:113], v144 offset:49152
    v_mfma_f32_16x16x32_bf16 v[20:23], a[136:139], v[128:131], v[20:23]
    ds_read_b64_tr_b16 v[114:115], v144 offset:51200
    buffer_load_dwordx4 a[228:231], v15, s[44:47], s92 offen offset:1024 sc1
    v_mfma_f32_16x16x32_bf16 v[24:27], a[140:143], v[128:131], v[24:27]
    ds_read_b64_tr_b16 v[116:117], v145 offset:49152
    buffer_load_dwordx4 a[232:235], v15, s[44:47], s92 offen offset:2048 sc1
    v_mfma_f32_16x16x32_bf16 v[156:159], v[128:131], v[128:131], v[156:159]
    ds_read_b64_tr_b16 v[118:119], v145 offset:51200
    s_add_u32 s67, s93, 147456
    v_mfma_f32_16x16x32_bf16 v[160:163], v[172:175], v[128:131], v[160:163]
    ds_read_b64_tr_b16 v[120:121], v146 offset:49152
    v_add_u32_e64 v190, s67, v15
    v_mfma_f32_16x16x32_bf16 v[28:31], a[132:135], v[132:135], v[28:31]
    ds_read_b64_tr_b16 v[122:123], v146 offset:51200
    s_lshr_b32 s64, s60, 1
    v_mfma_f32_16x16x32_bf16 v[32:35], a[136:139], v[132:135], v[32:35]
    ds_read_b64_tr_b16 v[124:125], v147 offset:49152
    s_and_b32 s66, s60, 1
    v_mfma_f32_16x16x32_bf16 v[36:39], a[140:143], v[132:135], v[36:39]
    ds_read_b64_tr_b16 v[126:127], v147 offset:51200
    s_lshl_b32 s65, s64, 7
    v_mfma_f32_16x16x32_bf16 v[40:43], a[132:135], v[136:139], v[40:43]
    s_add_u32 s65, s65, s66
    v_mfma_f32_16x16x32_bf16 v[44:47], a[136:139], v[136:139], v[44:47]
    s_lshl_b32 s65, s65, 3
    v_mfma_f32_16x16x32_bf16 v[48:51], a[140:143], v[136:139], v[48:51]
    buffer_load_dwordx4 v14, s[40:43], s97 offen offset:2048 sc1 lds
    v_mfma_f32_16x16x32_bf16 v[52:55], a[132:135], v[140:143], v[52:55]
    buffer_load_dwordx4 v14, s[40:43], s97 offen offset:3072 sc1 lds
    v_mfma_f32_16x16x32_bf16 v[56:59], a[136:139], v[140:143], v[56:59]
    v_mfma_f32_16x16x32_bf16 v[60:63], a[140:143], v[140:143], v[60:63]
    s_waitcnt lgkmcnt(0)
    v_mfma_f32_16x16x32_bf16 v[16:19], a[144:147], v[112:115], v[16:19]
    ds_read_b64_tr_b16 v[128:129], v144 offset:53248
    buffer_load_dwordx4 a[236:239], v15, s[44:47], s92 offen offset:3072 sc1
    v_mfma_f32_16x16x32_bf16 v[20:23], a[148:151], v[112:115], v[20:23]
    ds_read_b64_tr_b16 v[130:131], v144 offset:55296
    s_add_u32 s92, s92, 4096
    v_mfma_f32_16x16x32_bf16 v[24:27], a[152:155], v[112:115], v[24:27]
    ds_read_b64_tr_b16 v[132:133], v145 offset:53248
    v_mfma_f32_16x16x32_bf16 v[156:159], v[112:115], v[112:115], v[156:159]
    ds_read_b64_tr_b16 v[134:135], v145 offset:55296
    v_add_u32_e64 v192, s65, v190
    v_mfma_f32_16x16x32_bf16 v[160:163], v[172:175], v[112:115], v[160:163]
    ds_read_b64_tr_b16 v[136:137], v146 offset:53248
    s_lshl_b32 s66, s66, 6
    v_mfma_f32_16x16x32_bf16 v[28:31], a[144:147], v[116:119], v[28:31]
    ds_read_b64_tr_b16 v[138:139], v146 offset:55296
    s_add_u32 s64, s64, s66
    v_mfma_f32_16x16x32_bf16 v[32:35], a[148:151], v[116:119], v[32:35]
    ds_read_b64_tr_b16 v[140:141], v147 offset:53248
    s_lshl_b32 s64, s64, 3
    v_mfma_f32_16x16x32_bf16 v[36:39], a[152:155], v[116:119], v[36:39]
    ds_read_b64_tr_b16 v[142:143], v147 offset:55296
    s_add_u32 s64, s64, s67
    v_mfma_f32_16x16x32_bf16 v[40:43], a[144:147], v[120:123], v[40:43]
    s_add_u32 s64, s64, 2048
    v_mfma_f32_16x16x32_bf16 v[44:47], a[148:151], v[120:123], v[44:47]
    s_add_u32 m0, s93, 98304
    v_mfma_f32_16x16x32_bf16 v[48:51], a[152:155], v[120:123], v[48:51]
    s_add_u32 s97, s93, 1327104
    v_mfma_f32_16x16x32_bf16 v[52:55], a[144:147], v[124:127], v[52:55]
    buffer_load_dwordx4 v14, s[40:43], s97 offen offset:0 sc1 lds
    v_mfma_f32_16x16x32_bf16 v[56:59], a[148:151], v[124:127], v[56:59]
    buffer_load_dwordx4 v14, s[40:43], s97 offen offset:1024 sc1 lds
    v_mfma_f32_16x16x32_bf16 v[60:63], a[152:155], v[124:127], v[60:63]
    s_waitcnt vmcnt(22)
    s_waitcnt lgkmcnt(0)
    v_mfma_f32_16x16x32_bf16 v[16:19], a[156:159], v[128:131], v[16:19]
    ds_read_b64_tr_b16 v[112:113], v144 offset:57344
    v_and_b32 v7, 1, v11
    v_mfma_f32_16x16x32_bf16 v[20:23], a[160:163], v[128:131], v[20:23]
    ds_read_b64_tr_b16 v[114:115], v144 offset:59392
    v_lshlrev_b32 v7, 8, v7
    v_mfma_f32_16x16x32_bf16 v[24:27], a[164:167], v[128:131], v[24:27]
    ds_read_b64_tr_b16 v[116:117], v145 offset:57344
    v_lshl_add_u32 v7, v10, 4, v7
    v_mfma_f32_16x16x32_bf16 v[156:159], v[128:131], v[128:131], v[156:159]
    ds_read_b64_tr_b16 v[118:119], v145 offset:59392
    v_lshrrev_b32_e64 v8, 1, v11
    v_mfma_f32_16x16x32_bf16 v[160:163], v[172:175], v[128:131], v[160:163]
    ds_read_b64_tr_b16 v[120:121], v146 offset:57344
    v_lshl_add_u32 v7, v8, 2, v7
    v_mfma_f32_16x16x32_bf16 v[28:31], a[156:159], v[132:135], v[28:31]
    ds_read_b64_tr_b16 v[122:123], v146 offset:59392
    v_add_u32_e64 v196, s64, v7
    v_mfma_f32_16x16x32_bf16 v[32:35], a[160:163], v[132:135], v[32:35]
    ds_read_b64_tr_b16 v[124:125], v147 offset:57344
    buffer_load_dwordx4 v14, s[40:43], s97 offen offset:2048 sc1 lds
    v_mfma_f32_16x16x32_bf16 v[36:39], a[164:167], v[132:135], v[36:39]
    ds_read_b64_tr_b16 v[126:127], v147 offset:59392
    buffer_load_dwordx4 v14, s[40:43], s97 offen offset:3072 sc1 lds
    v_mfma_f32_16x16x32_bf16 v[40:43], a[156:159], v[136:139], v[40:43]
    v_mfma_f32_16x16x32_bf16 v[44:47], a[160:163], v[136:139], v[44:47]
    v_mfma_f32_16x16x32_bf16 v[48:51], a[164:167], v[136:139], v[48:51]
    v_mfma_f32_16x16x32_bf16 v[52:55], a[156:159], v[140:143], v[52:55]
    v_mfma_f32_16x16x32_bf16 v[56:59], a[160:163], v[140:143], v[56:59]
    v_mfma_f32_16x16x32_bf16 v[60:63], a[164:167], v[140:143], v[60:63]
    s_waitcnt lgkmcnt(0)
    v_mfma_f32_16x16x32_bf16 v[16:19], a[168:171], v[112:115], v[16:19]
    ds_read_b64_tr_b16 v[128:129], v144 offset:61440
    s_waitcnt vmcnt(15)
    v_add_f32_e64 v176, v176, v64
    v_mfma_f32_16x16x32_bf16 v[20:23], a[172:175], v[112:115], v[20:23]
    ds_read_b64_tr_b16 v[130:131], v144 offset:63488
    v_add_f32 v177, v177, v65
    v_add_f32 v178, v178, v66
    v_mfma_f32_16x16x32_bf16 v[24:27], a[176:179], v[112:115], v[24:27]
    ds_read_b64_tr_b16 v[132:133], v145 offset:61440
    v_add_f32 v179, v179, v67
    v_add_f32 v180, v180, v68
    v_mfma_f32_16x16x32_bf16 v[156:159], v[112:115], v[112:115], v[156:159]
    ds_read_b64_tr_b16 v[134:135], v145 offset:63488
    v_add_f32_e64 v181, v181, v69
    v_mfma_f32_16x16x32_bf16 v[160:163], v[172:175], v[112:115], v[160:163]
    ds_read_b64_tr_b16 v[136:137], v146 offset:61440
    v_add_f32_e64 v182, v182, v70
    v_mfma_f32_16x16x32_bf16 v[28:31], a[168:171], v[116:119], v[28:31]
    ds_read_b64_tr_b16 v[138:139], v146 offset:63488
    v_add_f32 v183, v183, v71
    v_mfma_f32_16x16x32_bf16 v[32:35], a[172:175], v[116:119], v[32:35]
    ds_read_b64_tr_b16 v[140:141], v147 offset:61440
    v_add_f32 v184, v184, v72
    v_mfma_f32_16x16x32_bf16 v[36:39], a[176:179], v[116:119], v[36:39]
    ds_read_b64_tr_b16 v[142:143], v147 offset:63488
    v_add_f32 v185, v185, v73
    v_mfma_f32_16x16x32_bf16 v[40:43], a[168:171], v[120:123], v[40:43]
    v_add_f32 v186, v186, v74
    v_add_f32_e64 v187, v187, v75
    v_mfma_f32_16x16x32_bf16 v[44:47], a[172:175], v[120:123], v[44:47]
    s_add_u32 s67, s67, 3072
    v_lshl_add_u32 v6, v10, 3, s67
    v_mfma_f32_16x16x32_bf16 v[48:51], a[176:179], v[120:123], v[48:51]
    v_xor_b32 v193, 4096, v192
    v_xor_b32 v197, 4096, v196
    v_mfma_f32_16x16x32_bf16 v[52:55], a[168:171], v[124:127], v[52:55]
    v_xor_b32 v7, 4096, v6
    v_xor_b32 v194, 8192, v192
    v_mfma_f32_16x16x32_bf16 v[56:59], a[172:175], v[124:127], v[56:59]
    s_add_u32 m0, s93, 114688
    s_add_u32 s97, s93, 1343488
    v_mfma_f32_16x16x32_bf16 v[60:63], a[176:179], v[124:127], v[60:63]
    buffer_load_dwordx4 v14, s[40:43], s97 offen offset:0 sc1 lds
    buffer_load_dwordx4 v14, s[40:43], s97 offen offset:1024 sc1 lds
    s_waitcnt lgkmcnt(0)
    v_mfma_f32_16x16x32_bf16 v[16:19], a[180:183], v[128:131], v[16:19]
    ds_read_b64_tr_b16 v[112:113], v148 offset:0
    v_add_f32_dpp v176, v176, v176 quad_perm:[1,0,3,2] row_mask:0xf bank_mask:0xf
    v_add_f32_dpp v177, v177, v177 quad_perm:[1,0,3,2] row_mask:0xf bank_mask:0xf
    v_mfma_f32_16x16x32_bf16 v[20:23], a[184:187], v[128:131], v[20:23]
    ds_read_b64_tr_b16 v[114:115], v148 offset:2048
    v_add_f32_dpp v178, v178, v178 quad_perm:[1,0,3,2] row_mask:0xf bank_mask:0xf
    v_add_f32_dpp v179, v179, v179 quad_perm:[1,0,3,2] row_mask:0xf bank_mask:0xf
    v_mfma_f32_16x16x32_bf16 v[24:27], a[188:191], v[128:131], v[24:27]
    ds_read_b64_tr_b16 v[116:117], v149 offset:0
    v_add_f32_dpp v180, v180, v180 quad_perm:[1,0,3,2] row_mask:0xf bank_mask:0xf
    v_add_f32_dpp v181, v181, v181 quad_perm:[1,0,3,2] row_mask:0xf bank_mask:0xf
    v_mfma_f32_16x16x32_bf16 v[156:159], v[128:131], v[128:131], v[156:159]
    ds_read_b64_tr_b16 v[118:119], v149 offset:2048
    v_add_f32_dpp v182, v182, v182 quad_perm:[1,0,3,2] row_mask:0xf bank_mask:0xf
    v_add_f32_dpp v183, v183, v183 quad_perm:[1,0,3,2] row_mask:0xf bank_mask:0xf
    v_mfma_f32_16x16x32_bf16 v[160:163], v[172:175], v[128:131], v[160:163]
    ds_read_b64_tr_b16 v[120:121], v150 offset:0
    v_add_f32_dpp v184, v184, v184 quad_perm:[1,0,3,2] row_mask:0xf bank_mask:0xf
    v_add_f32_dpp v185, v185, v185 quad_perm:[1,0,3,2] row_mask:0xf bank_mask:0xf
    v_mfma_f32_16x16x32_bf16 v[28:31], a[180:183], v[132:135], v[28:31]
    ds_read_b64_tr_b16 v[122:123], v150 offset:2048
    v_add_f32_dpp v186, v186, v186 quad_perm:[1,0,3,2] row_mask:0xf bank_mask:0xf
    v_mfma_f32_16x16x32_bf16 v[32:35], a[184:187], v[132:135], v[32:35]
    ds_read_b64_tr_b16 v[124:125], v151 offset:0
    v_add_f32_dpp v187, v187, v187 quad_perm:[1,0,3,2] row_mask:0xf bank_mask:0xf
    v_mfma_f32_16x16x32_bf16 v[36:39], a[188:191], v[132:135], v[36:39]
    ds_read_b64_tr_b16 v[126:127], v151 offset:2048
    v_xor_b32 v198, 8192, v196
    v_mfma_f32_16x16x32_bf16 v[40:43], a[180:183], v[136:139], v[40:43]
    v_xor_b32 v8, 8192, v6
    v_xor_b32 v195, 12288, v192
    v_mfma_f32_16x16x32_bf16 v[44:47], a[184:187], v[136:139], v[44:47]
    v_xor_b32 v199, 12288, v196
    v_xor_b32 v9, 12288, v6
    v_mfma_f32_16x16x32_bf16 v[48:51], a[188:191], v[136:139], v[48:51]
    v_and_b32 v188, 1, v0
    v_cmp_eq_u32 s[68:69], 1, v188
    v_mfma_f32_16x16x32_bf16 v[52:55], a[180:183], v[140:143], v[52:55]
    buffer_load_dwordx4 v14, s[40:43], s97 offen offset:2048 sc1 lds
    buffer_load_dwordx4 v14, s[40:43], s97 offen offset:3072 sc1 lds
    v_mfma_f32_16x16x32_bf16 v[56:59], a[184:187], v[140:143], v[56:59]
    buffer_load_dwordx4 v[220:223], v15, s[44:47], s96 offen offset:0 sc1
    v_mfma_f32_16x16x32_bf16 v[60:63], a[188:191], v[140:143], v[60:63]
    buffer_load_dwordx4 v[224:227], v15, s[44:47], s96 offen offset:1024 sc1
    buffer_load_dwordx4 v[228:231], v15, s[44:47], s96 offen offset:2048 sc1
    s_waitcnt lgkmcnt(0)
    v_mfma_f32_16x16x32_bf16 v[16:19], a[192:195], v[112:115], v[16:19]
    ds_read_b64_tr_b16 v[128:129], v148 offset:4096
    v_add_f32_dpp v176, v176, v176 quad_perm:[2,3,0,1] row_mask:0xf bank_mask:0xf
    v_add_f32_dpp v177, v177, v177 quad_perm:[2,3,0,1] row_mask:0xf bank_mask:0xf
    v_mfma_f32_16x16x32_bf16 v[20:23], a[196:199], v[112:115], v[20:23]
    ds_read_b64_tr_b16 v[130:131], v148 offset:6144
    v_add_f32_dpp v178, v178, v178 quad_perm:[2,3,0,1] row_mask:0xf bank_mask:0xf
    v_mfma_f32_16x16x32_bf16 v[24:27], a[200:203], v[112:115], v[24:27]
    ds_read_b64_tr_b16 v[132:133], v149 offset:4096
    v_add_f32_dpp v179, v179, v179 quad_perm:[2,3,0,1] row_mask:0xf bank_mask:0xf
    v_mfma_f32_16x16x32_bf16 v[156:159], v[112:115], v[112:115], v[156:159]
    ds_read_b64_tr_b16 v[134:135], v149 offset:6144
    v_add_f32_dpp v180, v180, v180 quad_perm:[2,3,0,1] row_mask:0xf bank_mask:0xf
    v_mfma_f32_16x16x32_bf16 v[160:163], v[172:175], v[112:115], v[160:163]
    ds_read_b64_tr_b16 v[136:137], v150 offset:4096
    v_add_f32_dpp v181, v181, v181 quad_perm:[2,3,0,1] row_mask:0xf bank_mask:0xf
    v_mfma_f32_16x16x32_bf16 v[28:31], a[192:195], v[116:119], v[28:31]
    ds_read_b64_tr_b16 v[138:139], v150 offset:6144
    v_add_f32_dpp v182, v182, v182 quad_perm:[2,3,0,1] row_mask:0xf bank_mask:0xf
    v_mfma_f32_16x16x32_bf16 v[32:35], a[196:199], v[116:119], v[32:35]
    ds_read_b64_tr_b16 v[140:141], v151 offset:4096
    v_add_f32_dpp v183, v183, v183 quad_perm:[2,3,0,1] row_mask:0xf bank_mask:0xf
    v_mfma_f32_16x16x32_bf16 v[36:39], a[200:203], v[116:119], v[36:39]
    ds_read_b64_tr_b16 v[142:143], v151 offset:6144
    v_add_f32_dpp v184, v184, v184 quad_perm:[2,3,0,1] row_mask:0xf bank_mask:0xf
    v_mfma_f32_16x16x32_bf16 v[40:43], a[192:195], v[120:123], v[40:43]
    v_add_f32_dpp v185, v185, v185 quad_perm:[2,3,0,1] row_mask:0xf bank_mask:0xf
    v_add_f32_dpp v186, v186, v186 quad_perm:[2,3,0,1] row_mask:0xf bank_mask:0xf
    v_mfma_f32_16x16x32_bf16 v[44:47], a[196:199], v[120:123], v[44:47]
    v_add_f32_dpp v187, v187, v187 quad_perm:[2,3,0,1] row_mask:0xf bank_mask:0xf
    v_and_b32 v188, 2, v0
    v_mfma_f32_16x16x32_bf16 v[48:51], a[200:203], v[120:123], v[48:51]
    v_cmp_eq_u32 s[70:71], 2, v188
    v_lshrrev_b32_e64 v188, 2, v10
    v_mfma_f32_16x16x32_bf16 v[52:55], a[192:195], v[124:127], v[52:55]
    v_cmp_eq_u32 s[64:65], v188, v11
    v_add_u32 v188, 512, v6
    v_mfma_f32_16x16x32_bf16 v[56:59], a[196:199], v[124:127], v[56:59]
    v_cndmask_b32 v191, v188, v6, s[64:65]
    buffer_load_dwordx4 v[232:235], v15, s[44:47], s96 offen offset:3072 sc1
    v_mfma_f32_16x16x32_bf16 v[60:63], a[200:203], v[124:127], v[60:63]
    s_add_u32 s96, s96, 4096
    buffer_load_dwordx4 v[236:239], v15, s[44:47], s96 offen offset:0 sc1
    s_waitcnt vmcnt(13)
    s_waitcnt lgkmcnt(0)
    v_mfma_f32_16x16x32_bf16 v[16:19], a[204:207], v[128:131], v[16:19]
    ds_read_b64_tr_b16 v[112:113], v148 offset:8192
    v_add_f32_dpp v176, v176, v176 row_half_mirror row_mask:0xf bank_mask:0xf
    v_add_f32_dpp v177, v177, v177 row_half_mirror row_mask:0xf bank_mask:0xf
    v_mfma_f32_16x16x32_bf16 v[20:23], a[208:211], v[128:131], v[20:23]
    ds_read_b64_tr_b16 v[114:115], v148 offset:10240
    v_add_f32_dpp v178, v178, v178 row_half_mirror row_mask:0xf bank_mask:0xf
    v_mfma_f32_16x16x32_bf16 v[24:27], a[212:215], v[128:131], v[24:27]
    ds_read_b64_tr_b16 v[116:117], v149 offset:8192
    v_add_f32_dpp v179, v179, v179 row_half_mirror row_mask:0xf bank_mask:0xf
    v_mfma_f32_16x16x32_bf16 v[156:159], v[128:131], v[128:131], v[156:159]
    ds_read_b64_tr_b16 v[118:119], v149 offset:10240
    v_add_f32_dpp v180, v180, v180 row_half_mirror row_mask:0xf bank_mask:0xf
    v_mfma_f32_16x16x32_bf16 v[160:163], v[172:175], v[128:131], v[160:163]
    ds_read_b64_tr_b16 v[120:121], v150 offset:8192
    v_add_f32_dpp v181, v181, v181 row_half_mirror row_mask:0xf bank_mask:0xf
    v_mfma_f32_16x16x32_bf16 v[28:31], a[204:207], v[132:135], v[28:31]
    ds_read_b64_tr_b16 v[122:123], v150 offset:10240
    v_add_f32_dpp v182, v182, v182 row_half_mirror row_mask:0xf bank_mask:0xf
    v_mfma_f32_16x16x32_bf16 v[32:35], a[208:211], v[132:135], v[32:35]
    ds_read_b64_tr_b16 v[124:125], v151 offset:8192
    v_add_f32_dpp v183, v183, v183 row_half_mirror row_mask:0xf bank_mask:0xf
    v_mfma_f32_16x16x32_bf16 v[36:39], a[212:215], v[132:135], v[36:39]
    ds_read_b64_tr_b16 v[126:127], v151 offset:10240
    v_add_f32_dpp v184, v184, v184 row_half_mirror row_mask:0xf bank_mask:0xf
    v_mfma_f32_16x16x32_bf16 v[40:43], a[204:207], v[136:139], v[40:43]
    v_add_f32_dpp v185, v185, v185 row_half_mirror row_mask:0xf bank_mask:0xf
    v_add_f32_dpp v186, v186, v186 row_half_mirror row_mask:0xf bank_mask:0xf
    v_mfma_f32_16x16x32_bf16 v[44:47], a[208:211], v[136:139], v[44:47]
    v_add_f32_dpp v187, v187, v187 row_half_mirror row_mask:0xf bank_mask:0xf
    s_lshl_b32 s95, s76, 5
    v_mfma_f32_16x16x32_bf16 v[48:51], a[212:215], v[136:139], v[48:51]
    s_add_u32 s95, s95, s77
    s_lshl_b32 s73, s95, 6
    v_mfma_f32_16x16x32_bf16 v[52:55], a[204:207], v[140:143], v[52:55]
    s_add_u32 s73, s73, 98304
    s_lshl_b32 s95, s95, 2
    v_mfma_f32_16x16x32_bf16 v[56:59], a[208:211], v[140:143], v[56:59]
    s_add_u32 s95, s95, s60
    buffer_load_dwordx4 v[240:243], v15, s[44:47], s96 offen offset:1024 sc1
    v_mfma_f32_16x16x32_bf16 v[60:63], a[212:215], v[140:143], v[60:63]
    buffer_load_dwordx4 v[244:247], v15, s[44:47], s96 offen offset:2048 sc1
    buffer_load_dwordx4 v[248:251], v15, s[44:47], s96 offen offset:3072 sc1
    s_waitcnt lgkmcnt(0)
    v_mfma_f32_16x16x32_bf16 v[16:19], a[216:219], v[112:115], v[16:19]
    ds_read_b64_tr_b16 v[128:129], v148 offset:12288
    v_add_f32_dpp v176, v176, v176 row_mirror row_mask:0xf bank_mask:0xf
    v_add_f32_dpp v177, v177, v177 row_mirror row_mask:0xf bank_mask:0xf
    v_mfma_f32_16x16x32_bf16 v[20:23], a[220:223], v[112:115], v[20:23]
    ds_read_b64_tr_b16 v[130:131], v148 offset:14336
    v_add_f32_dpp v178, v178, v178 row_mirror row_mask:0xf bank_mask:0xf
    v_mfma_f32_16x16x32_bf16 v[24:27], a[224:227], v[112:115], v[24:27]
    ds_read_b64_tr_b16 v[132:133], v149 offset:12288
    v_add_f32_dpp v179, v179, v179 row_mirror row_mask:0xf bank_mask:0xf
    v_mfma_f32_16x16x32_bf16 v[156:159], v[112:115], v[112:115], v[156:159]
    ds_read_b64_tr_b16 v[134:135], v149 offset:14336
    v_add_f32_dpp v180, v180, v180 row_mirror row_mask:0xf bank_mask:0xf
    v_mfma_f32_16x16x32_bf16 v[160:163], v[172:175], v[112:115], v[160:163]
    ds_read_b64_tr_b16 v[136:137], v150 offset:12288
    v_add_f32_dpp v181, v181, v181 row_mirror row_mask:0xf bank_mask:0xf
    v_mfma_f32_16x16x32_bf16 v[28:31], a[216:219], v[116:119], v[28:31]
    ds_read_b64_tr_b16 v[138:139], v150 offset:14336
    v_add_f32_dpp v182, v182, v182 row_mirror row_mask:0xf bank_mask:0xf
    v_mfma_f32_16x16x32_bf16 v[32:35], a[220:223], v[116:119], v[32:35]
    ds_read_b64_tr_b16 v[140:141], v151 offset:12288
    v_add_f32_dpp v183, v183, v183 row_mirror row_mask:0xf bank_mask:0xf
    v_mfma_f32_16x16x32_bf16 v[36:39], a[224:227], v[116:119], v[36:39]
    ds_read_b64_tr_b16 v[142:143], v151 offset:14336
    v_add_f32_dpp v184, v184, v184 row_mirror row_mask:0xf bank_mask:0xf
    v_mfma_f32_16x16x32_bf16 v[40:43], a[216:219], v[120:123], v[40:43]
    v_add_f32_dpp v185, v185, v185 row_mirror row_mask:0xf bank_mask:0xf
    v_add_f32_dpp v186, v186, v186 row_mirror row_mask:0xf bank_mask:0xf
    v_mfma_f32_16x16x32_bf16 v[44:47], a[220:223], v[120:123], v[44:47]
    v_add_f32_dpp v187, v187, v187 row_mirror row_mask:0xf bank_mask:0xf
    s_mul_i32 s95, s95, 3072
    v_mfma_f32_16x16x32_bf16 v[48:51], a[224:227], v[120:123], v[48:51]
    s_add_u32 s95, s95, 12189696
    s_lshl_b32 s64, s78, 11
    v_mfma_f32_16x16x32_bf16 v[52:55], a[216:219], v[124:127], v[52:55]
    s_add_u32 s64, s64, 98304
    v_min_u32 v252, 15, v0
    v_mfma_f32_16x16x32_bf16 v[56:59], a[220:223], v[124:127], v[56:59]
    v_lshl_add_u32 v252, v252, 6, s64
    s_add_u32 s96, s96, 4096
    v_mfma_f32_16x16x32_bf16 v[60:63], a[224:227], v[124:127], v[60:63]
    buffer_load_dwordx4 a[240:243], v15, s[44:47], s96 offen offset:0 sc1
    buffer_load_dwordx4 a[244:247], v15, s[44:47], s96 offen offset:1024 sc1
    s_waitcnt lgkmcnt(0)
    v_mfma_f32_16x16x32_bf16 v[156:159], v[128:131], v[128:131], v[156:159]
    s_lshl_b32 s74, s78, 3
    s_add_u32 s74, s74, s60
    v_mfma_f32_16x16x32_bf16 v[160:163], v[172:175], v[128:131], v[160:163]
    s_lshl_b32 s74, s74, 3
    s_add_u32 s74, s74, s79
    v_mfma_f32_16x16x32_bf16 v[16:19], a[228:231], v[128:131], v[16:19]
    s_mul_i32 s74, s74, 6144
    s_add_u32 s74, s74, 12189696
    v_mfma_f32_16x16x32_bf16 v[20:23], a[232:235], v[128:131], v[20:23]
    buffer_load_dwordx4 a[248:251], v15, s[44:47], s96 offen offset:2048 sc1
    v_mfma_f32_16x16x32_bf16 v[24:27], a[236:239], v[128:131], v[24:27]
    buffer_load_dwordx4 a[252:255], v15, s[44:47], s96 offen offset:3072 sc1
    v_mfma_f32_16x16x32_bf16 v[28:31], a[228:231], v[132:135], v[28:31]
    s_add_u32 s96, s96, 4096
    v_mfma_f32_16x16x32_bf16 v[32:35], a[232:235], v[132:135], v[32:35]
    v_mfma_f32_16x16x32_bf16 v[36:39], a[236:239], v[132:135], v[36:39]
    v_cndmask_b32 v4, v156, v157, s[68:69]
    v_cndmask_b32 v5, v158, v159, s[68:69]
    v_mfma_f32_16x16x32_bf16 v[40:43], a[228:231], v[136:139], v[40:43]
    v_mov_b32 v2, v160
    v_cndmask_b32 v3, v4, v5, s[70:71]
    v_mfma_f32_16x16x32_bf16 v[44:47], a[232:235], v[136:139], v[44:47]
    v_mul_f32 v2, 0x3acccccd, v2
    v_mul_f32 v3, 0x3acccccd, v3
    v_mfma_f32_16x16x32_bf16 v[48:51], a[236:239], v[136:139], v[48:51]
    v_fma_f32 v3, -v2, v2, v3
    v_max_f32_e64 v3, 0, v3
    v_mfma_f32_16x16x32_bf16 v[52:55], a[228:231], v[140:143], v[52:55]
    v_cvt_pk_bf16_f32 v3, v3, v3
    v_and_b32_e64 v3, s83, v3
    v_mfma_f32_16x16x32_bf16 v[56:59], a[232:235], v[140:143], v[56:59]
    v_add_f32 v3, 0x3727c5ac, v3
    v_cvt_pk_bf16_f32 v3, v3, v3
    v_mfma_f32_16x16x32_bf16 v[60:63], a[236:239], v[140:143], v[60:63]
    v_and_b32 v3, s83, v3
    v_sqrt_f32 v3, v3
    s_waitcnt vmcnt(21)
    s_barrier
    ds_read_b64_tr_b16 v[112:113], v148 offset:16384
    ds_read_b64_tr_b16 v[114:115], v148 offset:18432
    ds_read_b64_tr_b16 v[116:117], v149 offset:16384
    ds_read_b64_tr_b16 v[118:119], v149 offset:18432
    ds_read_b64_tr_b16 v[120:121], v150 offset:16384
    ds_read_b64_tr_b16 v[122:123], v150 offset:18432
    ds_read_b64_tr_b16 v[124:125], v151 offset:16384
    ds_read_b64_tr_b16 v[126:127], v151 offset:18432
    s_waitcnt lgkmcnt(0)
    v_mfma_f32_16x16x32_bf16 v[64:67], a[0:3], v[112:115], 0
    ds_read_b64_tr_b16 v[128:129], v148 offset:20480
    v_cvt_pk_bf16_f32 v2, v2, v2
    v_mfma_f32_16x16x32_bf16 v[68:71], a[4:7], v[112:115], 0
    ds_read_b64_tr_b16 v[130:131], v148 offset:22528
    v_and_b32 v2, s83, v2
    v_mfma_f32_16x16x32_bf16 v[72:75], a[8:11], v[112:115], 0
    ds_read_b64_tr_b16 v[132:133], v149 offset:20480
    v_cvt_pk_bf16_f32 v3, v3, v3
    v_mfma_f32_16x16x32_bf16 v[164:167], v[112:115], v[112:115], 0
    ds_read_b64_tr_b16 v[134:135], v149 offset:22528
    v_and_b32_e64 v3, s83, v3
    v_mfma_f32_16x16x32_bf16 v[168:171], v[172:175], v[112:115], 0
    ds_read_b64_tr_b16 v[136:137], v150 offset:20480
    v_rcp_f32_e64 v3, v3
    v_mfma_f32_16x16x32_bf16 v[76:79], a[0:3], v[116:119], 0
    ds_read_b64_tr_b16 v[138:139], v150 offset:22528
    v_mul_f32_e64 v3, v3, v3
    v_mfma_f32_16x16x32_bf16 v[80:83], a[4:7], v[116:119], 0
    ds_read_b64_tr_b16 v[140:141], v151 offset:20480
    ds_write_b64 v191, v[2:3]
    v_mfma_f32_16x16x32_bf16 v[84:87], a[8:11], v[116:119], 0
    ds_read_b64_tr_b16 v[142:143], v151 offset:22528
    s_add_u32 m0, s93, 131072
    v_mfma_f32_16x16x32_bf16 v[88:91], a[0:3], v[120:123], 0
    s_add_u32 s97, s93, 1359872
    v_mfma_f32_16x16x32_bf16 v[92:95], a[4:7], v[120:123], 0
    buffer_load_dwordx4 v14, s[40:43], s97 offen offset:0 sc1 lds
    v_mfma_f32_16x16x32_bf16 v[96:99], a[8:11], v[120:123], 0
    buffer_load_dwordx4 v14, s[40:43], s97 offen offset:1024 sc1 lds
    v_mfma_f32_16x16x32_bf16 v[100:103], a[0:3], v[124:127], 0
    v_mfma_f32_16x16x32_bf16 v[104:107], a[4:7], v[124:127], 0
    v_mfma_f32_16x16x32_bf16 v[108:111], a[8:11], v[124:127], 0
    s_waitcnt lgkmcnt(0)
    s_waitcnt vmcnt(14)
    s_barrier
    s_waitcnt lgkmcnt(0)
    v_mfma_f32_16x16x32_bf16 v[64:67], a[12:15], v[128:131], v[64:67]
    ds_read_b64_tr_b16 v[112:113], v148 offset:24576
    ds_read_b64 v[200:201], v6
    v_mfma_f32_16x16x32_bf16 v[68:71], a[16:19], v[128:131], v[68:71]
    ds_read_b64_tr_b16 v[114:115], v148 offset:26624
    ds_read_b64 v[202:203], v7
    v_mfma_f32_16x16x32_bf16 v[72:75], a[20:23], v[128:131], v[72:75]
    ds_read_b64_tr_b16 v[116:117], v149 offset:24576
    ds_read_b64 v[204:205], v8
    v_mfma_f32_16x16x32_bf16 v[164:167], v[128:131], v[128:131], v[164:167]
    ds_read_b64_tr_b16 v[118:119], v149 offset:26624
    ds_read_b64 v[206:207], v9
    v_mfma_f32_16x16x32_bf16 v[168:171], v[172:175], v[128:131], v[168:171]
    ds_read_b64_tr_b16 v[120:121], v150 offset:24576
    buffer_load_dwordx4 v14, s[40:43], s97 offen offset:2048 sc1 lds
    v_mfma_f32_16x16x32_bf16 v[76:79], a[12:15], v[132:135], v[76:79]
    ds_read_b64_tr_b16 v[122:123], v150 offset:26624
    buffer_load_dwordx4 v14, s[40:43], s97 offen offset:3072 sc1 lds
    v_mfma_f32_16x16x32_bf16 v[80:83], a[16:19], v[132:135], v[80:83]
    ds_read_b64_tr_b16 v[124:125], v151 offset:24576
    v_mfma_f32_16x16x32_bf16 v[84:87], a[20:23], v[132:135], v[84:87]
    ds_read_b64_tr_b16 v[126:127], v151 offset:26624
    v_mfma_f32_16x16x32_bf16 v[88:91], a[12:15], v[136:139], v[88:91]
    v_mfma_f32_16x16x32_bf16 v[92:95], a[16:19], v[136:139], v[92:95]
    v_mfma_f32_16x16x32_bf16 v[96:99], a[20:23], v[136:139], v[96:99]
    v_mfma_f32_16x16x32_bf16 v[100:103], a[12:15], v[140:143], v[100:103]
    v_mfma_f32_16x16x32_bf16 v[104:107], a[16:19], v[140:143], v[104:107]
    v_mfma_f32_16x16x32_bf16 v[108:111], a[20:23], v[140:143], v[108:111]
    s_waitcnt lgkmcnt(0)
    v_mfma_f32_16x16x32_bf16 v[64:67], a[24:27], v[112:115], v[64:67]
    ds_read_b64_tr_b16 v[128:129], v148 offset:28672
    v_fma_f32 v24, -v200, v184, v24
    v_fma_f32 v25, -v200, v185, v25
    v_mfma_f32_16x16x32_bf16 v[68:71], a[28:31], v[112:115], v[68:71]
    ds_read_b64_tr_b16 v[130:131], v148 offset:30720
    v_fma_f32 v26, -v200, v186, v26
    v_fma_f32 v27, -v200, v187, v27
    v_mfma_f32_16x16x32_bf16 v[72:75], a[32:35], v[112:115], v[72:75]
    ds_read_b64_tr_b16 v[132:133], v149 offset:28672
    v_fma_f32 v16, -v200, v176, v16
    v_fma_f32 v17, -v200, v177, v17
    v_mfma_f32_16x16x32_bf16 v[164:167], v[112:115], v[112:115], v[164:167]
    ds_read_b64_tr_b16 v[134:135], v149 offset:30720
    v_fma_f32 v18, -v200, v178, v18
    v_fma_f32 v19, -v200, v179, v19
    v_mfma_f32_16x16x32_bf16 v[168:171], v[172:175], v[112:115], v[168:171]
    ds_read_b64_tr_b16 v[136:137], v150 offset:28672
    v_fma_f32 v20, -v200, v180, v20
    v_fma_f32 v21, -v200, v181, v21
    v_mfma_f32_16x16x32_bf16 v[76:79], a[24:27], v[116:119], v[76:79]
    ds_read_b64_tr_b16 v[138:139], v150 offset:30720
    v_fma_f32 v22, -v200, v182, v22
    v_fma_f32 v23, -v200, v183, v23
    v_mfma_f32_16x16x32_bf16 v[80:83], a[28:31], v[116:119], v[80:83]
    ds_read_b64_tr_b16 v[140:141], v151 offset:28672
    v_permlane32_swap_b32 v24, v26
    v_mfma_f32_16x16x32_bf16 v[84:87], a[32:35], v[116:119], v[84:87]
    ds_read_b64_tr_b16 v[142:143], v151 offset:30720
    v_permlane32_swap_b32 v25, v27
    v_mfma_f32_16x16x32_bf16 v[88:91], a[24:27], v[120:123], v[88:91]
    v_mul_f32 v16, v16, v20
    v_mul_f32 v17, v17, v21
    v_mfma_f32_16x16x32_bf16 v[92:95], a[28:31], v[120:123], v[92:95]
    v_mul_f32 v18, v18, v22
    v_mul_f32 v19, v19, v23
    v_mfma_f32_16x16x32_bf16 v[96:99], a[32:35], v[120:123], v[96:99]
    v_mul_f32 v20, v24, v26
    v_mul_f32 v21, v25, v27
    v_mfma_f32_16x16x32_bf16 v[100:103], a[24:27], v[124:127], v[100:103]
    v_mul_f32 v16, v16, v201
    s_add_u32 m0, s93, 0
    v_mfma_f32_16x16x32_bf16 v[104:107], a[28:31], v[124:127], v[104:107]
    s_add_u32 s97, s93, 1376256
    buffer_load_dwordx4 v14, s[40:43], s97 offen offset:0 sc1 lds
    v_mfma_f32_16x16x32_bf16 v[108:111], a[32:35], v[124:127], v[108:111]
    buffer_load_dwordx4 v14, s[40:43], s97 offen offset:1024 sc1 lds
    buffer_load_dwordx4 a[0:3], v15, s[44:47], s96 offen offset:0 sc1
    s_waitcnt lgkmcnt(0)
    v_mfma_f32_16x16x32_bf16 v[64:67], a[36:39], v[128:131], v[64:67]
    ds_read_b64_tr_b16 v[112:113], v148 offset:32768
    v_mul_f32 v17, v17, v201
    v_mul_f32 v18, v18, v201
    v_mfma_f32_16x16x32_bf16 v[68:71], a[40:43], v[128:131], v[68:71]
    ds_read_b64_tr_b16 v[114:115], v148 offset:34816
    v_mul_f32 v19, v19, v201
    v_mul_f32 v20, v20, v201
    v_mfma_f32_16x16x32_bf16 v[72:75], a[44:47], v[128:131], v[72:75]
    ds_read_b64_tr_b16 v[116:117], v149 offset:32768
    v_mul_f32_e64 v21, v21, v201
    v_cvt_pk_bf16_f32 v16, v16, v17
    v_mfma_f32_16x16x32_bf16 v[164:167], v[128:131], v[128:131], v[164:167]
    ds_read_b64_tr_b16 v[118:119], v149 offset:34816
    v_cvt_pk_bf16_f32 v17, v18, v19
    v_cvt_pk_bf16_f32 v18, v20, v21
    v_mfma_f32_16x16x32_bf16 v[168:171], v[172:175], v[128:131], v[168:171]
    ds_read_b64_tr_b16 v[120:121], v150 offset:32768
    ds_write_b64 v192, v[16:17]
    ds_write_b32 v196, v18
    v_mfma_f32_16x16x32_bf16 v[76:79], a[36:39], v[132:135], v[76:79]
    ds_read_b64_tr_b16 v[122:123], v150 offset:34816
    v_fma_f32 v36, -v202, v184, v36
    v_mfma_f32_16x16x32_bf16 v[80:83], a[40:43], v[132:135], v[80:83]
    ds_read_b64_tr_b16 v[124:125], v151 offset:32768
    v_fma_f32 v37, -v202, v185, v37
    v_mfma_f32_16x16x32_bf16 v[84:87], a[44:47], v[132:135], v[84:87]
    ds_read_b64_tr_b16 v[126:127], v151 offset:34816
    v_fma_f32 v38, -v202, v186, v38
    v_mfma_f32_16x16x32_bf16 v[88:91], a[36:39], v[136:139], v[88:91]
    v_fma_f32 v39, -v202, v187, v39
    v_fma_f32 v28, -v202, v176, v28
    v_mfma_f32_16x16x32_bf16 v[92:95], a[40:43], v[136:139], v[92:95]
    v_fma_f32 v29, -v202, v177, v29
    v_fma_f32 v30, -v202, v178, v30
    v_mfma_f32_16x16x32_bf16 v[96:99], a[44:47], v[136:139], v[96:99]
    v_fma_f32 v31, -v202, v179, v31
    v_fma_f32 v32, -v202, v180, v32
    v_mfma_f32_16x16x32_bf16 v[100:103], a[36:39], v[140:143], v[100:103]
    v_fma_f32 v33, -v202, v181, v33
    v_fma_f32 v34, -v202, v182, v34
    v_mfma_f32_16x16x32_bf16 v[104:107], a[40:43], v[140:143], v[104:107]
    buffer_load_dwordx4 v14, s[40:43], s97 offen offset:2048 sc1 lds
    buffer_load_dwordx4 v14, s[40:43], s97 offen offset:3072 sc1 lds
    v_mfma_f32_16x16x32_bf16 v[108:111], a[44:47], v[140:143], v[108:111]
    buffer_load_dwordx4 a[4:7], v15, s[44:47], s96 offen offset:1024 sc1
    s_waitcnt lgkmcnt(0)
    v_mfma_f32_16x16x32_bf16 v[64:67], a[48:51], v[112:115], v[64:67]
    ds_read_b64_tr_b16 v[128:129], v148 offset:36864
    v_fma_f32 v35, -v202, v183, v35
    v_permlane32_swap_b32 v36, v38
    v_mfma_f32_16x16x32_bf16 v[68:71], a[52:55], v[112:115], v[68:71]
    ds_read_b64_tr_b16 v[130:131], v148 offset:38912
    v_permlane32_swap_b32 v37, v39
    v_mul_f32 v28, v28, v32
    v_mfma_f32_16x16x32_bf16 v[72:75], a[56:59], v[112:115], v[72:75]
    ds_read_b64_tr_b16 v[132:133], v149 offset:36864
    v_mul_f32 v29, v29, v33
    v_mul_f32 v30, v30, v34
    v_mfma_f32_16x16x32_bf16 v[164:167], v[112:115], v[112:115], v[164:167]
    ds_read_b64_tr_b16 v[134:135], v149 offset:38912
    v_mul_f32_e64 v31, v31, v35
    v_mfma_f32_16x16x32_bf16 v[168:171], v[172:175], v[112:115], v[168:171]
    ds_read_b64_tr_b16 v[136:137], v150 offset:36864
    v_mul_f32_e64 v32, v36, v38
    v_mfma_f32_16x16x32_bf16 v[76:79], a[48:51], v[116:119], v[76:79]
    ds_read_b64_tr_b16 v[138:139], v150 offset:38912
    v_mul_f32 v33, v37, v39
    v_mfma_f32_16x16x32_bf16 v[80:83], a[52:55], v[116:119], v[80:83]
    ds_read_b64_tr_b16 v[140:141], v151 offset:36864
    v_mul_f32 v28, v28, v203
    v_mfma_f32_16x16x32_bf16 v[84:87], a[56:59], v[116:119], v[84:87]
    ds_read_b64_tr_b16 v[142:143], v151 offset:38912
    v_mul_f32 v29, v29, v203
    v_mfma_f32_16x16x32_bf16 v[88:91], a[48:51], v[120:123], v[88:91]
    v_mul_f32 v30, v30, v203
    v_mul_f32 v31, v31, v203
    v_mfma_f32_16x16x32_bf16 v[92:95], a[52:55], v[120:123], v[92:95]
    v_mul_f32 v32, v32, v203
    v_mul_f32_e64 v33, v33, v203
    v_mfma_f32_16x16x32_bf16 v[96:99], a[56:59], v[120:123], v[96:99]
    v_cvt_pk_bf16_f32 v28, v28, v29
    v_cvt_pk_bf16_f32 v29, v30, v31
    v_mfma_f32_16x16x32_bf16 v[100:103], a[48:51], v[124:127], v[100:103]
    v_cvt_pk_bf16_f32 v30, v32, v33
    ds_write_b64 v193, v[28:29]
    v_mfma_f32_16x16x32_bf16 v[104:107], a[52:55], v[124:127], v[104:107]
    ds_write_b32 v197, v30
    buffer_load_dwordx4 a[8:11], v15, s[44:47], s96 offen offset:2048 sc1
    v_mfma_f32_16x16x32_bf16 v[108:111], a[56:59], v[124:127], v[108:111]
    buffer_load_dwordx4 a[12:15], v15, s[44:47], s96 offen offset:3072 sc1
    s_add_u32 s96, s96, 4096
    s_waitcnt lgkmcnt(0)
    v_mfma_f32_16x16x32_bf16 v[64:67], a[60:63], v[128:131], v[64:67]
    ds_read_b64_tr_b16 v[112:113], v148 offset:40960
    v_fma_f32 v48, -v204, v184, v48
    v_fma_f32 v49, -v204, v185, v49
    v_mfma_f32_16x16x32_bf16 v[68:71], a[64:67], v[128:131], v[68:71]
    ds_read_b64_tr_b16 v[114:115], v148 offset:43008
    v_fma_f32 v50, -v204, v186, v50
    v_fma_f32 v51, -v204, v187, v51
    v_mfma_f32_16x16x32_bf16 v[72:75], a[68:71], v[128:131], v[72:75]
    ds_read_b64_tr_b16 v[116:117], v149 offset:40960
    v_fma_f32 v40, -v204, v176, v40
    v_fma_f32 v41, -v204, v177, v41
    v_mfma_f32_16x16x32_bf16 v[164:167], v[128:131], v[128:131], v[164:167]
    ds_read_b64_tr_b16 v[118:119], v149 offset:43008
    v_fma_f32 v42, -v204, v178, v42
    v_fma_f32 v43, -v204, v179, v43
    v_mfma_f32_16x16x32_bf16 v[168:171], v[172:175], v[128:131], v[168:171]
    ds_read_b64_tr_b16 v[120:121], v150 offset:40960
    v_fma_f32 v44, -v204, v180, v44
    v_mfma_f32_16x16x32_bf16 v[76:79], a[60:63], v[132:135], v[76:79]
    ds_read_b64_tr_b16 v[122:123], v150 offset:43008
    v_fma_f32 v45, -v204, v181, v45
    v_mfma_f32_16x16x32_bf16 v[80:83], a[64:67], v[132:135], v[80:83]
    ds_read_b64_tr_b16 v[124:125], v151 offset:40960
    v_fma_f32 v46, -v204, v182, v46
    v_mfma_f32_16x16x32_bf16 v[84:87], a[68:71], v[132:135], v[84:87]
    ds_read_b64_tr_b16 v[126:127], v151 offset:43008
    v_fma_f32 v47, -v204, v183, v47
    v_mfma_f32_16x16x32_bf16 v[88:91], a[60:63], v[136:139], v[88:91]
    v_permlane32_swap_b32 v48, v50
    v_permlane32_swap_b32 v49, v51
    v_mfma_f32_16x16x32_bf16 v[92:95], a[64:67], v[136:139], v[92:95]
    v_mul_f32 v40, v40, v44
    v_mul_f32_e64 v41, v41, v45
    v_mfma_f32_16x16x32_bf16 v[96:99], a[68:71], v[136:139], v[96:99]
    v_mul_f32 v42, v42, v46
    v_mul_f32 v43, v43, v47
    v_mfma_f32_16x16x32_bf16 v[100:103], a[60:63], v[140:143], v[100:103]
    v_mul_f32 v44, v48, v50
    v_mul_f32 v45, v49, v51
    v_mfma_f32_16x16x32_bf16 v[104:107], a[64:67], v[140:143], v[104:107]
    v_mul_f32_e64 v40, v40, v205
    buffer_load_dwordx4 a[16:19], v15, s[44:47], s96 offen offset:0 sc1
    v_mfma_f32_16x16x32_bf16 v[108:111], a[68:71], v[140:143], v[108:111]
    buffer_load_dwordx4 a[20:23], v15, s[44:47], s96 offen offset:1024 sc1
    buffer_load_dwordx4 a[24:27], v15, s[44:47], s96 offen offset:2048 sc1
    s_waitcnt lgkmcnt(0)
    v_mfma_f32_16x16x32_bf16 v[64:67], a[72:75], v[112:115], v[64:67]
    ds_read_b64_tr_b16 v[128:129], v148 offset:45056
    v_mul_f32 v41, v41, v205
    v_mul_f32 v42, v42, v205
    v_mfma_f32_16x16x32_bf16 v[68:71], a[76:79], v[112:115], v[68:71]
    ds_read_b64_tr_b16 v[130:131], v148 offset:47104
    v_mul_f32 v43, v43, v205
    v_mul_f32 v44, v44, v205
    v_mfma_f32_16x16x32_bf16 v[72:75], a[80:83], v[112:115], v[72:75]
    ds_read_b64_tr_b16 v[132:133], v149 offset:45056
    v_mul_f32 v45, v45, v205
    v_cvt_pk_bf16_f32 v40, v40, v41
    v_mfma_f32_16x16x32_bf16 v[164:167], v[112:115], v[112:115], v[164:167]
    ds_read_b64_tr_b16 v[134:135], v149 offset:47104
    v_cvt_pk_bf16_f32 v41, v42, v43
    v_cvt_pk_bf16_f32 v42, v44, v45
    v_mfma_f32_16x16x32_bf16 v[168:171], v[172:175], v[112:115], v[168:171]
    ds_read_b64_tr_b16 v[136:137], v150 offset:45056
    ds_write_b64 v194, v[40:41]
    ds_write_b32 v198, v42
    v_mfma_f32_16x16x32_bf16 v[76:79], a[72:75], v[116:119], v[76:79]
    ds_read_b64_tr_b16 v[138:139], v150 offset:47104
    v_fma_f32 v60, -v206, v184, v60
    v_mfma_f32_16x16x32_bf16 v[80:83], a[76:79], v[116:119], v[80:83]
    ds_read_b64_tr_b16 v[140:141], v151 offset:45056
    v_fma_f32 v61, -v206, v185, v61
    v_mfma_f32_16x16x32_bf16 v[84:87], a[80:83], v[116:119], v[84:87]
    ds_read_b64_tr_b16 v[142:143], v151 offset:47104
    v_fma_f32 v62, -v206, v186, v62
    v_mfma_f32_16x16x32_bf16 v[88:91], a[72:75], v[120:123], v[88:91]
    v_fma_f32 v63, -v206, v187, v63
    v_fma_f32 v52, -v206, v176, v52
    v_mfma_f32_16x16x32_bf16 v[92:95], a[76:79], v[120:123], v[92:95]
    v_fma_f32 v53, -v206, v177, v53
    v_fma_f32 v54, -v206, v178, v54
    v_mfma_f32_16x16x32_bf16 v[96:99], a[80:83], v[120:123], v[96:99]
    v_fma_f32 v55, -v206, v179, v55
    v_fma_f32 v56, -v206, v180, v56
    v_mfma_f32_16x16x32_bf16 v[100:103], a[72:75], v[124:127], v[100:103]
    v_fma_f32 v57, -v206, v181, v57
    v_fma_f32 v58, -v206, v182, v58
    v_mfma_f32_16x16x32_bf16 v[104:107], a[76:79], v[124:127], v[104:107]
    buffer_load_dwordx4 a[28:31], v15, s[44:47], s96 offen offset:3072 sc1
    s_add_u32 s96, s96, 4096
    v_mfma_f32_16x16x32_bf16 v[108:111], a[80:83], v[124:127], v[108:111]
    buffer_load_dwordx4 a[32:35], v15, s[44:47], s96 offen offset:0 sc1
    buffer_load_dwordx4 a[36:39], v15, s[44:47], s96 offen offset:1024 sc1
    s_waitcnt lgkmcnt(0)
    v_mfma_f32_16x16x32_bf16 v[64:67], a[84:87], v[128:131], v[64:67]
    ds_read_b64_tr_b16 v[112:113], v148 offset:49152
    v_fma_f32 v59, -v206, v183, v59
    v_permlane32_swap_b32 v60, v62
    v_mfma_f32_16x16x32_bf16 v[68:71], a[88:91], v[128:131], v[68:71]
    ds_read_b64_tr_b16 v[114:115], v148 offset:51200
    v_permlane32_swap_b32 v61, v63
    v_mul_f32 v52, v52, v56
    v_mfma_f32_16x16x32_bf16 v[72:75], a[92:95], v[128:131], v[72:75]
    ds_read_b64_tr_b16 v[116:117], v149 offset:49152
    v_mul_f32 v53, v53, v57
    v_mul_f32 v54, v54, v58
    v_mfma_f32_16x16x32_bf16 v[164:167], v[128:131], v[128:131], v[164:167]
    ds_read_b64_tr_b16 v[118:119], v149 offset:51200
    v_mul_f32_e64 v55, v55, v59
    v_mfma_f32_16x16x32_bf16 v[168:171], v[172:175], v[128:131], v[168:171]
    ds_read_b64_tr_b16 v[120:121], v150 offset:49152
    v_mul_f32_e64 v56, v60, v62
    v_mfma_f32_16x16x32_bf16 v[76:79], a[84:87], v[132:135], v[76:79]
    ds_read_b64_tr_b16 v[122:123], v150 offset:51200
    v_mul_f32 v57, v61, v63
    v_mfma_f32_16x16x32_bf16 v[80:83], a[88:91], v[132:135], v[80:83]
    ds_read_b64_tr_b16 v[124:125], v151 offset:49152
    v_mul_f32 v52, v52, v207
    v_mfma_f32_16x16x32_bf16 v[84:87], a[92:95], v[132:135], v[84:87]
    ds_read_b64_tr_b16 v[126:127], v151 offset:51200
    v_mul_f32 v53, v53, v207
    v_mfma_f32_16x16x32_bf16 v[88:91], a[84:87], v[136:139], v[88:91]
    v_mul_f32 v54, v54, v207
    v_mul_f32 v55, v55, v207
    v_mfma_f32_16x16x32_bf16 v[92:95], a[88:91], v[136:139], v[92:95]
    v_mul_f32 v56, v56, v207
    v_mul_f32_e64 v57, v57, v207
    v_mfma_f32_16x16x32_bf16 v[96:99], a[92:95], v[136:139], v[96:99]
    v_cvt_pk_bf16_f32 v52, v52, v53
    v_cvt_pk_bf16_f32 v53, v54, v55
    v_mfma_f32_16x16x32_bf16 v[100:103], a[84:87], v[140:143], v[100:103]
    v_cvt_pk_bf16_f32 v54, v56, v57
    ds_write_b64 v195, v[52:53]
    v_mfma_f32_16x16x32_bf16 v[104:107], a[88:91], v[140:143], v[104:107]
    ds_write_b32 v199, v54
    buffer_load_dwordx4 a[40:43], v15, s[44:47], s96 offen offset:2048 sc1
    v_mfma_f32_16x16x32_bf16 v[108:111], a[92:95], v[140:143], v[108:111]
    buffer_load_dwordx4 a[44:47], v15, s[44:47], s96 offen offset:3072 sc1
    s_add_u32 s96, s96, 4096
    s_waitcnt lgkmcnt(0)
    s_waitcnt vmcnt(11)
    s_barrier
    s_waitcnt lgkmcnt(0)
    v_mfma_f32_16x16x32_bf16 v[64:67], a[96:99], v[112:115], v[64:67]
    ds_read_b64_tr_b16 v[128:129], v148 offset:53248
    ds_read_b128 v[208:211], v190 offset:0
    v_mfma_f32_16x16x32_bf16 v[68:71], a[100:103], v[112:115], v[68:71]
    ds_read_b64_tr_b16 v[130:131], v148 offset:55296
    ds_read_b128 v[212:215], v190 offset:1024
    v_mfma_f32_16x16x32_bf16 v[72:75], a[104:107], v[112:115], v[72:75]
    ds_read_b64_tr_b16 v[132:133], v149 offset:53248
    ds_read_b128 v[216:219], v190 offset:2048
    v_mfma_f32_16x16x32_bf16 v[164:167], v[112:115], v[112:115], v[164:167]
    ds_read_b64_tr_b16 v[134:135], v149 offset:55296
    buffer_load_dwordx4 a[48:51], v15, s[44:47], s96 offen offset:0 sc1
    v_mfma_f32_16x16x32_bf16 v[168:171], v[172:175], v[112:115], v[168:171]
    ds_read_b64_tr_b16 v[136:137], v150 offset:53248
    buffer_load_dwordx4 a[52:55], v15, s[44:47], s96 offen offset:1024 sc1
    v_mfma_f32_16x16x32_bf16 v[76:79], a[96:99], v[116:119], v[76:79]
    ds_read_b64_tr_b16 v[138:139], v150 offset:55296
    buffer_load_dwordx4 a[56:59], v15, s[44:47], s96 offen offset:2048 sc1
    v_mfma_f32_16x16x32_bf16 v[80:83], a[100:103], v[116:119], v[80:83]
    ds_read_b64_tr_b16 v[140:141], v151 offset:53248
    v_mfma_f32_16x16x32_bf16 v[84:87], a[104:107], v[116:119], v[84:87]
    ds_read_b64_tr_b16 v[142:143], v151 offset:55296
    v_mfma_f32_16x16x32_bf16 v[88:91], a[96:99], v[120:123], v[88:91]
    v_mfma_f32_16x16x32_bf16 v[92:95], a[100:103], v[120:123], v[92:95]
    v_mfma_f32_16x16x32_bf16 v[96:99], a[104:107], v[120:123], v[96:99]
    v_mfma_f32_16x16x32_bf16 v[100:103], a[96:99], v[124:127], v[100:103]
    v_mfma_f32_16x16x32_bf16 v[104:107], a[100:103], v[124:127], v[104:107]
    v_mfma_f32_16x16x32_bf16 v[108:111], a[104:107], v[124:127], v[108:111]
    s_waitcnt lgkmcnt(0)
    v_mfma_f32_16x16x32_bf16 v[64:67], a[108:111], v[128:131], v[64:67]
    ds_read_b64_tr_b16 v[112:113], v148 offset:57344
    buffer_store_dwordx4 v[208:211], v15, s[44:47], s95 offen offset:0 sc1
    v_mfma_f32_16x16x32_bf16 v[68:71], a[112:115], v[128:131], v[68:71]
    ds_read_b64_tr_b16 v[114:115], v148 offset:59392
    buffer_store_dwordx4 v[212:215], v15, s[44:47], s95 offen offset:1024 sc1
    v_mfma_f32_16x16x32_bf16 v[72:75], a[116:119], v[128:131], v[72:75]
    ds_read_b64_tr_b16 v[116:117], v149 offset:57344
    buffer_store_dwordx4 v[216:219], v15, s[44:47], s95 offen offset:2048 sc1
    v_mfma_f32_16x16x32_bf16 v[164:167], v[128:131], v[128:131], v[164:167]
    ds_read_b64_tr_b16 v[118:119], v149 offset:59392
    v_mfma_f32_16x16x32_bf16 v[168:171], v[172:175], v[128:131], v[168:171]
    ds_read_b64_tr_b16 v[120:121], v150 offset:57344
    v_mfma_f32_16x16x32_bf16 v[76:79], a[108:111], v[132:135], v[76:79]
    ds_read_b64_tr_b16 v[122:123], v150 offset:59392
    s_add_u32 s95, s95, 196608
    v_mfma_f32_16x16x32_bf16 v[80:83], a[112:115], v[132:135], v[80:83]
    ds_read_b64_tr_b16 v[124:125], v151 offset:57344
    buffer_load_dwordx4 a[60:63], v15, s[44:47], s96 offen offset:3072 sc1
    v_mfma_f32_16x16x32_bf16 v[84:87], a[116:119], v[132:135], v[84:87]
    ds_read_b64_tr_b16 v[126:127], v151 offset:59392
    s_add_u32 s96, s96, 4096
    v_mfma_f32_16x16x32_bf16 v[88:91], a[108:111], v[136:139], v[88:91]
    buffer_load_dwordx4 a[64:67], v15, s[44:47], s96 offen offset:0 sc1
    v_mfma_f32_16x16x32_bf16 v[92:95], a[112:115], v[136:139], v[92:95]
    buffer_load_dwordx4 a[68:71], v15, s[44:47], s96 offen offset:1024 sc1
    v_mfma_f32_16x16x32_bf16 v[96:99], a[116:119], v[136:139], v[96:99]
    v_mfma_f32_16x16x32_bf16 v[100:103], a[108:111], v[140:143], v[100:103]
    v_mfma_f32_16x16x32_bf16 v[104:107], a[112:115], v[140:143], v[104:107]
    v_mfma_f32_16x16x32_bf16 v[108:111], a[116:119], v[140:143], v[108:111]
    s_waitcnt lgkmcnt(0)
    v_mfma_f32_16x16x32_bf16 v[64:67], a[120:123], v[112:115], v[64:67]
    ds_read_b64_tr_b16 v[128:129], v148 offset:61440
    buffer_load_dwordx4 a[72:75], v15, s[44:47], s96 offen offset:2048 sc1
    v_mfma_f32_16x16x32_bf16 v[68:71], a[124:127], v[112:115], v[68:71]
    ds_read_b64_tr_b16 v[130:131], v148 offset:63488
    buffer_load_dwordx4 a[76:79], v15, s[44:47], s96 offen offset:3072 sc1
    v_mfma_f32_16x16x32_bf16 v[72:75], a[128:131], v[112:115], v[72:75]
    ds_read_b64_tr_b16 v[132:133], v149 offset:61440
    s_add_u32 s96, s96, 4096
    v_mfma_f32_16x16x32_bf16 v[164:167], v[112:115], v[112:115], v[164:167]
    ds_read_b64_tr_b16 v[134:135], v149 offset:63488
    v_mfma_f32_16x16x32_bf16 v[168:171], v[172:175], v[112:115], v[168:171]
    ds_read_b64_tr_b16 v[136:137], v150 offset:61440
    v_mfma_f32_16x16x32_bf16 v[76:79], a[120:123], v[116:119], v[76:79]
    ds_read_b64_tr_b16 v[138:139], v150 offset:63488
    v_mfma_f32_16x16x32_bf16 v[80:83], a[124:127], v[116:119], v[80:83]
    ds_read_b64_tr_b16 v[140:141], v151 offset:61440
    v_mfma_f32_16x16x32_bf16 v[84:87], a[128:131], v[116:119], v[84:87]
    ds_read_b64_tr_b16 v[142:143], v151 offset:63488
    v_mfma_f32_16x16x32_bf16 v[88:91], a[120:123], v[120:123], v[88:91]
    v_mfma_f32_16x16x32_bf16 v[92:95], a[124:127], v[120:123], v[92:95]
    v_mfma_f32_16x16x32_bf16 v[96:99], a[128:131], v[120:123], v[96:99]
    v_mfma_f32_16x16x32_bf16 v[100:103], a[120:123], v[124:127], v[100:103]
    v_mfma_f32_16x16x32_bf16 v[104:107], a[124:127], v[124:127], v[104:107]
    v_mfma_f32_16x16x32_bf16 v[108:111], a[128:131], v[124:127], v[108:111]
    s_waitcnt lgkmcnt(0)
    v_mfma_f32_16x16x32_bf16 v[64:67], a[132:135], v[128:131], v[64:67]
    ds_read_b64_tr_b16 v[112:113], v152 offset:0
    buffer_load_dwordx4 a[80:83], v15, s[44:47], s96 offen offset:0 sc1
    v_mfma_f32_16x16x32_bf16 v[68:71], a[136:139], v[128:131], v[68:71]
    ds_read_b64_tr_b16 v[114:115], v152 offset:2048
    buffer_load_dwordx4 a[84:87], v15, s[44:47], s96 offen offset:1024 sc1
    v_mfma_f32_16x16x32_bf16 v[72:75], a[140:143], v[128:131], v[72:75]
    ds_read_b64_tr_b16 v[116:117], v153 offset:0
    buffer_load_dwordx4 a[88:91], v15, s[44:47], s96 offen offset:2048 sc1
    v_mfma_f32_16x16x32_bf16 v[164:167], v[128:131], v[128:131], v[164:167]
    ds_read_b64_tr_b16 v[118:119], v153 offset:2048
    s_mov_b32 s56, s30
    v_mfma_f32_16x16x32_bf16 v[168:171], v[172:175], v[128:131], v[168:171]
    ds_read_b64_tr_b16 v[120:121], v154 offset:0
    s_mov_b32 s57, s31
    v_mfma_f32_16x16x32_bf16 v[76:79], a[132:135], v[132:135], v[76:79]
    ds_read_b64_tr_b16 v[122:123], v154 offset:2048
    s_mov_b32 s58, 0x280000
    v_mfma_f32_16x16x32_bf16 v[80:83], a[136:139], v[132:135], v[80:83]
    ds_read_b64_tr_b16 v[124:125], v155 offset:0
    s_mov_b32 s59, 0x20000
    v_mfma_f32_16x16x32_bf16 v[84:87], a[140:143], v[132:135], v[84:87]
    ds_read_b64_tr_b16 v[126:127], v155 offset:2048
    v_lshrrev_b32 v3, 2, v0
    v_mfma_f32_16x16x32_bf16 v[88:91], a[132:135], v[136:139], v[88:91]
    v_and_b32 v2, 3, v0
    v_mfma_f32_16x16x32_bf16 v[92:95], a[136:139], v[136:139], v[92:95]
    v_lshlrev_b32 v10, 7, v3
    v_mfma_f32_16x16x32_bf16 v[96:99], a[140:143], v[136:139], v[96:99]
    v_lshl_add_u32 v10, v2, 4, v10
    v_mfma_f32_16x16x32_bf16 v[100:103], a[132:135], v[140:143], v[100:103]
    v_mfma_f32_16x16x32_bf16 v[104:107], a[136:139], v[140:143], v[104:107]
    v_mfma_f32_16x16x32_bf16 v[108:111], a[140:143], v[140:143], v[108:111]
    s_waitcnt lgkmcnt(0)
    v_mfma_f32_16x16x32_bf16 v[64:67], a[144:147], v[112:115], v[64:67]
    ds_read_b64_tr_b16 v[128:129], v152 offset:4096
    buffer_load_dwordx4 a[92:95], v15, s[44:47], s96 offen offset:3072 sc1
    v_mfma_f32_16x16x32_bf16 v[68:71], a[148:151], v[112:115], v[68:71]
    ds_read_b64_tr_b16 v[130:131], v152 offset:6144
    s_add_u32 s96, s96, 4096
    v_mfma_f32_16x16x32_bf16 v[72:75], a[152:155], v[112:115], v[72:75]
    ds_read_b64_tr_b16 v[132:133], v153 offset:4096
    buffer_load_dwordx4 a[96:99], v15, s[44:47], s96 offen offset:0 sc1
    v_mfma_f32_16x16x32_bf16 v[164:167], v[112:115], v[112:115], v[164:167]
    ds_read_b64_tr_b16 v[134:135], v153 offset:6144
    buffer_load_dwordx4 a[100:103], v15, s[44:47], s96 offen offset:1024 sc1
    v_mfma_f32_16x16x32_bf16 v[168:171], v[172:175], v[112:115], v[168:171]
    ds_read_b64_tr_b16 v[136:137], v154 offset:4096
    s_mul_i32 s48, s80, 10240
    v_mfma_f32_16x16x32_bf16 v[76:79], a[144:147], v[116:119], v[76:79]
    ds_read_b64_tr_b16 v[138:139], v154 offset:6144
    s_mul_i32 s49, s78, 81920
    v_mfma_f32_16x16x32_bf16 v[80:83], a[148:151], v[116:119], v[80:83]
    ds_read_b64_tr_b16 v[140:141], v155 offset:4096
    s_add_u32 s48, s48, s49
    v_mfma_f32_16x16x32_bf16 v[84:87], a[152:155], v[116:119], v[84:87]
    ds_read_b64_tr_b16 v[142:143], v155 offset:6144
    s_lshl_b32 s49, s79, 6
    v_mfma_f32_16x16x32_bf16 v[88:91], a[144:147], v[120:123], v[88:91]
    s_add_u32 s48, s48, s49
    v_mfma_f32_16x16x32_bf16 v[92:95], a[148:151], v[120:123], v[92:95]
    s_add_u32 s49, s60, 0
    v_mfma_f32_16x16x32_bf16 v[96:99], a[152:155], v[120:123], v[96:99]
    s_min_u32 s49, s49, 9
    v_mfma_f32_16x16x32_bf16 v[100:103], a[144:147], v[124:127], v[100:103]
    v_mfma_f32_16x16x32_bf16 v[104:107], a[148:151], v[124:127], v[104:107]
    v_mfma_f32_16x16x32_bf16 v[108:111], a[152:155], v[124:127], v[108:111]
    s_waitcnt lgkmcnt(0)
    v_mfma_f32_16x16x32_bf16 v[64:67], a[156:159], v[128:131], v[64:67]
    ds_read_b64_tr_b16 v[112:113], v152 offset:8192
    buffer_load_dwordx4 a[104:107], v15, s[44:47], s96 offen offset:2048 sc1
    v_mfma_f32_16x16x32_bf16 v[68:71], a[160:163], v[128:131], v[68:71]
    ds_read_b64_tr_b16 v[114:115], v152 offset:10240
    buffer_load_dwordx4 a[108:111], v15, s[44:47], s96 offen offset:3072 sc1
    v_mfma_f32_16x16x32_bf16 v[72:75], a[164:167], v[128:131], v[72:75]
    ds_read_b64_tr_b16 v[116:117], v153 offset:8192
    s_add_u32 s96, s96, 4096
    v_mfma_f32_16x16x32_bf16 v[164:167], v[128:131], v[128:131], v[164:167]
    ds_read_b64_tr_b16 v[118:119], v153 offset:10240
    s_lshl_b32 s50, s49, 10
    v_mfma_f32_16x16x32_bf16 v[168:171], v[172:175], v[128:131], v[168:171]
    ds_read_b64_tr_b16 v[120:121], v154 offset:8192
    s_add_u32 m0, s50, 81920
    v_mfma_f32_16x16x32_bf16 v[76:79], a[156:159], v[132:135], v[76:79]
    ds_read_b64_tr_b16 v[122:123], v154 offset:10240
    s_cmp_ge_u32 s49, 5
    s_cselect_b32 s50, 1300480, 0
    v_mfma_f32_16x16x32_bf16 v[80:83], a[160:163], v[132:135], v[80:83]
    ds_read_b64_tr_b16 v[124:125], v155 offset:8192
    s_lshl_b32 s49, s49, 11
    v_mfma_f32_16x16x32_bf16 v[84:87], a[164:167], v[132:135], v[84:87]
    ds_read_b64_tr_b16 v[126:127], v155 offset:10240
    s_add_u32 s49, s49, s50
    v_mfma_f32_16x16x32_bf16 v[88:91], a[156:159], v[136:139], v[88:91]
    s_add_u32 s49, s49, s48
    v_mfma_f32_16x16x32_bf16 v[92:95], a[160:163], v[136:139], v[92:95]
    buffer_load_dwordx4 v10, s[40:43], s49 offen sc1 lds
    v_mfma_f32_16x16x32_bf16 v[96:99], a[164:167], v[136:139], v[96:99]
    v_mfma_f32_16x16x32_bf16 v[100:103], a[156:159], v[140:143], v[100:103]
    v_mfma_f32_16x16x32_bf16 v[104:107], a[160:163], v[140:143], v[104:107]
    v_mfma_f32_16x16x32_bf16 v[108:111], a[164:167], v[140:143], v[108:111]
    s_waitcnt vmcnt(14)
    s_barrier
    s_waitcnt lgkmcnt(0)
    v_mfma_f32_16x16x32_bf16 v[64:67], a[168:171], v[112:115], v[64:67]
    ds_read_b64_tr_b16 v[128:129], v152 offset:12288
    buffer_store_dword v13, v12, s[44:47], s73 offen sc1
    v_mfma_f32_16x16x32_bf16 v[68:71], a[172:175], v[112:115], v[68:71]
    ds_read_b64_tr_b16 v[130:131], v152 offset:14336
    v_mfma_f32_16x16x32_bf16 v[72:75], a[176:179], v[112:115], v[72:75]
    ds_read_b64_tr_b16 v[132:133], v153 offset:12288
    s_add_u32 s73, s73, 1024
    v_mfma_f32_16x16x32_bf16 v[164:167], v[112:115], v[112:115], v[164:167]
    ds_read_b64_tr_b16 v[134:135], v153 offset:14336
    buffer_load_dwordx4 a[112:115], v15, s[44:47], s96 offen offset:0 sc1
    v_mfma_f32_16x16x32_bf16 v[168:171], v[172:175], v[112:115], v[168:171]
    ds_read_b64_tr_b16 v[136:137], v154 offset:12288
    buffer_load_dwordx4 a[116:119], v15, s[44:47], s96 offen offset:1024 sc1
    v_mfma_f32_16x16x32_bf16 v[76:79], a[168:171], v[116:119], v[76:79]
    ds_read_b64_tr_b16 v[138:139], v154 offset:14336
    buffer_load_dwordx4 a[120:123], v15, s[44:47], s96 offen offset:2048 sc1
    v_mfma_f32_16x16x32_bf16 v[80:83], a[172:175], v[116:119], v[80:83]
    ds_read_b64_tr_b16 v[140:141], v155 offset:12288
    s_add_u32 s49, s60, 4
    v_mfma_f32_16x16x32_bf16 v[84:87], a[176:179], v[116:119], v[84:87]
    ds_read_b64_tr_b16 v[142:143], v155 offset:14336
    s_min_u32 s49, s49, 9
    v_mfma_f32_16x16x32_bf16 v[88:91], a[168:171], v[120:123], v[88:91]
    s_lshl_b32 s50, s49, 10
    v_mfma_f32_16x16x32_bf16 v[92:95], a[172:175], v[120:123], v[92:95]
    s_add_u32 m0, s50, 81920
    v_mfma_f32_16x16x32_bf16 v[96:99], a[176:179], v[120:123], v[96:99]
    s_cmp_ge_u32 s49, 5
    s_cselect_b32 s50, 1300480, 0
    v_mfma_f32_16x16x32_bf16 v[100:103], a[168:171], v[124:127], v[100:103]
    s_lshl_b32 s49, s49, 11
    v_mfma_f32_16x16x32_bf16 v[104:107], a[172:175], v[124:127], v[104:107]
    s_add_u32 s49, s49, s50
    v_mfma_f32_16x16x32_bf16 v[108:111], a[176:179], v[124:127], v[108:111]
    s_waitcnt lgkmcnt(0)
    v_mfma_f32_16x16x32_bf16 v[64:67], a[180:183], v[128:131], v[64:67]
    ds_read_b64_tr_b16 v[112:113], v144 offset:0
    buffer_load_dwordx4 a[124:127], v15, s[44:47], s96 offen offset:3072 sc1
    v_mfma_f32_16x16x32_bf16 v[68:71], a[184:187], v[128:131], v[68:71]
    ds_read_b64_tr_b16 v[114:115], v144 offset:2048
    s_add_u32 s96, s96, 4096
    v_mfma_f32_16x16x32_bf16 v[72:75], a[188:191], v[128:131], v[72:75]
    ds_read_b64_tr_b16 v[116:117], v145 offset:0
    buffer_load_dwordx4 a[128:131], v15, s[44:47], s96 offen offset:0 sc1
    v_mfma_f32_16x16x32_bf16 v[164:167], v[128:131], v[128:131], v[164:167]
    ds_read_b64_tr_b16 v[118:119], v145 offset:2048
    buffer_load_dwordx4 a[132:135], v15, s[44:47], s96 offen offset:1024 sc1
    v_mfma_f32_16x16x32_bf16 v[168:171], v[172:175], v[128:131], v[168:171]
    ds_read_b64_tr_b16 v[120:121], v146 offset:0
    s_add_u32 s49, s49, s48
    v_mfma_f32_16x16x32_bf16 v[76:79], a[180:183], v[132:135], v[76:79]
    ds_read_b64_tr_b16 v[122:123], v146 offset:2048
    buffer_load_dwordx4 v10, s[40:43], s49 offen sc1 lds
    v_mfma_f32_16x16x32_bf16 v[80:83], a[184:187], v[132:135], v[80:83]
    ds_read_b64_tr_b16 v[124:125], v147 offset:0
    s_add_u32 s49, s60, 8
    v_mfma_f32_16x16x32_bf16 v[84:87], a[188:191], v[132:135], v[84:87]
    ds_read_b64_tr_b16 v[126:127], v147 offset:2048
    s_min_u32 s49, s49, 9
    v_mfma_f32_16x16x32_bf16 v[88:91], a[180:183], v[136:139], v[88:91]
    s_lshl_b32 s50, s49, 10
    v_mfma_f32_16x16x32_bf16 v[92:95], a[184:187], v[136:139], v[92:95]
    s_add_u32 m0, s50, 81920
    v_mfma_f32_16x16x32_bf16 v[96:99], a[188:191], v[136:139], v[96:99]
    s_cmp_ge_u32 s49, 5
    s_cselect_b32 s50, 1300480, 0
    v_mfma_f32_16x16x32_bf16 v[100:103], a[180:183], v[140:143], v[100:103]
    v_mfma_f32_16x16x32_bf16 v[104:107], a[184:187], v[140:143], v[104:107]
    v_mfma_f32_16x16x32_bf16 v[108:111], a[188:191], v[140:143], v[108:111]
    s_waitcnt lgkmcnt(0)
    v_mfma_f32_16x16x32_bf16 v[64:67], a[192:195], v[112:115], v[64:67]
    ds_read_b64_tr_b16 v[128:129], v144 offset:4096
    buffer_load_dwordx4 a[136:139], v15, s[44:47], s96 offen offset:2048 sc1
    v_mfma_f32_16x16x32_bf16 v[68:71], a[196:199], v[112:115], v[68:71]
    ds_read_b64_tr_b16 v[130:131], v144 offset:6144
    buffer_load_dwordx4 a[140:143], v15, s[44:47], s96 offen offset:3072 sc1
    v_mfma_f32_16x16x32_bf16 v[72:75], a[200:203], v[112:115], v[72:75]
    ds_read_b64_tr_b16 v[132:133], v145 offset:4096
    s_add_u32 s96, s96, 4096
    v_mfma_f32_16x16x32_bf16 v[164:167], v[112:115], v[112:115], v[164:167]
    ds_read_b64_tr_b16 v[134:135], v145 offset:6144
    s_lshl_b32 s49, s49, 11
    v_mfma_f32_16x16x32_bf16 v[168:171], v[172:175], v[112:115], v[168:171]
    ds_read_b64_tr_b16 v[136:137], v146 offset:4096
    s_add_u32 s49, s49, s50
    v_mfma_f32_16x16x32_bf16 v[76:79], a[192:195], v[116:119], v[76:79]
    ds_read_b64_tr_b16 v[138:139], v146 offset:6144
    s_add_u32 s49, s49, s48
    v_mfma_f32_16x16x32_bf16 v[80:83], a[196:199], v[116:119], v[80:83]
    ds_read_b64_tr_b16 v[140:141], v147 offset:4096
    buffer_load_dwordx4 v10, s[40:43], s49 offen sc1 lds
    v_mfma_f32_16x16x32_bf16 v[84:87], a[200:203], v[116:119], v[84:87]
    ds_read_b64_tr_b16 v[142:143], v147 offset:6144
    v_mfma_f32_16x16x32_bf16 v[88:91], a[192:195], v[120:123], v[88:91]
    s_mul_i32 s48, s60, 5120
    v_mfma_f32_16x16x32_bf16 v[92:95], a[196:199], v[120:123], v[92:95]
    v_add_u32 v189, s48, v15
    v_mfma_f32_16x16x32_bf16 v[96:99], a[200:203], v[120:123], v[96:99]
    buffer_load_dword v1, v252, s[44:47], 0 offen sc1
    v_mfma_f32_16x16x32_bf16 v[100:103], a[192:195], v[124:127], v[100:103]
    v_mfma_f32_16x16x32_bf16 v[104:107], a[196:199], v[124:127], v[104:107]
    v_mfma_f32_16x16x32_bf16 v[108:111], a[200:203], v[124:127], v[108:111]
    s_waitcnt lgkmcnt(0)
    v_mfma_f32_16x16x32_bf16 v[64:67], a[204:207], v[128:131], v[64:67]
    ds_read_b64_tr_b16 v[112:113], v144 offset:8192
    buffer_load_dwordx4 a[144:147], v15, s[44:47], s96 offen offset:0 sc1
    v_mfma_f32_16x16x32_bf16 v[68:71], a[208:211], v[128:131], v[68:71]
    ds_read_b64_tr_b16 v[114:115], v144 offset:10240
    buffer_load_dwordx4 a[148:151], v15, s[44:47], s96 offen offset:1024 sc1
    v_mfma_f32_16x16x32_bf16 v[72:75], a[212:215], v[128:131], v[72:75]
    ds_read_b64_tr_b16 v[116:117], v145 offset:8192
    buffer_load_dwordx4 a[152:155], v15, s[44:47], s96 offen offset:2048 sc1
    v_mfma_f32_16x16x32_bf16 v[164:167], v[128:131], v[128:131], v[164:167]
    ds_read_b64_tr_b16 v[118:119], v145 offset:10240
    s_mul_i32 s48, s60, 1280
    v_mfma_f32_16x16x32_bf16 v[168:171], v[172:175], v[128:131], v[168:171]
    ds_read_b64_tr_b16 v[120:121], v146 offset:8192
    v_add_u32 v188, s48, v15
    v_mfma_f32_16x16x32_bf16 v[76:79], a[204:207], v[132:135], v[76:79]
    ds_read_b64_tr_b16 v[122:123], v146 offset:10240
    s_add_u32 s48, s48, 81920
    v_mfma_f32_16x16x32_bf16 v[80:83], a[208:211], v[132:135], v[80:83]
    ds_read_b64_tr_b16 v[124:125], v147 offset:8192
    v_lshlrev_b32_e64 v3, 6, v3
    v_mfma_f32_16x16x32_bf16 v[84:87], a[212:215], v[132:135], v[84:87]
    ds_read_b64_tr_b16 v[126:127], v147 offset:10240
    v_lshl_add_u32 v3, v2, 3, v3
    v_mfma_f32_16x16x32_bf16 v[88:91], a[204:207], v[136:139], v[88:91]
    v_add_u32_e64 v11, s48, v3
    v_mfma_f32_16x16x32_bf16 v[92:95], a[208:211], v[136:139], v[92:95]
    s_lshl_b32 s50, s78, 6
    v_mfma_f32_16x16x32_bf16 v[96:99], a[212:215], v[136:139], v[96:99]
    v_mfma_f32_16x16x32_bf16 v[100:103], a[204:207], v[140:143], v[100:103]
    v_mfma_f32_16x16x32_bf16 v[104:107], a[208:211], v[140:143], v[104:107]
    v_mfma_f32_16x16x32_bf16 v[108:111], a[212:215], v[140:143], v[108:111]
    s_waitcnt lgkmcnt(0)
    v_mfma_f32_16x16x32_bf16 v[64:67], a[216:219], v[112:115], v[64:67]
    ds_read_b64_tr_b16 v[128:129], v144 offset:12288
    buffer_load_dwordx4 a[156:159], v15, s[44:47], s96 offen offset:3072 sc1
    v_mfma_f32_16x16x32_bf16 v[68:71], a[220:223], v[112:115], v[68:71]
    ds_read_b64_tr_b16 v[130:131], v144 offset:14336
    s_add_u32 s96, s96, 4096
    v_mfma_f32_16x16x32_bf16 v[72:75], a[224:227], v[112:115], v[72:75]
    ds_read_b64_tr_b16 v[132:133], v145 offset:12288
    buffer_load_dwordx4 a[160:163], v15, s[44:47], s96 offen offset:0 sc1
    v_mfma_f32_16x16x32_bf16 v[164:167], v[112:115], v[112:115], v[164:167]
    ds_read_b64_tr_b16 v[134:135], v145 offset:14336
    buffer_load_dwordx4 a[164:167], v15, s[44:47], s96 offen offset:1024 sc1
    v_mfma_f32_16x16x32_bf16 v[168:171], v[172:175], v[112:115], v[168:171]
    ds_read_b64_tr_b16 v[136:137], v146 offset:12288
    s_lshl_b32 s51, s79, 5
    v_mfma_f32_16x16x32_bf16 v[76:79], a[216:219], v[116:119], v[76:79]
    ds_read_b64_tr_b16 v[138:139], v146 offset:14336
    s_add_u32 s50, s50, s51
    v_mfma_f32_16x16x32_bf16 v[80:83], a[220:223], v[116:119], v[80:83]
    ds_read_b64_tr_b16 v[140:141], v147 offset:12288
    s_mul_i32 s50, s50, 1280
    v_mfma_f32_16x16x32_bf16 v[84:87], a[224:227], v[116:119], v[84:87]
    ds_read_b64_tr_b16 v[142:143], v147 offset:14336
    s_mul_i32 s51, s80, 160
    v_mfma_f32_16x16x32_bf16 v[88:91], a[216:219], v[120:123], v[88:91]
    s_add_u32 s50, s50, s51
    v_mfma_f32_16x16x32_bf16 v[92:95], a[220:223], v[120:123], v[92:95]
    s_mul_i32 s49, s60, 40
    v_mfma_f32_16x16x32_bf16 v[96:99], a[224:227], v[120:123], v[96:99]
    s_add_u32 s50, s50, s49
    v_mfma_f32_16x16x32_bf16 v[100:103], a[216:219], v[124:127], v[100:103]
    v_mfma_f32_16x16x32_bf16 v[104:107], a[220:223], v[124:127], v[104:107]
    v_mfma_f32_16x16x32_bf16 v[108:111], a[224:227], v[124:127], v[108:111]
    s_waitcnt lgkmcnt(0)
    v_mfma_f32_16x16x32_bf16 v[164:167], v[128:131], v[128:131], v[164:167]
    buffer_load_dwordx4 a[168:171], v15, s[44:47], s96 offen offset:2048 sc1
    buffer_load_dwordx4 a[172:175], v15, s[44:47], s96 offen offset:3072 sc1
    v_mfma_f32_16x16x32_bf16 v[168:171], v[172:175], v[128:131], v[168:171]
    s_add_u32 s96, s96, 4096
    buffer_load_dwordx4 a[176:179], v15, s[44:47], s96 offen offset:0 sc1
    v_mfma_f32_16x16x32_bf16 v[64:67], a[228:231], v[128:131], v[64:67]
    v_and_b32 v3, 15, v0
    v_mul_u32_u24 v3, 1280, v3
    v_mfma_f32_16x16x32_bf16 v[68:71], a[232:235], v[128:131], v[68:71]
    v_lshrrev_b32 v4, 4, v0
    v_lshl_add_u32 v253, v4, 3, v3
    v_mfma_f32_16x16x32_bf16 v[72:75], a[236:239], v[128:131], v[72:75]
    v_cmp_gt_u32 vcc, 16, v0
    v_mov_b32 v4, 0x40000000
    v_mfma_f32_16x16x32_bf16 v[76:79], a[228:231], v[132:135], v[76:79]
    v_cndmask_b32_e64 v10, v4, v253, vcc
    v_mfma_f32_16x16x32_bf16 v[80:83], a[232:235], v[132:135], v[80:83]
    v_mfma_f32_16x16x32_bf16 v[84:87], a[236:239], v[132:135], v[84:87]
    v_cndmask_b32 v4, v164, v165, s[68:69]
    v_cndmask_b32 v5, v166, v167, s[68:69]
    v_mfma_f32_16x16x32_bf16 v[88:91], a[228:231], v[136:139], v[88:91]
    v_mov_b32_e64 v2, v168
    v_cndmask_b32 v3, v4, v5, s[70:71]
    v_mfma_f32_16x16x32_bf16 v[92:95], a[232:235], v[136:139], v[92:95]
    v_mul_f32 v2, 0x3acccccd, v2
    v_mul_f32 v3, 0x3acccccd, v3
    v_mfma_f32_16x16x32_bf16 v[96:99], a[236:239], v[136:139], v[96:99]
    v_fma_f32 v3, -v2, v2, v3
    v_max_f32 v3, 0, v3
    v_mfma_f32_16x16x32_bf16 v[100:103], a[228:231], v[140:143], v[100:103]
    v_cvt_pk_bf16_f32 v3, v3, v3
    v_and_b32 v3, s83, v3
    v_mfma_f32_16x16x32_bf16 v[104:107], a[232:235], v[140:143], v[104:107]
    v_add_f32 v3, 0x3727c5ac, v3
    v_cvt_pk_bf16_f32 v3, v3, v3
    v_mfma_f32_16x16x32_bf16 v[108:111], a[236:239], v[140:143], v[108:111]
    v_and_b32 v3, s83, v3
    v_sqrt_f32 v3, v3
    v_cvt_pk_bf16_f32 v2, v2, v2
    v_and_b32 v2, s83, v2
    v_cvt_pk_bf16_f32 v3, v3, v3
    v_and_b32 v3, s83, v3
    v_rcp_f32 v3, v3
    s_nop 0
    v_mul_f32 v3, v3, v3
    ds_write_b64 v191, v[2:3]
    s_waitcnt vmcnt(9)
    v_cmp_ne_u32 vcc, s63, v1
    s_mov_b32 s67, 0
    s_waitcnt lgkmcnt(0)
    s_barrier
    ds_read_b64 v[200:201], v6
    ds_read_b64 v[202:203], v7
    ds_read_b64 v[204:205], v8
    ds_read_b64 v[206:207], v9
    buffer_load_dwordx4 a[180:183], v15, s[44:47], s96 offen offset:1024 sc1
    buffer_load_dwordx4 a[184:187], v15, s[44:47], s96 offen offset:2048 sc1
    buffer_load_dwordx4 a[188:191], v15, s[44:47], s96 offen offset:3072 sc1
    s_add_u32 s96, s96, 4096
    s_cbranch_vccnz L_hlater
    s_add_u32 s64, s74, 0
    buffer_load_dwordx4 v[16:19], v15, s[44:47], s64 offen offset:0 sc1
    buffer_load_dwordx4 v[20:23], v15, s[44:47], s64 offen offset:1024 sc1
    buffer_load_dwordx4 v[24:27], v15, s[44:47], s64 offen offset:2048 sc1
    s_add_u32 s64, s64, 12288
    buffer_load_dwordx4 v[28:31], v15, s[44:47], s64 offen offset:0 sc1
    buffer_load_dwordx4 v[32:35], v15, s[44:47], s64 offen offset:1024 sc1
    buffer_load_dwordx4 v[36:39], v15, s[44:47], s64 offen offset:2048 sc1
    s_add_u32 s64, s64, 12288
    s_mov_b32 s67, 1
L_hlater:
    s_waitcnt lgkmcnt(0)
    v_pk_fma_f32 v[72:73], v[184:185], v[200:201], v[72:73] op_sel:[0,0,0] op_sel_hi:[1,0,1] neg_lo:[0,1,0] neg_hi:[0,1,0]
    v_pk_fma_f32 v[84:85], v[184:185], v[202:203], v[84:85] op_sel:[0,0,0] op_sel_hi:[1,0,1] neg_lo:[0,1,0] neg_hi:[0,1,0]
    v_pk_fma_f32 v[96:97], v[184:185], v[204:205], v[96:97] op_sel:[0,0,0] op_sel_hi:[1,0,1] neg_lo:[0,1,0] neg_hi:[0,1,0]
    v_pk_fma_f32 v[108:109], v[184:185], v[206:207], v[108:109] op_sel:[0,0,0] op_sel_hi:[1,0,1] neg_lo:[0,1,0] neg_hi:[0,1,0]
    v_pk_fma_f32 v[74:75], v[186:187], v[200:201], v[74:75] op_sel:[0,0,0] op_sel_hi:[1,0,1] neg_lo:[0,1,0] neg_hi:[0,1,0]
    v_pk_fma_f32 v[86:87], v[186:187], v[202:203], v[86:87] op_sel:[0,0,0] op_sel_hi:[1,0,1] neg_lo:[0,1,0] neg_hi:[0,1,0]
    v_pk_fma_f32 v[98:99], v[186:187], v[204:205], v[98:99] op_sel:[0,0,0] op_sel_hi:[1,0,1] neg_lo:[0,1,0] neg_hi:[0,1,0]
    v_pk_fma_f32 v[110:111], v[186:187], v[206:207], v[110:111] op_sel:[0,0,0] op_sel_hi:[1,0,1] neg_lo:[0,1,0] neg_hi:[0,1,0]
    v_pk_fma_f32 v[64:65], v[176:177], v[200:201], v[64:65] op_sel:[0,0,0] op_sel_hi:[1,0,1] neg_lo:[0,1,0] neg_hi:[0,1,0]
    v_pk_fma_f32 v[76:77], v[176:177], v[202:203], v[76:77] op_sel:[0,0,0] op_sel_hi:[1,0,1] neg_lo:[0,1,0] neg_hi:[0,1,0]
    v_pk_fma_f32 v[88:89], v[176:177], v[204:205], v[88:89] op_sel:[0,0,0] op_sel_hi:[1,0,1] neg_lo:[0,1,0] neg_hi:[0,1,0]
    v_pk_fma_f32 v[100:101], v[176:177], v[206:207], v[100:101] op_sel:[0,0,0] op_sel_hi:[1,0,1] neg_lo:[0,1,0] neg_hi:[0,1,0]
    v_pk_fma_f32 v[66:67], v[178:179], v[200:201], v[66:67] op_sel:[0,0,0] op_sel_hi:[1,0,1] neg_lo:[0,1,0] neg_hi:[0,1,0]
    v_pk_fma_f32 v[78:79], v[178:179], v[202:203], v[78:79] op_sel:[0,0,0] op_sel_hi:[1,0,1] neg_lo:[0,1,0] neg_hi:[0,1,0]
    v_pk_fma_f32 v[90:91], v[178:179], v[204:205], v[90:91] op_sel:[0,0,0] op_sel_hi:[1,0,1] neg_lo:[0,1,0] neg_hi:[0,1,0]
    v_pk_fma_f32 v[102:103], v[178:179], v[206:207], v[102:103] op_sel:[0,0,0] op_sel_hi:[1,0,1] neg_lo:[0,1,0] neg_hi:[0,1,0]
    v_pk_fma_f32 v[68:69], v[180:181], v[200:201], v[68:69] op_sel:[0,0,0] op_sel_hi:[1,0,1] neg_lo:[0,1,0] neg_hi:[0,1,0]
    v_pk_fma_f32 v[80:81], v[180:181], v[202:203], v[80:81] op_sel:[0,0,0] op_sel_hi:[1,0,1] neg_lo:[0,1,0] neg_hi:[0,1,0]
    v_pk_fma_f32 v[92:93], v[180:181], v[204:205], v[92:93] op_sel:[0,0,0] op_sel_hi:[1,0,1] neg_lo:[0,1,0] neg_hi:[0,1,0]
    v_pk_fma_f32 v[104:105], v[180:181], v[206:207], v[104:105] op_sel:[0,0,0] op_sel_hi:[1,0,1] neg_lo:[0,1,0] neg_hi:[0,1,0]
    v_pk_fma_f32 v[70:71], v[182:183], v[200:201], v[70:71] op_sel:[0,0,0] op_sel_hi:[1,0,1] neg_lo:[0,1,0] neg_hi:[0,1,0]
    v_pk_fma_f32 v[82:83], v[182:183], v[202:203], v[82:83] op_sel:[0,0,0] op_sel_hi:[1,0,1] neg_lo:[0,1,0] neg_hi:[0,1,0]
    v_pk_fma_f32 v[94:95], v[182:183], v[204:205], v[94:95] op_sel:[0,0,0] op_sel_hi:[1,0,1] neg_lo:[0,1,0] neg_hi:[0,1,0]
    v_pk_fma_f32 v[106:107], v[182:183], v[206:207], v[106:107] op_sel:[0,0,0] op_sel_hi:[1,0,1] neg_lo:[0,1,0] neg_hi:[0,1,0]
    v_permlane32_swap_b32 v72, v74
    v_permlane32_swap_b32 v84, v86
    v_permlane32_swap_b32 v96, v98
    v_permlane32_swap_b32 v108, v110
    v_permlane32_swap_b32 v73, v75
    v_permlane32_swap_b32 v85, v87
    v_permlane32_swap_b32 v97, v99
    v_permlane32_swap_b32 v109, v111
    v_pk_mul_f32 v[64:65], v[64:65], v[68:69]
    v_pk_mul_f32 v[76:77], v[76:77], v[80:81]
    v_pk_mul_f32 v[88:89], v[88:89], v[92:93]
    v_pk_mul_f32 v[100:101], v[100:101], v[104:105]
    v_pk_mul_f32 v[66:67], v[66:67], v[70:71]
    v_pk_mul_f32 v[78:79], v[78:79], v[82:83]
    v_pk_mul_f32 v[90:91], v[90:91], v[94:95]
    v_pk_mul_f32 v[102:103], v[102:103], v[106:107]
    v_pk_mul_f32 v[68:69], v[72:73], v[74:75]
    v_pk_mul_f32 v[80:81], v[84:85], v[86:87]
    v_pk_mul_f32 v[92:93], v[96:97], v[98:99]
    v_pk_mul_f32 v[104:105], v[108:109], v[110:111]
    v_pk_mul_f32 v[64:65], v[64:65], v[200:201] op_sel:[0,1] op_sel_hi:[1,1]
    v_pk_mul_f32 v[76:77], v[76:77], v[202:203] op_sel:[0,1] op_sel_hi:[1,1]
    v_pk_mul_f32 v[88:89], v[88:89], v[204:205] op_sel:[0,1] op_sel_hi:[1,1]
    v_pk_mul_f32 v[100:101], v[100:101], v[206:207] op_sel:[0,1] op_sel_hi:[1,1]
    v_pk_mul_f32 v[66:67], v[66:67], v[200:201] op_sel:[0,1] op_sel_hi:[1,1]
    v_pk_mul_f32 v[78:79], v[78:79], v[202:203] op_sel:[0,1] op_sel_hi:[1,1]
    v_pk_mul_f32 v[90:91], v[90:91], v[204:205] op_sel:[0,1] op_sel_hi:[1,1]
    v_pk_mul_f32 v[102:103], v[102:103], v[206:207] op_sel:[0,1] op_sel_hi:[1,1]
    v_pk_mul_f32 v[68:69], v[68:69], v[200:201] op_sel:[0,1] op_sel_hi:[1,1]
    v_pk_mul_f32 v[80:81], v[80:81], v[202:203] op_sel:[0,1] op_sel_hi:[1,1]
    v_pk_mul_f32 v[92:93], v[92:93], v[204:205] op_sel:[0,1] op_sel_hi:[1,1]
    v_pk_mul_f32 v[104:105], v[104:105], v[206:207] op_sel:[0,1] op_sel_hi:[1,1]
    v_cvt_pk_bf16_f32 v64, v64, v65
    v_cvt_pk_bf16_f32 v76, v76, v77
    v_cvt_pk_bf16_f32 v88, v88, v89
    v_cvt_pk_bf16_f32 v100, v100, v101
    v_cvt_pk_bf16_f32 v65, v66, v67
    v_cvt_pk_bf16_f32 v77, v78, v79
    v_cvt_pk_bf16_f32 v89, v90, v91
    v_cvt_pk_bf16_f32 v101, v102, v103
    v_cvt_pk_bf16_f32 v66, v68, v69
    v_cvt_pk_bf16_f32 v78, v80, v81
    v_cvt_pk_bf16_f32 v90, v92, v93
    v_cvt_pk_bf16_f32 v102, v104, v105
    ds_write_b64 v192, v[64:65]
    ds_write_b64 v193, v[76:77]
    ds_write_b64 v194, v[88:89]
    ds_write_b64 v195, v[100:101]
    ds_write_b32 v196, v66
    ds_write_b32 v197, v78
    ds_write_b32 v198, v90
    ds_write_b32 v199, v102
    s_waitcnt lgkmcnt(0)
    s_barrier
    ds_read_b128 v[208:211], v190 offset:0
    ds_read_b128 v[212:215], v190 offset:1024
    ds_read_b128 v[216:219], v190 offset:2048
    s_waitcnt lgkmcnt(2)
    buffer_store_dwordx4 v[208:211], v15, s[44:47], s95 offen offset:0 sc1
    s_waitcnt lgkmcnt(1)
    buffer_store_dwordx4 v[212:215], v15, s[44:47], s95 offen offset:1024 sc1
    s_waitcnt lgkmcnt(0)
    buffer_store_dwordx4 v[216:219], v15, s[44:47], s95 offen offset:2048 sc1
    s_cmp_eq_u32 s67, 1
    s_cbranch_scc1 L_hgot
    buffer_load_dword v1, v252, s[44:47], 0 offen sc1
    s_waitcnt vmcnt(0)
    v_cmp_ne_u32 vcc, s63, v1
    s_cbranch_vccz L_pdone_24
    s_mov_b32 s82, 0
L_poll_23:
    buffer_load_dword v1, v252, s[44:47], 0 offen sc1
    s_waitcnt vmcnt(0)
    v_cmp_ne_u32 vcc, s63, v1
    s_cbranch_vccz L_pdone_24
    s_add_u32 s82, s82, 1
    s_cmp_lt_u32 s82, 400000
    s_cbranch_scc1 L_poll_23
L_pdone_24:
    s_add_u32 s64, s74, 0
    s_nop 0
    buffer_load_dwordx4 v[16:19], v15, s[44:47], s64 offen offset:0 sc1
    buffer_load_dwordx4 v[20:23], v15, s[44:47], s64 offen offset:1024 sc1
    buffer_load_dwordx4 v[24:27], v15, s[44:47], s64 offen offset:2048 sc1
    s_add_u32 s64, s64, 12288
    buffer_load_dwordx4 v[28:31], v15, s[44:47], s64 offen offset:0 sc1
    buffer_load_dwordx4 v[32:35], v15, s[44:47], s64 offen offset:1024 sc1
    buffer_load_dwordx4 v[36:39], v15, s[44:47], s64 offen offset:2048 sc1
    s_add_u32 s64, s64, 12288
L_hgot:
    buffer_load_dwordx4 v[40:43], v15, s[44:47], s64 offen offset:0 sc1
    buffer_load_dwordx4 v[44:47], v15, s[44:47], s64 offen offset:1024 sc1
    buffer_load_dwordx4 v[48:51], v15, s[44:47], s64 offen offset:2048 sc1
    s_add_u32 s64, s64, 12288
    buffer_load_dwordx4 v[52:55], v15, s[44:47], s64 offen offset:0 sc1
    buffer_load_dwordx4 v[56:59], v15, s[44:47], s64 offen offset:1024 sc1
    buffer_load_dwordx4 v[60:63], v15, s[44:47], s64 offen offset:2048 sc1
    v_add_u32 v252, 1024, v252
    s_waitcnt vmcnt(11)
    v_mfma_f32_16x16x32_bf16 v[144:147], v[220:223], v[16:19], 0
    s_add_u32 s64, s74, 3072
    v_mfma_f32_16x16x32_bf16 v[148:151], v[224:227], v[16:19], 0
    buffer_load_dwordx4 a[192:195], v15, s[44:47], s64 offen offset:0 sc1
    v_mfma_f32_16x16x32_bf16 v[152:155], v[228:231], v[16:19], 0
    v_mfma_f32_16x16x32_bf16 v[156:159], v[232:235], v[16:19], 0
    buffer_load_dwordx4 a[196:199], v15, s[44:47], s64 offen offset:1024 sc1
    v_mfma_f32_16x16x32_bf16 v[160:163], v[236:239], v[16:19], 0
    s_waitcnt vmcnt(12)
    v_mfma_f32_16x16x32_bf16 v[144:147], v[240:243], v[20:23], v[144:147]
    v_mfma_f32_16x16x32_bf16 v[148:151], v[244:247], v[20:23], v[148:151]
    buffer_load_dwordx4 a[200:203], v15, s[44:47], s64 offen offset:2048 sc1
    v_mfma_f32_16x16x32_bf16 v[152:155], v[248:251], v[20:23], v[152:155]
    v_mfma_f32_16x16x32_bf16 v[156:159], a[240:243], v[20:23], v[156:159]
    v_mfma_f32_16x16x32_bf16 v[160:163], a[244:247], v[20:23], v[160:163]
    s_waitcnt vmcnt(12)
    v_mfma_f32_16x16x32_bf16 v[144:147], a[248:251], v[24:27], v[144:147]
    s_add_u32 s64, s64, 12288
    v_mfma_f32_16x16x32_bf16 v[148:151], a[252:255], v[24:27], v[148:151]
    buffer_load_dwordx4 a[204:207], v15, s[44:47], s64 offen offset:0 sc1
    v_mfma_f32_16x16x32_bf16 v[152:155], a[0:3], v[24:27], v[152:155]
    v_mfma_f32_16x16x32_bf16 v[156:159], a[4:7], v[24:27], v[156:159]
    v_mfma_f32_16x16x32_bf16 v[160:163], a[8:11], v[24:27], v[160:163]
    s_waitcnt vmcnt(12)
    v_mfma_f32_16x16x32_bf16 v[144:147], a[12:15], v[28:31], v[144:147]
    buffer_load_dwordx4 a[208:211], v15, s[44:47], s64 offen offset:1024 sc1
    v_mfma_f32_16x16x32_bf16 v[148:151], a[16:19], v[28:31], v[148:151]
    v_mfma_f32_16x16x32_bf16 v[152:155], a[20:23], v[28:31], v[152:155]
    buffer_load_dwordx4 a[212:215], v15, s[44:47], s64 offen offset:2048 sc1
    v_mfma_f32_16x16x32_bf16 v[156:159], a[24:27], v[28:31], v[156:159]
    v_mfma_f32_16x16x32_bf16 v[160:163], a[28:31], v[28:31], v[160:163]
    s_waitcnt vmcnt(13)
    v_mfma_f32_16x16x32_bf16 v[144:147], a[32:35], v[32:35], v[144:147]
    v_mfma_f32_16x16x32_bf16 v[148:151], a[36:39], v[32:35], v[148:151]
    s_add_u32 s64, s64, 12288
    v_mfma_f32_16x16x32_bf16 v[152:155], a[40:43], v[32:35], v[152:155]
    buffer_load_dwordx4 a[216:219], v15, s[44:47], s64 offen offset:0 sc1
    v_mfma_f32_16x16x32_bf16 v[156:159], a[44:47], v[32:35], v[156:159]
    v_mfma_f32_16x16x32_bf16 v[160:163], a[48:51], v[32:35], v[160:163]
    s_waitcnt vmcnt(13)
    v_mfma_f32_16x16x32_bf16 v[144:147], a[52:55], v[36:39], v[144:147]
    v_mfma_f32_16x16x32_bf16 v[148:151], a[56:59], v[36:39], v[148:151]
    buffer_load_dwordx4 a[220:223], v15, s[44:47], s64 offen offset:1024 sc1
    v_mfma_f32_16x16x32_bf16 v[152:155], a[60:63], v[36:39], v[152:155]
    v_mfma_f32_16x16x32_bf16 v[156:159], a[64:67], v[36:39], v[156:159]
    v_mfma_f32_16x16x32_bf16 v[160:163], a[68:71], v[36:39], v[160:163]
    s_waitcnt vmcnt(14)
    s_barrier
    s_waitcnt vmcnt(13)
    v_mfma_f32_16x16x32_bf16 v[144:147], a[72:75], v[40:43], v[144:147]
    buffer_store_dword v13, v12, s[44:47], s73 offen sc1
    v_mfma_f32_16x16x32_bf16 v[148:151], a[76:79], v[40:43], v[148:151]
    buffer_load_dwordx4 a[224:227], v15, s[44:47], s64 offen offset:2048 sc1
    v_mfma_f32_16x16x32_bf16 v[152:155], a[80:83], v[40:43], v[152:155]
    v_mfma_f32_16x16x32_bf16 v[156:159], a[84:87], v[40:43], v[156:159]
    s_add_u32 s64, s64, 12288
    v_mfma_f32_16x16x32_bf16 v[160:163], a[88:91], v[40:43], v[160:163]
    s_waitcnt vmcnt(14)
    v_mfma_f32_16x16x32_bf16 v[144:147], a[92:95], v[44:47], v[144:147]
    buffer_load_dwordx4 a[228:231], v15, s[44:47], s64 offen offset:0 sc1
    v_mfma_f32_16x16x32_bf16 v[148:151], a[96:99], v[44:47], v[148:151]
    v_mfma_f32_16x16x32_bf16 v[152:155], a[100:103], v[44:47], v[152:155]
    buffer_load_dwordx4 a[232:235], v15, s[44:47], s64 offen offset:1024 sc1
    v_mfma_f32_16x16x32_bf16 v[156:159], a[104:107], v[44:47], v[156:159]
    v_mfma_f32_16x16x32_bf16 v[160:163], a[108:111], v[44:47], v[160:163]
    s_waitcnt vmcnt(15)
    v_mfma_f32_16x16x32_bf16 v[144:147], a[112:115], v[48:51], v[144:147]
    v_mfma_f32_16x16x32_bf16 v[148:151], a[116:119], v[48:51], v[148:151]
    buffer_load_dwordx4 a[236:239], v15, s[44:47], s64 offen offset:2048 sc1
    v_mfma_f32_16x16x32_bf16 v[152:155], a[120:123], v[48:51], v[152:155]
    v_mfma_f32_16x16x32_bf16 v[156:159], a[124:127], v[48:51], v[156:159]
    v_mfma_f32_16x16x32_bf16 v[160:163], a[128:131], v[48:51], v[160:163]
    s_waitcnt vmcnt(15)
    v_mfma_f32_16x16x32_bf16 v[144:147], a[132:135], v[52:55], v[144:147]
    v_mfma_f32_16x16x32_bf16 v[148:151], a[136:139], v[52:55], v[148:151]
    v_mfma_f32_16x16x32_bf16 v[152:155], a[140:143], v[52:55], v[152:155]
    v_mfma_f32_16x16x32_bf16 v[156:159], a[144:147], v[52:55], v[156:159]
    v_mfma_f32_16x16x32_bf16 v[160:163], a[148:151], v[52:55], v[160:163]
    s_waitcnt vmcnt(14)
    v_mfma_f32_16x16x32_bf16 v[144:147], a[152:155], v[56:59], v[144:147]
    v_mfma_f32_16x16x32_bf16 v[148:151], a[156:159], v[56:59], v[148:151]
    v_mfma_f32_16x16x32_bf16 v[152:155], a[160:163], v[56:59], v[152:155]
    v_mfma_f32_16x16x32_bf16 v[156:159], a[164:167], v[56:59], v[156:159]
    v_mfma_f32_16x16x32_bf16 v[160:163], a[168:171], v[56:59], v[160:163]
    s_waitcnt vmcnt(13)
    v_mfma_f32_16x16x32_bf16 v[144:147], a[172:175], v[60:63], v[144:147]
    v_mfma_f32_16x16x32_bf16 v[148:151], a[176:179], v[60:63], v[148:151]
    v_mfma_f32_16x16x32_bf16 v[152:155], a[180:183], v[60:63], v[152:155]
    v_mfma_f32_16x16x32_bf16 v[156:159], a[184:187], v[60:63], v[156:159]
    v_mfma_f32_16x16x32_bf16 v[160:163], a[188:191], v[60:63], v[160:163]
    s_waitcnt vmcnt(12)
    v_mfma_f32_16x16x32_bf16 v[112:115], v[220:223], a[192:195], 0
    v_mfma_f32_16x16x32_bf16 v[116:119], v[224:227], a[192:195], 0
    v_mfma_f32_16x16x32_bf16 v[120:123], v[228:231], a[192:195], 0
    v_mfma_f32_16x16x32_bf16 v[124:127], v[232:235], a[192:195], 0
    v_mfma_f32_16x16x32_bf16 v[128:131], v[236:239], a[192:195], 0
    s_waitcnt vmcnt(11)
    v_mfma_f32_16x16x32_bf16 v[112:115], v[240:243], a[196:199], v[112:115]
    ds_write_b128 v189, v[144:147] offset:0
    v_mfma_f32_16x16x32_bf16 v[116:119], v[244:247], a[196:199], v[116:119]
    ds_write_b128 v189, v[148:151] offset:1024
    v_mfma_f32_16x16x32_bf16 v[120:123], v[248:251], a[196:199], v[120:123]
    v_mfma_f32_16x16x32_bf16 v[124:127], a[240:243], a[196:199], v[124:127]
    v_mfma_f32_16x16x32_bf16 v[128:131], a[244:247], a[196:199], v[128:131]
    s_waitcnt vmcnt(10)
    v_mfma_f32_16x16x32_bf16 v[112:115], a[248:251], a[200:203], v[112:115]
    ds_write_b128 v189, v[152:155] offset:2048
    v_mfma_f32_16x16x32_bf16 v[116:119], a[252:255], a[200:203], v[116:119]
    ds_write_b128 v189, v[156:159] offset:3072
    v_mfma_f32_16x16x32_bf16 v[120:123], a[0:3], a[200:203], v[120:123]
    v_mfma_f32_16x16x32_bf16 v[124:127], a[4:7], a[200:203], v[124:127]
    v_mfma_f32_16x16x32_bf16 v[128:131], a[8:11], a[200:203], v[128:131]
    s_waitcnt vmcnt(9)
    v_mfma_f32_16x16x32_bf16 v[112:115], a[12:15], a[204:207], v[112:115]
    ds_write_b128 v189, v[160:163] offset:4096
    v_mfma_f32_16x16x32_bf16 v[116:119], a[16:19], a[204:207], v[116:119]
    v_mfma_f32_16x16x32_bf16 v[120:123], a[20:23], a[204:207], v[120:123]
    v_mfma_f32_16x16x32_bf16 v[124:127], a[24:27], a[204:207], v[124:127]
    v_mfma_f32_16x16x32_bf16 v[128:131], a[28:31], a[204:207], v[128:131]
    s_waitcnt lgkmcnt(0)
    s_barrier
    s_waitcnt vmcnt(8)
    v_mfma_f32_16x16x32_bf16 v[112:115], a[32:35], a[208:211], v[112:115]
    ds_read_b64_tr_b16 v[212:213], v11 offset:0
    ds_read_b128 v[164:167], v188 offset:0
    v_mfma_f32_16x16x32_bf16 v[116:119], a[36:39], a[208:211], v[116:119]
    ds_read_b128 v[168:171], v188 offset:5120
    v_mfma_f32_16x16x32_bf16 v[120:123], a[40:43], a[208:211], v[120:123]
    ds_read_b128 v[172:175], v188 offset:10240
    v_mfma_f32_16x16x32_bf16 v[124:127], a[44:47], a[208:211], v[124:127]
    ds_read_b128 v[176:179], v188 offset:15360
    v_mfma_f32_16x16x32_bf16 v[128:131], a[48:51], a[208:211], v[128:131]
    s_waitcnt vmcnt(7)
    v_mfma_f32_16x16x32_bf16 v[112:115], a[52:55], a[212:215], v[112:115]
    ds_read_b64_tr_b16 v[214:215], v11 offset:1024
    ds_read_b128 v[192:195], v188 offset:1024
    v_mfma_f32_16x16x32_bf16 v[116:119], a[56:59], a[212:215], v[116:119]
    ds_read_b128 v[196:199], v188 offset:6144
    v_mfma_f32_16x16x32_bf16 v[120:123], a[60:63], a[212:215], v[120:123]
    ds_read_b128 v[200:203], v188 offset:11264
    v_mfma_f32_16x16x32_bf16 v[124:127], a[64:67], a[212:215], v[124:127]
    ds_read_b128 v[204:207], v188 offset:16384
    v_mfma_f32_16x16x32_bf16 v[128:131], a[68:71], a[212:215], v[128:131]
    s_waitcnt vmcnt(6)
    v_mfma_f32_16x16x32_bf16 v[112:115], a[72:75], a[216:219], v[112:115]
    s_add_u32 s51, s50, 0
    s_waitcnt lgkmcnt(5)
    v_mfma_f32_16x16x32_bf16 v[116:119], a[76:79], a[216:219], v[116:119]
    v_lshlrev_b32 v132, 16, v212
    v_and_b32 v133, s83, v212
    v_mfma_f32_16x16x32_bf16 v[120:123], a[80:83], a[216:219], v[120:123]
    v_lshlrev_b32 v134, 16, v213
    v_and_b32_e64 v135, s83, v213
    v_mfma_f32_16x16x32_bf16 v[124:127], a[84:87], a[216:219], v[124:127]
    v_add_f32 v164, v164, v168
    v_add_f32 v172, v172, v176
    v_mfma_f32_16x16x32_bf16 v[128:131], a[88:91], a[216:219], v[128:131]
    v_add_f32 v165, v165, v169
    s_waitcnt vmcnt(5)
    v_mfma_f32_16x16x32_bf16 v[112:115], a[92:95], a[220:223], v[112:115]
    v_add_f32 v173, v173, v177
    v_add_f32 v166, v166, v170
    v_mfma_f32_16x16x32_bf16 v[116:119], a[96:99], a[220:223], v[116:119]
    v_add_f32 v174, v174, v178
    v_add_f32 v167, v167, v171
    v_mfma_f32_16x16x32_bf16 v[120:123], a[100:103], a[220:223], v[120:123]
    v_add_f32 v175, v175, v179
    v_add_f32 v164, v164, v132
    v_mfma_f32_16x16x32_bf16 v[124:127], a[104:107], a[220:223], v[124:127]
    v_add_f32 v165, v165, v133
    v_add_f32 v166, v166, v134
    v_mfma_f32_16x16x32_bf16 v[128:131], a[108:111], a[220:223], v[128:131]
    buffer_load_dword v1, v252, s[44:47], 0 offen sc1
    s_waitcnt vmcnt(4)
    v_mfma_f32_16x16x32_bf16 v[112:115], a[112:115], a[224:227], v[112:115]
    v_add_f32 v167, v167, v135
    v_add_f32 v164, v164, v172
    v_mfma_f32_16x16x32_bf16 v[116:119], a[116:119], a[224:227], v[116:119]
    v_add_f32 v165, v165, v173
    v_add_f32 v166, v166, v174
    v_mfma_f32_16x16x32_bf16 v[120:123], a[120:123], a[224:227], v[120:123]
    v_add_f32 v167, v167, v175
    v_cvt_pk_bf16_f32 v164, v164, v165
    v_mfma_f32_16x16x32_bf16 v[124:127], a[124:127], a[224:227], v[124:127]
    v_cvt_pk_bf16_f32 v165, v166, v167
    v_mfma_f32_16x16x32_bf16 v[128:131], a[128:131], a[224:227], v[128:131]
    buffer_store_dwordx2 v[164:165], v253, s[56:59], s51 offen offset:0
    s_waitcnt vmcnt(4)
    v_mfma_f32_16x16x32_bf16 v[112:115], a[132:135], a[228:231], v[112:115]
    s_waitcnt lgkmcnt(0)
    v_lshlrev_b32_e64 v136, 16, v214
    v_mfma_f32_16x16x32_bf16 v[116:119], a[136:139], a[228:231], v[116:119]
    v_and_b32 v137, s83, v214
    v_lshlrev_b32 v138, 16, v215
    v_mfma_f32_16x16x32_bf16 v[120:123], a[140:143], a[228:231], v[120:123]
    v_and_b32 v139, s83, v215
    v_add_f32 v192, v192, v196
    v_mfma_f32_16x16x32_bf16 v[124:127], a[144:147], a[228:231], v[124:127]
    v_add_f32 v200, v200, v204
    v_mfma_f32_16x16x32_bf16 v[128:131], a[148:151], a[228:231], v[128:131]
    v_add_f32 v193, v193, v197
    s_waitcnt vmcnt(3)
    v_mfma_f32_16x16x32_bf16 v[112:115], a[152:155], a[232:235], v[112:115]
    v_add_f32 v201, v201, v205
    v_add_f32 v194, v194, v198
    v_mfma_f32_16x16x32_bf16 v[116:119], a[156:159], a[232:235], v[116:119]
    v_add_f32 v202, v202, v206
    v_add_f32_e64 v195, v195, v199
    v_mfma_f32_16x16x32_bf16 v[120:123], a[160:163], a[232:235], v[120:123]
    v_add_f32 v203, v203, v207
    v_add_f32 v192, v192, v136
    v_mfma_f32_16x16x32_bf16 v[124:127], a[164:167], a[232:235], v[124:127]
    v_add_f32_e64 v193, v193, v137
    v_mfma_f32_16x16x32_bf16 v[128:131], a[168:171], a[232:235], v[128:131]
    v_add_f32 v194, v194, v138
    s_waitcnt vmcnt(1)
    v_cmp_ne_u32 vcc, s63, v1
    s_mov_b32 s67, 0
    s_cbranch_vccnz L_h2later
    s_add_u32 s64, s74, 196608
    buffer_load_dwordx4 v[16:19], v15, s[44:47], s64 offen offset:0 sc1
    buffer_load_dwordx4 v[20:23], v15, s[44:47], s64 offen offset:1024 sc1
    buffer_load_dwordx4 v[24:27], v15, s[44:47], s64 offen offset:2048 sc1
    s_nop 0
    s_add_u32 s64, s64, 12288
    buffer_load_dwordx4 v[28:31], v15, s[44:47], s64 offen offset:0 sc1
    buffer_load_dwordx4 v[32:35], v15, s[44:47], s64 offen offset:1024 sc1
    buffer_load_dwordx4 v[36:39], v15, s[44:47], s64 offen offset:2048 sc1
    s_add_u32 s64, s64, 12288
    buffer_load_dwordx4 v[40:43], v15, s[44:47], s64 offen offset:0 sc1
    buffer_load_dwordx4 v[44:47], v15, s[44:47], s64 offen offset:1024 sc1
    s_mov_b32 s67, 1
L_h2later:
    v_mfma_f32_16x16x32_bf16 v[112:115], a[172:175], a[236:239], v[112:115]
    v_add_f32 v195, v195, v139
    v_add_f32 v192, v192, v200
    v_mfma_f32_16x16x32_bf16 v[116:119], a[176:179], a[236:239], v[116:119]
    v_add_f32 v193, v193, v201
    v_add_f32_e64 v194, v194, v202
    v_mfma_f32_16x16x32_bf16 v[120:123], a[180:183], a[236:239], v[120:123]
    v_add_f32_e64 v195, v195, v203
    v_cvt_pk_bf16_f32 v192, v192, v193
    v_mfma_f32_16x16x32_bf16 v[124:127], a[184:187], a[236:239], v[124:127]
    v_cvt_pk_bf16_f32 v193, v194, v195
    v_mfma_f32_16x16x32_bf16 v[128:131], a[188:191], a[236:239], v[128:131]
    buffer_store_dwordx2 v[192:193], v10, s[56:59], s51 offen offset:32
    s_cmp_eq_u32 s67, 1
    s_cbranch_scc1 L_h2got
    buffer_load_dword v1, v252, s[44:47], 0 offen sc1
    s_waitcnt vmcnt(0)
    v_cmp_ne_u32 vcc, s63, v1
    s_cbranch_vccz L_pdone_26
    s_mov_b32 s82, 0
L_poll_25:
    buffer_load_dword v1, v252, s[44:47], 0 offen sc1
    s_waitcnt vmcnt(0)
    v_cmp_ne_u32 vcc, s63, v1
    s_cbranch_vccz L_pdone_26
    s_add_u32 s82, s82, 1
    s_cmp_lt_u32 s82, 400000
    s_cbranch_scc1 L_poll_25
L_pdone_26:
    s_nop 0
    s_add_u32 s64, s74, 196608
    buffer_load_dwordx4 v[16:19], v15, s[44:47], s64 offen offset:0 sc1
    buffer_load_dwordx4 v[20:23], v15, s[44:47], s64 offen offset:1024 sc1
    buffer_load_dwordx4 v[24:27], v15, s[44:47], s64 offen offset:2048 sc1
    s_add_u32 s64, s64, 12288
    buffer_load_dwordx4 v[28:31], v15, s[44:47], s64 offen offset:0 sc1
    buffer_load_dwordx4 v[32:35], v15, s[44:47], s64 offen offset:1024 sc1
    buffer_load_dwordx4 v[36:39], v15, s[44:47], s64 offen offset:2048 sc1
    s_add_u32 s64, s64, 12288
    buffer_load_dwordx4 v[40:43], v15, s[44:47], s64 offen offset:0 sc1
    buffer_load_dwordx4 v[44:47], v15, s[44:47], s64 offen offset:1024 sc1
L_h2got:
    buffer_load_dwordx4 v[48:51], v15, s[44:47], s64 offen offset:2048 sc1
    s_add_u32 s64, s64, 12288
    buffer_load_dwordx4 v[52:55], v15, s[44:47], s64 offen offset:0 sc1
    buffer_load_dwordx4 v[56:59], v15, s[44:47], s64 offen offset:1024 sc1
    buffer_load_dwordx4 v[60:63], v15, s[44:47], s64 offen offset:2048 sc1
    ds_write_b128 v189, v[112:115] offset:20480
    ds_write_b128 v189, v[116:119] offset:21504
    ds_write_b128 v189, v[120:123] offset:22528
    ds_write_b128 v189, v[124:127] offset:23552
    ds_write_b128 v189, v[128:131] offset:24576
    s_waitcnt lgkmcnt(0)
    s_barrier
    ds_read_b64_tr_b16 v[212:213], v11 offset:32
    ds_read_b128 v[164:167], v188 offset:20480
    ds_read_b128 v[168:171], v188 offset:25600
    ds_read_b128 v[172:175], v188 offset:30720
    ds_read_b128 v[176:179], v188 offset:35840
    ds_read_b64_tr_b16 v[214:215], v11 offset:1056
    ds_read_b128 v[192:195], v188 offset:21504
    ds_read_b128 v[196:199], v188 offset:26624
    ds_read_b128 v[200:203], v188 offset:31744
    ds_read_b128 v[204:207], v188 offset:36864
    s_waitcnt vmcnt(11)
    v_mfma_f32_16x16x32_bf16 v[64:67], v[220:223], v[16:19], 0
    s_add_u32 s64, s74, 199680
    buffer_load_dwordx4 a[192:195], v15, s[44:47], s64 offen offset:0 sc1
    v_mfma_f32_16x16x32_bf16 v[68:71], v[224:227], v[16:19], 0
    buffer_load_dwordx4 a[196:199], v15, s[44:47], s64 offen offset:1024 sc1
    v_mfma_f32_16x16x32_bf16 v[72:75], v[228:231], v[16:19], 0
    s_add_u32 s51, s50, 20480
    s_waitcnt lgkmcnt(5)
    v_mfma_f32_16x16x32_bf16 v[76:79], v[232:235], v[16:19], 0
    v_lshlrev_b32 v132, 16, v212
    v_and_b32 v133, s83, v212
    v_mfma_f32_16x16x32_bf16 v[80:83], v[236:239], v[16:19], 0
    v_lshlrev_b32 v134, 16, v213
    s_waitcnt vmcnt(12)
    v_mfma_f32_16x16x32_bf16 v[64:67], v[240:243], v[20:23], v[64:67]
    buffer_load_dwordx4 a[200:203], v15, s[44:47], s64 offen offset:2048 sc1
    v_mfma_f32_16x16x32_bf16 v[68:71], v[244:247], v[20:23], v[68:71]
    v_and_b32_e64 v135, s83, v213
    v_mfma_f32_16x16x32_bf16 v[72:75], v[248:251], v[20:23], v[72:75]
    v_add_f32 v164, v164, v168
    v_add_f32 v172, v172, v176
    v_mfma_f32_16x16x32_bf16 v[76:79], a[240:243], v[20:23], v[76:79]
    v_add_f32_e64 v165, v165, v169
    v_mfma_f32_16x16x32_bf16 v[80:83], a[244:247], v[20:23], v[80:83]
    v_add_f32 v173, v173, v177
    s_waitcnt vmcnt(12)
    v_mfma_f32_16x16x32_bf16 v[64:67], a[248:251], v[24:27], v[64:67]
    s_add_u32 s64, s64, 12288
    buffer_load_dwordx4 a[204:207], v15, s[44:47], s64 offen offset:0 sc1
    v_mfma_f32_16x16x32_bf16 v[68:71], a[252:255], v[24:27], v[68:71]
    v_add_f32 v166, v166, v170
    v_mfma_f32_16x16x32_bf16 v[72:75], a[0:3], v[24:27], v[72:75]
    v_add_f32 v174, v174, v178
    v_add_f32 v167, v167, v171
    v_mfma_f32_16x16x32_bf16 v[76:79], a[4:7], v[24:27], v[76:79]
    v_add_f32 v175, v175, v179
    v_mfma_f32_16x16x32_bf16 v[80:83], a[8:11], v[24:27], v[80:83]
    v_add_f32 v164, v164, v132
    s_waitcnt vmcnt(12)
    v_mfma_f32_16x16x32_bf16 v[64:67], a[12:15], v[28:31], v[64:67]
    buffer_load_dwordx4 a[208:211], v15, s[44:47], s64 offen offset:1024 sc1
    v_mfma_f32_16x16x32_bf16 v[68:71], a[16:19], v[28:31], v[68:71]
    buffer_load_dwordx4 a[212:215], v15, s[44:47], s64 offen offset:2048 sc1
    v_add_f32 v165, v165, v133
    v_mfma_f32_16x16x32_bf16 v[72:75], a[20:23], v[28:31], v[72:75]
    v_add_f32 v166, v166, v134
    v_add_f32 v167, v167, v135
    v_mfma_f32_16x16x32_bf16 v[76:79], a[24:27], v[28:31], v[76:79]
    v_add_f32 v164, v164, v172
    v_mfma_f32_16x16x32_bf16 v[80:83], a[28:31], v[28:31], v[80:83]
    v_add_f32 v165, v165, v173
    s_waitcnt vmcnt(13)
    v_mfma_f32_16x16x32_bf16 v[64:67], a[32:35], v[32:35], v[64:67]
    s_add_u32 s64, s64, 12288
    v_mfma_f32_16x16x32_bf16 v[68:71], a[36:39], v[32:35], v[68:71]
    buffer_load_dwordx4 a[216:219], v15, s[44:47], s64 offen offset:0 sc1
    v_add_f32 v166, v166, v174
    v_mfma_f32_16x16x32_bf16 v[72:75], a[40:43], v[32:35], v[72:75]
    v_add_f32 v167, v167, v175
    v_cvt_pk_bf16_f32 v164, v164, v165
    v_mfma_f32_16x16x32_bf16 v[76:79], a[44:47], v[32:35], v[76:79]
    v_cvt_pk_bf16_f32 v165, v166, v167
    v_mfma_f32_16x16x32_bf16 v[80:83], a[48:51], v[32:35], v[80:83]
    buffer_store_dwordx2 v[164:165], v253, s[56:59], s51 offen offset:0
    s_waitcnt vmcnt(14)
    v_mfma_f32_16x16x32_bf16 v[64:67], a[52:55], v[36:39], v[64:67]
    buffer_load_dwordx4 a[220:223], v15, s[44:47], s64 offen offset:1024 sc1
    v_mfma_f32_16x16x32_bf16 v[68:71], a[56:59], v[36:39], v[68:71]
    s_waitcnt lgkmcnt(0)
    v_mfma_f32_16x16x32_bf16 v[72:75], a[60:63], v[36:39], v[72:75]
    v_lshlrev_b32 v136, 16, v214
    v_and_b32 v137, s83, v214
    v_mfma_f32_16x16x32_bf16 v[76:79], a[64:67], v[36:39], v[76:79]
    v_lshlrev_b32 v138, 16, v215
    v_mfma_f32_16x16x32_bf16 v[80:83], a[68:71], v[36:39], v[80:83]
    v_and_b32 v139, s83, v215
    s_waitcnt vmcnt(14)
    v_mfma_f32_16x16x32_bf16 v[64:67], a[72:75], v[40:43], v[64:67]
    buffer_load_dwordx4 a[224:227], v15, s[44:47], s64 offen offset:2048 sc1
    v_mfma_f32_16x16x32_bf16 v[68:71], a[76:79], v[40:43], v[68:71]
    s_add_u32 s64, s64, 12288
    v_add_f32 v192, v192, v196
    v_mfma_f32_16x16x32_bf16 v[72:75], a[80:83], v[40:43], v[72:75]
    v_add_f32 v200, v200, v204
    v_add_f32 v193, v193, v197
    v_mfma_f32_16x16x32_bf16 v[76:79], a[84:87], v[40:43], v[76:79]
    v_add_f32 v201, v201, v205
    v_mfma_f32_16x16x32_bf16 v[80:83], a[88:91], v[40:43], v[80:83]
    v_add_f32 v194, v194, v198
    s_waitcnt vmcnt(14)
    v_mfma_f32_16x16x32_bf16 v[64:67], a[92:95], v[44:47], v[64:67]
    buffer_load_dwordx4 a[228:231], v15, s[44:47], s64 offen offset:0 sc1
    v_mfma_f32_16x16x32_bf16 v[68:71], a[96:99], v[44:47], v[68:71]
    buffer_load_dwordx4 a[232:235], v15, s[44:47], s64 offen offset:1024 sc1
    v_add_f32 v202, v202, v206
    v_mfma_f32_16x16x32_bf16 v[72:75], a[100:103], v[44:47], v[72:75]
    v_add_f32 v195, v195, v199
    v_add_f32 v203, v203, v207
    v_mfma_f32_16x16x32_bf16 v[76:79], a[104:107], v[44:47], v[76:79]
    v_add_f32 v192, v192, v136
    v_mfma_f32_16x16x32_bf16 v[80:83], a[108:111], v[44:47], v[80:83]
    v_add_f32 v193, v193, v137
    s_waitcnt vmcnt(15)
    v_mfma_f32_16x16x32_bf16 v[64:67], a[112:115], v[48:51], v[64:67]
    buffer_load_dwordx4 a[236:239], v15, s[44:47], s64 offen offset:2048 sc1
    v_mfma_f32_16x16x32_bf16 v[68:71], a[116:119], v[48:51], v[68:71]
    v_add_f32 v194, v194, v138
    v_mfma_f32_16x16x32_bf16 v[72:75], a[120:123], v[48:51], v[72:75]
    v_add_f32 v195, v195, v139
    v_add_f32 v192, v192, v200
    v_mfma_f32_16x16x32_bf16 v[76:79], a[124:127], v[48:51], v[76:79]
    v_add_f32 v193, v193, v201
    v_mfma_f32_16x16x32_bf16 v[80:83], a[128:131], v[48:51], v[80:83]
    v_add_f32 v194, v194, v202
    s_waitcnt vmcnt(15)
    v_mfma_f32_16x16x32_bf16 v[64:67], a[132:135], v[52:55], v[64:67]
    v_add_f32 v195, v195, v203
    v_mfma_f32_16x16x32_bf16 v[68:71], a[136:139], v[52:55], v[68:71]
    v_cvt_pk_bf16_f32 v192, v192, v193
    v_mfma_f32_16x16x32_bf16 v[72:75], a[140:143], v[52:55], v[72:75]
    v_cvt_pk_bf16_f32 v193, v194, v195
    v_mfma_f32_16x16x32_bf16 v[76:79], a[144:147], v[52:55], v[76:79]
    buffer_store_dwordx2 v[192:193], v10, s[56:59], s51 offen offset:32
    v_mfma_f32_16x16x32_bf16 v[80:83], a[148:151], v[52:55], v[80:83]
    s_waitcnt vmcnt(15)
    v_mfma_f32_16x16x32_bf16 v[64:67], a[152:155], v[56:59], v[64:67]
    v_mfma_f32_16x16x32_bf16 v[68:71], a[156:159], v[56:59], v[68:71]
    v_mfma_f32_16x16x32_bf16 v[72:75], a[160:163], v[56:59], v[72:75]
    v_mfma_f32_16x16x32_bf16 v[76:79], a[164:167], v[56:59], v[76:79]
    v_mfma_f32_16x16x32_bf16 v[80:83], a[168:171], v[56:59], v[80:83]
    s_waitcnt vmcnt(14)
    v_mfma_f32_16x16x32_bf16 v[64:67], a[172:175], v[60:63], v[64:67]
    v_mfma_f32_16x16x32_bf16 v[68:71], a[176:179], v[60:63], v[68:71]
    v_mfma_f32_16x16x32_bf16 v[72:75], a[180:183], v[60:63], v[72:75]
    v_mfma_f32_16x16x32_bf16 v[76:79], a[184:187], v[60:63], v[76:79]
    v_mfma_f32_16x16x32_bf16 v[80:83], a[188:191], v[60:63], v[80:83]
    s_waitcnt vmcnt(13)
    v_mfma_f32_16x16x32_bf16 v[84:87], v[220:223], a[192:195], 0
    v_mfma_f32_16x16x32_bf16 v[88:91], v[224:227], a[192:195], 0
    v_mfma_f32_16x16x32_bf16 v[92:95], v[228:231], a[192:195], 0
    v_mfma_f32_16x16x32_bf16 v[96:99], v[232:235], a[192:195], 0
    v_mfma_f32_16x16x32_bf16 v[100:103], v[236:239], a[192:195], 0
    s_waitcnt vmcnt(12)
    v_mfma_f32_16x16x32_bf16 v[84:87], v[240:243], a[196:199], v[84:87]
    ds_write_b128 v189, v[64:67] offset:40960
    v_mfma_f32_16x16x32_bf16 v[88:91], v[244:247], a[196:199], v[88:91]
    ds_write_b128 v189, v[68:71] offset:41984
    v_mfma_f32_16x16x32_bf16 v[92:95], v[248:251], a[196:199], v[92:95]
    v_mfma_f32_16x16x32_bf16 v[96:99], a[240:243], a[196:199], v[96:99]
    v_mfma_f32_16x16x32_bf16 v[100:103], a[244:247], a[196:199], v[100:103]
    s_waitcnt vmcnt(11)
    v_mfma_f32_16x16x32_bf16 v[84:87], a[248:251], a[200:203], v[84:87]
    ds_write_b128 v189, v[72:75] offset:43008
    v_mfma_f32_16x16x32_bf16 v[88:91], a[252:255], a[200:203], v[88:91]
    ds_write_b128 v189, v[76:79] offset:44032
    v_mfma_f32_16x16x32_bf16 v[92:95], a[0:3], a[200:203], v[92:95]
    v_mfma_f32_16x16x32_bf16 v[96:99], a[4:7], a[200:203], v[96:99]
    v_mfma_f32_16x16x32_bf16 v[100:103], a[8:11], a[200:203], v[100:103]
    s_waitcnt vmcnt(10)
    v_mfma_f32_16x16x32_bf16 v[84:87], a[12:15], a[204:207], v[84:87]
    ds_write_b128 v189, v[80:83] offset:45056
    v_mfma_f32_16x16x32_bf16 v[88:91], a[16:19], a[204:207], v[88:91]
    v_mfma_f32_16x16x32_bf16 v[92:95], a[20:23], a[204:207], v[92:95]
    v_mfma_f32_16x16x32_bf16 v[96:99], a[24:27], a[204:207], v[96:99]
    v_mfma_f32_16x16x32_bf16 v[100:103], a[28:31], a[204:207], v[100:103]
    s_waitcnt lgkmcnt(0)
    s_barrier
    s_waitcnt vmcnt(9)
    v_mfma_f32_16x16x32_bf16 v[84:87], a[32:35], a[208:211], v[84:87]
    ds_read_b64_tr_b16 v[212:213], v11 offset:5120
    ds_read_b128 v[164:167], v188 offset:40960
    v_mfma_f32_16x16x32_bf16 v[88:91], a[36:39], a[208:211], v[88:91]
    ds_read_b128 v[168:171], v188 offset:46080
    v_mfma_f32_16x16x32_bf16 v[92:95], a[40:43], a[208:211], v[92:95]
    ds_read_b128 v[172:175], v188 offset:51200
    v_mfma_f32_16x16x32_bf16 v[96:99], a[44:47], a[208:211], v[96:99]
    ds_read_b128 v[176:179], v188 offset:56320
    v_mfma_f32_16x16x32_bf16 v[100:103], a[48:51], a[208:211], v[100:103]
    s_waitcnt vmcnt(8)
    v_mfma_f32_16x16x32_bf16 v[84:87], a[52:55], a[212:215], v[84:87]
    ds_read_b64_tr_b16 v[214:215], v11 offset:6144
    ds_read_b128 v[192:195], v188 offset:41984
    v_mfma_f32_16x16x32_bf16 v[88:91], a[56:59], a[212:215], v[88:91]
    ds_read_b128 v[196:199], v188 offset:47104
    v_mfma_f32_16x16x32_bf16 v[92:95], a[60:63], a[212:215], v[92:95]
    ds_read_b128 v[200:203], v188 offset:52224
    v_mfma_f32_16x16x32_bf16 v[96:99], a[64:67], a[212:215], v[96:99]
    ds_read_b128 v[204:207], v188 offset:57344
    v_mfma_f32_16x16x32_bf16 v[100:103], a[68:71], a[212:215], v[100:103]
    s_waitcnt vmcnt(6)
    v_mfma_f32_16x16x32_bf16 v[84:87], a[72:75], a[216:219], v[84:87]
    s_add_u32 s51, s50, 1310720
    s_waitcnt lgkmcnt(5)
    v_mfma_f32_16x16x32_bf16 v[88:91], a[76:79], a[216:219], v[88:91]
    v_lshlrev_b32 v132, 16, v212
    v_and_b32 v133, s83, v212
    v_mfma_f32_16x16x32_bf16 v[92:95], a[80:83], a[216:219], v[92:95]
    v_lshlrev_b32 v134, 16, v213
    v_and_b32 v135, s83, v213
    v_mfma_f32_16x16x32_bf16 v[96:99], a[84:87], a[216:219], v[96:99]
    v_add_f32 v164, v164, v168
    v_add_f32 v172, v172, v176
    v_mfma_f32_16x16x32_bf16 v[100:103], a[88:91], a[216:219], v[100:103]
    v_add_f32 v165, v165, v169
    s_waitcnt vmcnt(5)
    v_mfma_f32_16x16x32_bf16 v[84:87], a[92:95], a[220:223], v[84:87]
    v_add_f32 v173, v173, v177
    v_add_f32 v166, v166, v170
    v_mfma_f32_16x16x32_bf16 v[88:91], a[96:99], a[220:223], v[88:91]
    v_add_f32 v174, v174, v178
    v_add_f32 v167, v167, v171
    v_mfma_f32_16x16x32_bf16 v[92:95], a[100:103], a[220:223], v[92:95]
    v_add_f32 v175, v175, v179
    v_add_f32 v164, v164, v132
    v_mfma_f32_16x16x32_bf16 v[96:99], a[104:107], a[220:223], v[96:99]
    v_add_f32 v165, v165, v133
    v_mfma_f32_16x16x32_bf16 v[100:103], a[108:111], a[220:223], v[100:103]
    v_add_f32 v166, v166, v134
    s_waitcnt vmcnt(4)
    v_mfma_f32_16x16x32_bf16 v[84:87], a[112:115], a[224:227], v[84:87]
    v_add_f32 v167, v167, v135
    v_add_f32 v164, v164, v172
    v_mfma_f32_16x16x32_bf16 v[88:91], a[116:119], a[224:227], v[88:91]
    v_add_f32 v165, v165, v173
    v_add_f32 v166, v166, v174
    v_mfma_f32_16x16x32_bf16 v[92:95], a[120:123], a[224:227], v[92:95]
    v_add_f32 v167, v167, v175
    v_cvt_pk_bf16_f32 v164, v164, v165
    v_mfma_f32_16x16x32_bf16 v[96:99], a[124:127], a[224:227], v[96:99]
    v_cvt_pk_bf16_f32 v165, v166, v167
    v_mfma_f32_16x16x32_bf16 v[100:103], a[128:131], a[224:227], v[100:103]
    buffer_store_dwordx2 v[164:165], v253, s[56:59], s51 offen offset:0
    s_waitcnt vmcnt(4)
    v_mfma_f32_16x16x32_bf16 v[84:87], a[132:135], a[228:231], v[84:87]
    s_waitcnt lgkmcnt(0)
    v_lshlrev_b32 v136, 16, v214
    v_mfma_f32_16x16x32_bf16 v[88:91], a[136:139], a[228:231], v[88:91]
    v_and_b32 v137, s83, v214
    v_lshlrev_b32_e64 v138, 16, v215
    v_mfma_f32_16x16x32_bf16 v[92:95], a[140:143], a[228:231], v[92:95]
    v_and_b32 v139, s83, v215
    v_add_f32 v192, v192, v196
    v_mfma_f32_16x16x32_bf16 v[96:99], a[144:147], a[228:231], v[96:99]
    v_add_f32_e64 v200, v200, v204
    v_mfma_f32_16x16x32_bf16 v[100:103], a[148:151], a[228:231], v[100:103]
    v_add_f32 v193, v193, v197
    s_waitcnt vmcnt(3)
    v_mfma_f32_16x16x32_bf16 v[84:87], a[152:155], a[232:235], v[84:87]
    v_add_f32 v201, v201, v205
    v_add_f32 v194, v194, v198
    v_mfma_f32_16x16x32_bf16 v[88:91], a[156:159], a[232:235], v[88:91]
    v_add_f32 v202, v202, v206
    v_add_f32 v195, v195, v199
    v_mfma_f32_16x16x32_bf16 v[92:95], a[160:163], a[232:235], v[92:95]
    v_add_f32 v203, v203, v207
    v_add_f32 v192, v192, v136
    v_mfma_f32_16x16x32_bf16 v[96:99], a[164:167], a[232:235], v[96:99]
    v_add_f32 v193, v193, v137
    v_mfma_f32_16x16x32_bf16 v[100:103], a[168:171], a[232:235], v[100:103]
    v_add_f32 v194, v194, v138
    s_waitcnt vmcnt(2)
    v_mfma_f32_16x16x32_bf16 v[84:87], a[172:175], a[236:239], v[84:87]
    v_add_f32 v195, v195, v139
    v_add_f32 v192, v192, v200
    v_mfma_f32_16x16x32_bf16 v[88:91], a[176:179], a[236:239], v[88:91]
    v_add_f32 v193, v193, v201
    v_add_f32_e64 v194, v194, v202
    v_mfma_f32_16x16x32_bf16 v[92:95], a[180:183], a[236:239], v[92:95]
    v_add_f32_e64 v195, v195, v203
    v_cvt_pk_bf16_f32 v192, v192, v193
    v_mfma_f32_16x16x32_bf16 v[96:99], a[184:187], a[236:239], v[96:99]
    v_cvt_pk_bf16_f32 v193, v194, v195
    v_mfma_f32_16x16x32_bf16 v[100:103], a[188:191], a[236:239], v[100:103]
    buffer_store_dwordx2 v[192:193], v10, s[56:59], s51 offen offset:32
    ds_write_b128 v189, v[84:87] offset:0
    ds_write_b128 v189, v[88:91] offset:1024
    ds_write_b128 v189, v[92:95] offset:2048
    s_nop 1
    ds_write_b128 v189, v[96:99] offset:3072
    s_nop 0
    ds_write_b128 v189, v[100:103] offset:4096
    s_waitcnt lgkmcnt(0)
    s_barrier
    ds_read_b64_tr_b16 v[212:213], v11 offset:5152
    ds_read_b128 v[164:167], v188 offset:0
    ds_read_b128 v[168:171], v188 offset:5120
    ds_read_b128 v[172:175], v188 offset:10240
    ds_read_b128 v[176:179], v188 offset:15360
    ds_read_b64_tr_b16 v[214:215], v11 offset:6176
    ds_read_b128 v[192:195], v188 offset:1024
    ds_read_b128 v[196:199], v188 offset:6144
    ds_read_b128 v[200:203], v188 offset:11264
    ds_read_b128 v[204:207], v188 offset:16384
    s_add_u32 s51, s50, 1331200
    s_waitcnt lgkmcnt(5)
    v_lshlrev_b32 v132, 16, v212
    v_and_b32 v133, s83, v212
    v_lshlrev_b32 v134, 16, v213
    v_and_b32 v135, s83, v213
    v_add_f32 v164, v164, v168
    v_add_f32 v172, v172, v176
    v_add_f32 v165, v165, v169
    v_add_f32 v173, v173, v177
    v_add_f32 v166, v166, v170
    v_add_f32 v174, v174, v178
    v_add_f32 v167, v167, v171
    v_add_f32 v175, v175, v179
    v_add_f32 v164, v164, v132
    v_add_f32 v165, v165, v133
    v_add_f32 v166, v166, v134
    v_add_f32 v167, v167, v135
    v_add_f32 v164, v164, v172
    v_add_f32 v165, v165, v173
    v_add_f32 v166, v166, v174
    v_add_f32_e64 v167, v167, v175
    v_cvt_pk_bf16_f32 v164, v164, v165
    v_cvt_pk_bf16_f32 v165, v166, v167
    buffer_store_dwordx2 v[164:165], v253, s[56:59], s51 offen offset:0
    s_waitcnt lgkmcnt(0)
    v_lshlrev_b32 v136, 16, v214
    v_and_b32 v137, s83, v214
    v_lshlrev_b32 v138, 16, v215
    v_and_b32 v139, s83, v215
    v_add_f32 v192, v192, v196
    v_add_f32 v200, v200, v204
    v_add_f32 v193, v193, v197
    v_add_f32 v201, v201, v205
    v_add_f32 v194, v194, v198
    v_add_f32 v202, v202, v206
    v_add_f32 v195, v195, v199
    v_add_f32 v203, v203, v207
    v_add_f32 v192, v192, v136
    v_add_f32 v193, v193, v137
    v_add_f32 v194, v194, v138
    v_add_f32 v195, v195, v139
    v_add_f32 v192, v192, v200
    v_add_f32 v193, v193, v201
    v_add_f32 v194, v194, v202
    v_add_f32_e64 v195, v195, v203
    v_cvt_pk_bf16_f32 v192, v192, v193
    v_cvt_pk_bf16_f32 v193, v194, v195
    buffer_store_dwordx2 v[192:193], v10, s[56:59], s51 offen offset:32
L_end:
    s_endpgm
.section .rodata,"a"
.p2align 6
.amdhsa_kernel sequential_preLN__ssm_conv_s4d__glu_gated_bilinear__prompt_kernel
  .amdhsa_next_free_vgpr 512
  .amdhsa_next_free_sgpr 102
  .amdhsa_accum_offset 256
  .amdhsa_group_segment_fixed_size 0
  .amdhsa_kernarg_size 112
  .amdhsa_user_sgpr_count 2
  .amdhsa_user_sgpr_kernarg_segment_ptr 1
  .amdhsa_system_sgpr_workgroup_id_x 1
  .amdhsa_float_denorm_mode_32 3
.end_amdhsa_kernel
```
